```python
import torch

def _softmax(x, axis=-1):
    return torch.softmax(x, dim=axis)
def _gelu(x):
    return torch.nn.functional.gelu(x, approximate="tanh")
def _silu(x):
    return torch.nn.functional.silu(x)
def _sigmoid(x):
    return torch.sigmoid(x)
def _layernorm(x, axis=-1, eps=1e-5):
    m = x.mean(dim=axis, keepdim=True)
    v = x.var(dim=axis, keepdim=True, unbiased=False)
    return (x - m) / torch.sqrt(v + eps)
def _scatter_add(tgt, idx, src, axis=0):
    return tgt.clone().index_add_(axis, idx, src)
def _segment_sum(src, seg, n):
    out = torch.zeros((n,) + src.shape[1:], dtype=src.dtype)
    return out.index_add_(0, seg, src)
def _pad(x, pw):
    flat = tuple(v for pair in reversed(pw) for v in pair)
    return torch.nn.functional.pad(x, flat)

kernel_name = 'sequential_preLN__spectral_gfnet__dense_activation_silu__prompt'

def setup_inputs():

    _w = (lambda a: (lambda t: t.to(torch.bfloat16) if t.is_floating_point() else t)(torch.as_tensor(a)))
    def _A_setup():
        B, S, D = 1, 2048, 640
        Df = D // 2 + 1
        return {
            "x": _w((lambda *s: torch.randn(*s, dtype=torch.bfloat16) * 0.05)(B, S, D)),
            "w_r": _w((lambda *s: torch.randn(*s, dtype=torch.bfloat16) * 0.4)(S, Df) * 0.02),
            "w_i": _w((lambda *s: torch.randn(*s, dtype=torch.bfloat16) * 0.4)(S, Df) * 0.02),
        }
    _A_in = _A_setup()

    def _B_setup():
        B, S, D, F = 1, 2048, 640, 1728
        return {
            "x": _w((lambda *s: torch.randn(*s, dtype=torch.bfloat16) * 0.05)(B, S, D)),
            "w1": _w((lambda *s: torch.randn(*s, dtype=torch.bfloat16) * 0.8)(D, F) * (D ** -0.5)),
            "w2": _w((lambda *s: torch.randn(*s, dtype=torch.bfloat16) * 0.1)(F, D) * (F ** -0.5)),
        }
    _B_in = _B_setup()

    return {
        "A_x": _A_in["x"],
        "A_w_r": _A_in["w_r"],
        "A_w_i": _A_in["w_i"],
        "B_x": _B_in["x"],
        "B_w1": _B_in["w1"],
        "B_w2": _B_in["w2"],
    }

def reference(A_x, A_w_r, A_w_i, B_x, B_w1, B_w2):
    def _A_ref(x, w_r, w_i):
        B, S, D = x.shape
        X = (lambda x, axes=(-2,-1): torch.fft.rfft2(x.float(), dim=axes))(x, axes=(-2, -1))
        W = w_r + 1j * w_i
        X = X * W
        y = (lambda x, s, axes=(-2,-1): torch.fft.irfft2(x, s=s, dim=axes).to(torch.bfloat16))(X, (S, D), axes=(-2, -1))
        return y

    def _B_ref(x, w1, w2):
        h = torch.einsum("bsd,df->bsf", x, w1)
        h = _silu(h)
        out = torch.einsum("bsf,fd->bsd", h, w2)
        return out

    x = A_x
    h = x + _A_ref(_layernorm(x, axis=-1), A_w_r, A_w_i)
    h2 = h + _B_ref(_layernorm(h, axis=-1), B_w1, B_w2)
    return h2
```

```asm
; @launch kernel=sequential_preLN__spectral_gfnet__dense_activation_silu__prompt_kernel grid=(256,1,1) block=(256,1,1) lds=163840
.amdgcn_target "amdgcn-amd-amdhsa--gfx950"
.text
.globl sequential_preLN__spectral_gfnet__dense_activation_silu__prompt_kernel
.p2align 8
.type sequential_preLN__spectral_gfnet__dense_activation_silu__prompt_kernel,@function
sequential_preLN__spectral_gfnet__dense_activation_silu__prompt_kernel:
    s_load_dwordx2 s[8:9], s[0:1], 0
    s_load_dwordx4 s[36:39], s[0:1], 8
    s_load_dwordx2 s[6:7], s[0:1], 64
    s_load_dwordx8 s[44:51], s[0:1], 32
    s_getpc_b64 s[12:13]
K_pc:
    s_mov_b32 s14, CODE_END - K_pc
    s_mov_b32 s15, 0x20000
    v_lshlrev_b32 v255, 3, v0
    s_lshr_b32 s3, s2, 3
    s_lshl_b32 s3, s3, 11
    buffer_load_dword v254, v255, s[12:15], s3 offen
    s_cmp_ge_u32 s2, 256
    s_cbranch_scc1 K_end
    v_lshrrev_b32 v14, 4, v0
    v_and_b32 v15, 15, v0
    v_readfirstlane_b32 s20, v14
    v_and_b32 v14, 3, v14
    s_bfe_u32 s3, s2, 0x30003
    s_and_b32 s52, s2, 7
    s_lshl3_add_u32 s52, s52, s3
    s_lshr_b32 s3, s52, 4
    s_mulk_i32 s3, 224
    s_lshl1_add_u32 s23, s52, s3
    s_lshr_b32 s20, s20, 2
    s_and_b32 s27, s20, 1
    s_lshl_b32 s26, s27, 3
    v_xor_b32 v17, v15, v14
    v_xor_b32 v17, s26, v17
    v_lshrrev_b32 v18, 3, v17
    v_lshlrev_b32 v17, 4, v17
    v_lshl_add_u32 v17, v18, 9, v17
    v_mul_u32_u24 v16, 40960, v14
    v_add_u32 v180, v16, v17
    v_xor_b32 v181, 64, v180
    s_add_u32 s23, s23, s27
    s_lshr_b32 s25, s20, 1
    s_lshl_b32 s24, s25, 10
    s_add_u32 s23, s23, s24
    s_mulk_i32 s23, 1280
    s_add_u32 s24, s23, 162816
    s_lshl_b32 s3, s20, 11
    s_add_u32 m0, s3, 114688
    s_mov_b32 s10, 2621440
    s_mov_b32 s11, 0x20000
    s_waitcnt lgkmcnt(0)
    buffer_load_dwordx4 v180, s[8:11], s23 offen offset:0 lds
    buffer_load_dwordx4 v181, s[8:11], s24 offen offset:1024 lds
    s_addk_i32 m0, 8064
    s_nop 0
    buffer_load_dwordx4 v180, s[8:11], s23 offen offset:128 lds
    buffer_load_dwordx4 v181, s[8:11], s24 offen offset:1152 lds
    s_lshl2_add_u32 s3, s2, s20
    s_lshl_b32 s3, s3, 6
    s_add_u32 s3, s3, JTAB - K_pc
    s_add_u32 s12, s12, s3
    s_addc_u32 s13, s13, 0
    s_load_dwordx8 s[56:63], s[12:13], 0
    s_load_dwordx4 s[96:99], s[12:13], 32
    s_load_dwordx4 s[40:43], s[12:13], 48
    s_lshr_b32 s53, s2, 6
    v_and_b32 v1, 63, v0
    v_lshlrev_b32 v5, 3, v14
    v_cvt_f32_u32 v252, v5
    v_lshrrev_b32 v253, 1, v15
    v_and_b32 v5, 1, v253
    v_xor_b32 v5, 1, v5
    v_lshlrev_b32 v16, 31, v5
    v_or_b32 v16, 1.0, v16
    s_addk_i32 m0, 8064
    s_nop 0
    buffer_load_dwordx4 v180, s[8:11], s23 offen offset:256 lds
    v_and_b32 v5, s27, v5
    v_and_b32 v6, 1, v15
    v_lshl_add_u32 v5, v5, 1, v6
    v_cvt_f32_u32 v5, v5
    v_mul_f32 v17, 0x3e800000, v5
    s_lshl_b32 s22, s53, 2
    s_add_u32 s22, s22, s20
    s_lshl_b32 s22, s22, 3
    s_add_u32 s22, s22, 1
    v_add_u32 v18, s22, v253
    buffer_load_dwordx4 v181, s[8:11], s24 offen offset:1280 lds
    v_cvt_f32_u32 v5, v18
    v_mul_f32 v2, 0x3acccccd, v5
    v_mul_f32 v5, 0x42000000, v2
    v_cos_f32 v4, v5
    v_fma_f32 v3, v252, v2, v17
    v_add_f32 v4, v4, v4
    v_cos_f32 v140, v3
    s_addk_i32 m0, 8064
    s_nop 0
    buffer_load_dwordx4 v180, s[8:11], s23 offen offset:384 lds
    v_fmamk_f32 v141, v2, 0x3f800000, v3
    v_cos_f32 v141, v141
    v_fmamk_f32 v142, v2, 0x40000000, v3
    v_cos_f32 v142, v142
    v_fmamk_f32 v143, v2, 0x40400000, v3
    v_cos_f32 v143, v143
    buffer_load_dwordx4 v181, s[8:11], s24 offen offset:1408 lds
    v_fmamk_f32 v144, v2, 0x40800000, v3
    v_cos_f32 v144, v144
    v_fmamk_f32 v145, v2, 0x40a00000, v3
    v_cos_f32 v145, v145
    v_fmamk_f32 v146, v2, 0x40c00000, v3
    v_cos_f32 v146, v146
    s_addk_i32 m0, 8064
    s_nop 0
    buffer_load_dwordx4 v180, s[8:11], s23 offen offset:512 lds
    v_fmamk_f32 v147, v2, 0x40e00000, v3
    v_cos_f32 v147, v147
    v_fmamk_f32 v148, v2, 0x42000000, v3
    v_cos_f32 v148, v148
    v_fmamk_f32 v149, v2, 0x42040000, v3
    v_cos_f32 v149, v149
    buffer_load_dwordx4 v181, s[8:11], s24 offen offset:1536 lds
    v_fmamk_f32 v150, v2, 0x42080000, v3
    v_cos_f32 v150, v150
    v_fmamk_f32 v151, v2, 0x420c0000, v3
    v_cos_f32 v151, v151
    v_fmamk_f32 v152, v2, 0x42100000, v3
    v_cos_f32 v152, v152
    v_fmamk_f32 v153, v2, 0x42140000, v3
    v_cos_f32 v153, v153
    v_fmamk_f32 v154, v2, 0x42180000, v3
    v_cos_f32 v154, v154
    v_fmamk_f32 v155, v2, 0x421c0000, v3
    v_cos_f32 v155, v155
    v_mov_b32 v236, 0x3f803f80
    v_mov_b32 v228, 0xbf803f80
    v_mov_b32 v237, 0x3f803f80
    v_mov_b32 v229, 0xbf803f80
    v_mov_b32 v238, 0x3f803f80
    v_mov_b32 v230, 0xbf803f80
    v_mov_b32 v239, 0x3f803f80
    v_mov_b32 v231, 0xbf803f80
    v_cvt_pk_bf16_f32 v20, v140, v141
    v_cvt_pk_bf16_f32 v21, v142, v143
    v_cvt_pk_bf16_f32 v22, v144, v145
    v_cvt_pk_bf16_f32 v23, v146, v147
    v_cvt_pk_bf16_f32 v24, v148, v149
    v_cvt_pk_bf16_f32 v25, v150, v151
    v_cvt_pk_bf16_f32 v26, v152, v153
    v_cvt_pk_bf16_f32 v27, v154, v155
    v_pk_fma_f32 v[140:141], v[4:5], v[148:149], v[140:141] op_sel_hi:[0,1,1] neg_lo:[0,0,1] neg_hi:[0,0,1]
    v_pk_fma_f32 v[142:143], v[4:5], v[150:151], v[142:143] op_sel_hi:[0,1,1] neg_lo:[0,0,1] neg_hi:[0,0,1]
    v_pk_fma_f32 v[144:145], v[4:5], v[152:153], v[144:145] op_sel_hi:[0,1,1] neg_lo:[0,0,1] neg_hi:[0,0,1]
    v_pk_fma_f32 v[146:147], v[4:5], v[154:155], v[146:147] op_sel_hi:[0,1,1] neg_lo:[0,0,1] neg_hi:[0,0,1]
    v_cvt_pk_bf16_f32 v28, v140, v141
    v_cvt_pk_bf16_f32 v29, v142, v143
    v_cvt_pk_bf16_f32 v30, v144, v145
    v_cvt_pk_bf16_f32 v31, v146, v147
    v_pk_fma_f32 v[148:149], v[4:5], v[140:141], v[148:149] op_sel_hi:[0,1,1] neg_lo:[0,0,1] neg_hi:[0,0,1]
    v_pk_fma_f32 v[150:151], v[4:5], v[142:143], v[150:151] op_sel_hi:[0,1,1] neg_lo:[0,0,1] neg_hi:[0,0,1]
    v_pk_fma_f32 v[152:153], v[4:5], v[144:145], v[152:153] op_sel_hi:[0,1,1] neg_lo:[0,0,1] neg_hi:[0,0,1]
    v_pk_fma_f32 v[154:155], v[4:5], v[146:147], v[154:155] op_sel_hi:[0,1,1] neg_lo:[0,0,1] neg_hi:[0,0,1]
    v_cvt_pk_bf16_f32 v32, v148, v149
    v_cvt_pk_bf16_f32 v33, v150, v151
    v_cvt_pk_bf16_f32 v34, v152, v153
    v_cvt_pk_bf16_f32 v35, v154, v155
    v_pk_fma_f32 v[140:141], v[4:5], v[148:149], v[140:141] op_sel_hi:[0,1,1] neg_lo:[0,0,1] neg_hi:[0,0,1]
    v_pk_fma_f32 v[142:143], v[4:5], v[150:151], v[142:143] op_sel_hi:[0,1,1] neg_lo:[0,0,1] neg_hi:[0,0,1]
    v_pk_fma_f32 v[144:145], v[4:5], v[152:153], v[144:145] op_sel_hi:[0,1,1] neg_lo:[0,0,1] neg_hi:[0,0,1]
    v_pk_fma_f32 v[146:147], v[4:5], v[154:155], v[146:147] op_sel_hi:[0,1,1] neg_lo:[0,0,1] neg_hi:[0,0,1]
    v_cvt_pk_bf16_f32 v36, v140, v141
    v_cvt_pk_bf16_f32 v37, v142, v143
    v_cvt_pk_bf16_f32 v38, v144, v145
    v_cvt_pk_bf16_f32 v39, v146, v147
    v_pk_fma_f32 v[148:149], v[4:5], v[140:141], v[148:149] op_sel_hi:[0,1,1] neg_lo:[0,0,1] neg_hi:[0,0,1]
    v_pk_fma_f32 v[150:151], v[4:5], v[142:143], v[150:151] op_sel_hi:[0,1,1] neg_lo:[0,0,1] neg_hi:[0,0,1]
    v_pk_fma_f32 v[152:153], v[4:5], v[144:145], v[152:153] op_sel_hi:[0,1,1] neg_lo:[0,0,1] neg_hi:[0,0,1]
    v_pk_fma_f32 v[154:155], v[4:5], v[146:147], v[154:155] op_sel_hi:[0,1,1] neg_lo:[0,0,1] neg_hi:[0,0,1]
    v_cvt_pk_bf16_f32 v40, v148, v149
    v_cvt_pk_bf16_f32 v41, v150, v151
    v_cvt_pk_bf16_f32 v42, v152, v153
    v_cvt_pk_bf16_f32 v43, v154, v155
    v_pk_fma_f32 v[140:141], v[4:5], v[148:149], v[140:141] op_sel_hi:[0,1,1] neg_lo:[0,0,1] neg_hi:[0,0,1]
    v_pk_fma_f32 v[142:143], v[4:5], v[150:151], v[142:143] op_sel_hi:[0,1,1] neg_lo:[0,0,1] neg_hi:[0,0,1]
    v_pk_fma_f32 v[144:145], v[4:5], v[152:153], v[144:145] op_sel_hi:[0,1,1] neg_lo:[0,0,1] neg_hi:[0,0,1]
    v_pk_fma_f32 v[146:147], v[4:5], v[154:155], v[146:147] op_sel_hi:[0,1,1] neg_lo:[0,0,1] neg_hi:[0,0,1]
    v_cvt_pk_bf16_f32 v44, v140, v141
    v_cvt_pk_bf16_f32 v45, v142, v143
    v_cvt_pk_bf16_f32 v46, v144, v145
    v_cvt_pk_bf16_f32 v47, v146, v147
    v_pk_fma_f32 v[148:149], v[4:5], v[140:141], v[148:149] op_sel_hi:[0,1,1] neg_lo:[0,0,1] neg_hi:[0,0,1]
    v_pk_fma_f32 v[150:151], v[4:5], v[142:143], v[150:151] op_sel_hi:[0,1,1] neg_lo:[0,0,1] neg_hi:[0,0,1]
    v_pk_fma_f32 v[152:153], v[4:5], v[144:145], v[152:153] op_sel_hi:[0,1,1] neg_lo:[0,0,1] neg_hi:[0,0,1]
    v_pk_fma_f32 v[154:155], v[4:5], v[146:147], v[154:155] op_sel_hi:[0,1,1] neg_lo:[0,0,1] neg_hi:[0,0,1]
    v_cvt_pk_bf16_f32 v48, v148, v149
    v_cvt_pk_bf16_f32 v49, v150, v151
    v_cvt_pk_bf16_f32 v50, v152, v153
    v_cvt_pk_bf16_f32 v51, v154, v155
    v_pk_fma_f32 v[140:141], v[4:5], v[148:149], v[140:141] op_sel_hi:[0,1,1] neg_lo:[0,0,1] neg_hi:[0,0,1]
    v_pk_fma_f32 v[142:143], v[4:5], v[150:151], v[142:143] op_sel_hi:[0,1,1] neg_lo:[0,0,1] neg_hi:[0,0,1]
    v_pk_fma_f32 v[144:145], v[4:5], v[152:153], v[144:145] op_sel_hi:[0,1,1] neg_lo:[0,0,1] neg_hi:[0,0,1]
    v_pk_fma_f32 v[146:147], v[4:5], v[154:155], v[146:147] op_sel_hi:[0,1,1] neg_lo:[0,0,1] neg_hi:[0,0,1]
    v_cvt_pk_bf16_f32 v52, v140, v141
    v_cvt_pk_bf16_f32 v53, v142, v143
    v_cvt_pk_bf16_f32 v54, v144, v145
    v_cvt_pk_bf16_f32 v55, v146, v147
    v_pk_fma_f32 v[148:149], v[4:5], v[140:141], v[148:149] op_sel_hi:[0,1,1] neg_lo:[0,0,1] neg_hi:[0,0,1]
    v_pk_fma_f32 v[150:151], v[4:5], v[142:143], v[150:151] op_sel_hi:[0,1,1] neg_lo:[0,0,1] neg_hi:[0,0,1]
    v_pk_fma_f32 v[152:153], v[4:5], v[144:145], v[152:153] op_sel_hi:[0,1,1] neg_lo:[0,0,1] neg_hi:[0,0,1]
    v_pk_fma_f32 v[154:155], v[4:5], v[146:147], v[154:155] op_sel_hi:[0,1,1] neg_lo:[0,0,1] neg_hi:[0,0,1]
    v_cvt_pk_bf16_f32 v56, v148, v149
    v_cvt_pk_bf16_f32 v57, v150, v151
    v_cvt_pk_bf16_f32 v58, v152, v153
    v_cvt_pk_bf16_f32 v59, v154, v155
    s_mov_b64 s[12:13], s[6:7]
    s_mov_b32 s14, 0x1e00000
    v_lshlrev_b32 v12, 21, v1
    buffer_load_dword v255, v12, s[12:15], 0 offen
    s_add_u32 s28, s6, 29360128
    s_addc_u32 s29, s7, 0
    s_mov_b32 s30, 131072
    s_mov_b32 s31, 0x20000
    s_lshl2_add_u32 s3, s2, s20
    s_cmp_lg_u32 s3, 991
    s_cbranch_scc1 P1_nb
    v_mov_b32 v8, 0
    v_lshlrev_b32 v12, 8, v1
    s_mov_b32 s3, 65536
    buffer_store_dword v8, v12, s[28:31], s3 offen sc1
    s_mov_b32 s3, 81920
    buffer_store_dword v8, v12, s[28:31], s3 offen sc1
P1_nb:
    s_lshl_b32 s22, s53, 1
    s_add_u32 s22, s22, s25
    s_lshl_b32 s22, s22, 3
    s_add_u32 s22, s22, 129
    s_movk_i32 s26, 192
    v_mfma_f32_16x16x32_bf16 v[240:243], v[236:239], v[20:23], 0
    v_add_u32 v19, s22, v253
    v_cmp_eq_u32 vcc, s26, v19
    v_mov_b32 v5, 0x140
    s_nop 0
    v_cndmask_b32 v19, v19, v5, vcc
    v_cvt_f32_u32 v5, v19
    v_mfma_f32_16x16x32_bf16 v[240:243], v[236:239], v[24:27], v[240:243]
    v_mul_f32 v2, 0x3acccccd, v5
    v_mul_f32 v5, 0x42000000, v2
    v_cos_f32 v4, v5
    v_fma_f32 v3, v252, v2, v17
    v_add_f32 v4, v4, v4
    v_mfma_f32_16x16x32_bf16 v[240:243], v[236:239], v[28:31], v[240:243]
    v_cos_f32 v140, v3
    v_fmamk_f32 v141, v2, 0x3f800000, v3
    v_cos_f32 v141, v141
    v_fmamk_f32 v142, v2, 0x40000000, v3
    v_cos_f32 v142, v142
    v_mfma_f32_16x16x32_bf16 v[240:243], v[236:239], v[32:35], v[240:243]
    v_fmamk_f32 v143, v2, 0x40400000, v3
    v_cos_f32 v143, v143
    v_fmamk_f32 v144, v2, 0x40800000, v3
    v_cos_f32 v144, v144
    v_fmamk_f32 v145, v2, 0x40a00000, v3
    v_mfma_f32_16x16x32_bf16 v[240:243], v[236:239], v[36:39], v[240:243]
    v_cos_f32 v145, v145
    v_fmamk_f32 v146, v2, 0x40c00000, v3
    v_cos_f32 v146, v146
    v_fmamk_f32 v147, v2, 0x40e00000, v3
    v_cos_f32 v147, v147
    v_mfma_f32_16x16x32_bf16 v[240:243], v[236:239], v[40:43], v[240:243]
    v_fmamk_f32 v148, v2, 0x42000000, v3
    v_cos_f32 v148, v148
    v_fmamk_f32 v149, v2, 0x42040000, v3
    v_cos_f32 v149, v149
    v_fmamk_f32 v150, v2, 0x42080000, v3
    v_mfma_f32_16x16x32_bf16 v[240:243], v[236:239], v[44:47], v[240:243]
    v_cos_f32 v150, v150
    v_fmamk_f32 v151, v2, 0x420c0000, v3
    v_cos_f32 v151, v151
    v_fmamk_f32 v152, v2, 0x42100000, v3
    v_cos_f32 v152, v152
    v_mfma_f32_16x16x32_bf16 v[240:243], v[236:239], v[48:51], v[240:243]
    v_fmamk_f32 v153, v2, 0x42140000, v3
    v_cos_f32 v153, v153
    v_fmamk_f32 v154, v2, 0x42180000, v3
    v_cos_f32 v154, v154
    v_fmamk_f32 v155, v2, 0x421c0000, v3
    v_mfma_f32_16x16x32_bf16 v[240:243], v[236:239], v[52:55], v[240:243]
    v_cos_f32 v155, v155
    v_mfma_f32_16x16x32_bf16 v[240:243], v[236:239], v[56:59], v[240:243]
    v_cvt_pk_bf16_f32 v100, v140, v141
    v_cvt_pk_bf16_f32 v101, v142, v143
    v_cvt_pk_bf16_f32 v102, v144, v145
    v_cvt_pk_bf16_f32 v103, v146, v147
    v_cvt_pk_bf16_f32 v104, v148, v149
    v_cvt_pk_bf16_f32 v105, v150, v151
    v_cvt_pk_bf16_f32 v106, v152, v153
    v_cvt_pk_bf16_f32 v107, v154, v155
    v_pk_fma_f32 v[140:141], v[4:5], v[148:149], v[140:141] op_sel_hi:[0,1,1] neg_lo:[0,0,1] neg_hi:[0,0,1]
    v_pk_fma_f32 v[142:143], v[4:5], v[150:151], v[142:143] op_sel_hi:[0,1,1] neg_lo:[0,0,1] neg_hi:[0,0,1]
    v_pk_fma_f32 v[144:145], v[4:5], v[152:153], v[144:145] op_sel_hi:[0,1,1] neg_lo:[0,0,1] neg_hi:[0,0,1]
    v_pk_fma_f32 v[146:147], v[4:5], v[154:155], v[146:147] op_sel_hi:[0,1,1] neg_lo:[0,0,1] neg_hi:[0,0,1]
    v_cvt_pk_bf16_f32 v108, v140, v141
    v_cvt_pk_bf16_f32 v109, v142, v143
    v_cvt_pk_bf16_f32 v110, v144, v145
    v_cvt_pk_bf16_f32 v111, v146, v147
    v_pk_fma_f32 v[148:149], v[4:5], v[140:141], v[148:149] op_sel_hi:[0,1,1] neg_lo:[0,0,1] neg_hi:[0,0,1]
    v_pk_fma_f32 v[150:151], v[4:5], v[142:143], v[150:151] op_sel_hi:[0,1,1] neg_lo:[0,0,1] neg_hi:[0,0,1]
    v_pk_fma_f32 v[152:153], v[4:5], v[144:145], v[152:153] op_sel_hi:[0,1,1] neg_lo:[0,0,1] neg_hi:[0,0,1]
    v_pk_fma_f32 v[154:155], v[4:5], v[146:147], v[154:155] op_sel_hi:[0,1,1] neg_lo:[0,0,1] neg_hi:[0,0,1]
    v_cvt_pk_bf16_f32 v112, v148, v149
    v_cvt_pk_bf16_f32 v113, v150, v151
    v_cvt_pk_bf16_f32 v114, v152, v153
    v_cvt_pk_bf16_f32 v115, v154, v155
    v_pk_fma_f32 v[140:141], v[4:5], v[148:149], v[140:141] op_sel_hi:[0,1,1] neg_lo:[0,0,1] neg_hi:[0,0,1]
    v_pk_fma_f32 v[142:143], v[4:5], v[150:151], v[142:143] op_sel_hi:[0,1,1] neg_lo:[0,0,1] neg_hi:[0,0,1]
    v_pk_fma_f32 v[144:145], v[4:5], v[152:153], v[144:145] op_sel_hi:[0,1,1] neg_lo:[0,0,1] neg_hi:[0,0,1]
    v_pk_fma_f32 v[146:147], v[4:5], v[154:155], v[146:147] op_sel_hi:[0,1,1] neg_lo:[0,0,1] neg_hi:[0,0,1]
    v_cvt_pk_bf16_f32 v116, v140, v141
    v_cvt_pk_bf16_f32 v117, v142, v143
    v_cvt_pk_bf16_f32 v118, v144, v145
    v_cvt_pk_bf16_f32 v119, v146, v147
    v_pk_fma_f32 v[148:149], v[4:5], v[140:141], v[148:149] op_sel_hi:[0,1,1] neg_lo:[0,0,1] neg_hi:[0,0,1]
    v_pk_fma_f32 v[150:151], v[4:5], v[142:143], v[150:151] op_sel_hi:[0,1,1] neg_lo:[0,0,1] neg_hi:[0,0,1]
    v_pk_fma_f32 v[152:153], v[4:5], v[144:145], v[152:153] op_sel_hi:[0,1,1] neg_lo:[0,0,1] neg_hi:[0,0,1]
    v_pk_fma_f32 v[154:155], v[4:5], v[146:147], v[154:155] op_sel_hi:[0,1,1] neg_lo:[0,0,1] neg_hi:[0,0,1]
    v_cvt_pk_bf16_f32 v120, v148, v149
    v_cvt_pk_bf16_f32 v121, v150, v151
    v_cvt_pk_bf16_f32 v122, v152, v153
    v_cvt_pk_bf16_f32 v123, v154, v155
    v_pk_fma_f32 v[140:141], v[4:5], v[148:149], v[140:141] op_sel_hi:[0,1,1] neg_lo:[0,0,1] neg_hi:[0,0,1]
    v_pk_fma_f32 v[142:143], v[4:5], v[150:151], v[142:143] op_sel_hi:[0,1,1] neg_lo:[0,0,1] neg_hi:[0,0,1]
    v_pk_fma_f32 v[144:145], v[4:5], v[152:153], v[144:145] op_sel_hi:[0,1,1] neg_lo:[0,0,1] neg_hi:[0,0,1]
    v_pk_fma_f32 v[146:147], v[4:5], v[154:155], v[146:147] op_sel_hi:[0,1,1] neg_lo:[0,0,1] neg_hi:[0,0,1]
    v_cvt_pk_bf16_f32 v124, v140, v141
    v_cvt_pk_bf16_f32 v125, v142, v143
    v_cvt_pk_bf16_f32 v126, v144, v145
    v_cvt_pk_bf16_f32 v127, v146, v147
    v_pk_fma_f32 v[148:149], v[4:5], v[140:141], v[148:149] op_sel_hi:[0,1,1] neg_lo:[0,0,1] neg_hi:[0,0,1]
    v_pk_fma_f32 v[150:151], v[4:5], v[142:143], v[150:151] op_sel_hi:[0,1,1] neg_lo:[0,0,1] neg_hi:[0,0,1]
    v_pk_fma_f32 v[152:153], v[4:5], v[144:145], v[152:153] op_sel_hi:[0,1,1] neg_lo:[0,0,1] neg_hi:[0,0,1]
    v_pk_fma_f32 v[154:155], v[4:5], v[146:147], v[154:155] op_sel_hi:[0,1,1] neg_lo:[0,0,1] neg_hi:[0,0,1]
    v_cvt_pk_bf16_f32 v128, v148, v149
    v_cvt_pk_bf16_f32 v129, v150, v151
    v_cvt_pk_bf16_f32 v130, v152, v153
    v_cvt_pk_bf16_f32 v131, v154, v155
    v_pk_fma_f32 v[140:141], v[4:5], v[148:149], v[140:141] op_sel_hi:[0,1,1] neg_lo:[0,0,1] neg_hi:[0,0,1]
    v_pk_fma_f32 v[142:143], v[4:5], v[150:151], v[142:143] op_sel_hi:[0,1,1] neg_lo:[0,0,1] neg_hi:[0,0,1]
    v_pk_fma_f32 v[144:145], v[4:5], v[152:153], v[144:145] op_sel_hi:[0,1,1] neg_lo:[0,0,1] neg_hi:[0,0,1]
    v_pk_fma_f32 v[146:147], v[4:5], v[154:155], v[146:147] op_sel_hi:[0,1,1] neg_lo:[0,0,1] neg_hi:[0,0,1]
    v_cvt_pk_bf16_f32 v132, v140, v141
    v_cvt_pk_bf16_f32 v133, v142, v143
    v_cvt_pk_bf16_f32 v134, v144, v145
    v_cvt_pk_bf16_f32 v135, v146, v147
    v_pk_fma_f32 v[148:149], v[4:5], v[140:141], v[148:149] op_sel_hi:[0,1,1] neg_lo:[0,0,1] neg_hi:[0,0,1]
    v_pk_fma_f32 v[150:151], v[4:5], v[142:143], v[150:151] op_sel_hi:[0,1,1] neg_lo:[0,0,1] neg_hi:[0,0,1]
    v_pk_fma_f32 v[152:153], v[4:5], v[144:145], v[152:153] op_sel_hi:[0,1,1] neg_lo:[0,0,1] neg_hi:[0,0,1]
    v_pk_fma_f32 v[154:155], v[4:5], v[146:147], v[154:155] op_sel_hi:[0,1,1] neg_lo:[0,0,1] neg_hi:[0,0,1]
    v_cvt_pk_bf16_f32 v136, v148, v149
    v_cvt_pk_bf16_f32 v137, v150, v151
    v_cvt_pk_bf16_f32 v138, v152, v153
    v_cvt_pk_bf16_f32 v139, v154, v155
    s_mov_b64 s[4:5], s[8:9]
    s_mov_b64 s[16:17], s[48:49]
    s_mov_b64 s[18:19], s[50:51]
    v_lshlrev_b32 v251, 4, v1
    s_mov_b32 s32, s44
    s_mov_b32 s33, s45
    s_mov_b32 s34, 2211840
    s_mov_b32 s35, 0x20000
    s_waitcnt lgkmcnt(0)
    v_lshrrev_b32 v172, s96, v1
    s_cmp_eq_u32 s99, 0
    v_bfe_u32 v173, v1, 0, s96
    s_cselect_b64 s[8:9], s[44:45], s[46:47]
    v_xor_b32 v181, s97, v172
    s_cmp_eq_u32 s96, 3
    v_mul_u32_u24 v181, s61, v181
    s_cselect_b64 s[12:13], s[38:39], s[8:9]
    v_mad_u32_u24 v181, v173, s98, v181
    s_cselect_b64 s[8:9], s[36:37], s[8:9]
    v_and_b32 v181, -4, v181
    s_mov_b32 s10, s42
    s_mov_b32 s14, s42
    buffer_load_dwordx4 v[140:143], v181, s[8:11], s56 offen
    v_mul_u32_u24 v180, s40, v172
    s_add_u32 s56, s56, s57
    buffer_load_dwordx4 v[156:159], v181, s[12:15], s56 offen
    v_mad_u32_u24 v180, v173, s41, v180
    s_add_u32 s56, s56, s58
    buffer_load_dwordx4 v[144:147], v181, s[8:11], s56 offen
    v_and_b32 v172, 1, v1
    s_add_u32 s56, s56, s57
    buffer_load_dwordx4 v[160:163], v181, s[12:15], s56 offen
    v_mul_u32_u24 v172, s99, v172
    s_add_u32 s56, s56, s59
    buffer_load_dwordx4 v[148:151], v181, s[8:11], s56 offen
    v_or_b32 v182, 0x03020100, v172
    s_add_u32 s56, s56, s57
    buffer_load_dwordx4 v[164:167], v181, s[12:15], s56 offen
    s_add_u32 s56, s56, s58
    buffer_load_dwordx4 v[152:155], v181, s[8:11], s56 offen
    s_add_u32 s56, s56, s57
    buffer_load_dwordx4 v[168:171], v181, s[12:15], s56 offen
    s_mov_b64 s[8:9], s[6:7]
    s_mov_b32 s10, s43
    s_cmp_lg_u32 s20, 3
    s_cbranch_scc1 P1_ns
    s_getreg_b32 s3, hwreg(HW_REG_XCC_ID, 0, 4)
    s_add_u32 s3, s3, 1
    v_mov_b32 v8, s3
    s_and_b32 s3, s2, 7
    s_lshl_b32 s3, s3, 8
    s_and_b32 s24, s2, 0x80
    s_add_u32 s3, s3, s24
    s_bfe_u32 s22, s2, 0x40003
    s_add_u32 s3, s3, s22
    s_add_u32 s3, s3, 98304
    v_mov_b32 v9, 0
    s_mov_b64 exec, 1
    buffer_store_byte v8, v9, s[28:31], s3 offen sc1
    s_mov_b64 exec, -1
    s_cmp_le_u32 s2, 247
    s_cbranch_scc1 P1_ns
    v_mov_b32 v8, 0
    v_mov_b32 v10, 0
    v_mov_b32 v11, 0
    s_sub_u32 s3, 255, s2
    v_lshlrev_b32 v12, 7, v1
    s_lshl_b32 s3, s3, 13
    buffer_store_dwordx4 v[8:11], v12, s[28:31], s3 offen sc1
P1_ns:
    s_lshl_b32 s48, s27, 3
    s_lshl_b32 s3, s25, 12
    s_add_u32 s3, s3, 114688
    v_mfma_f32_16x16x32_bf16 v[184:187], v[236:239], v[100:103], 0
    s_bfe_u32 s22, s2, 0x40003
    v_lshlrev_b32 v176, 4, v6
    s_lshl_b32 s24, s20, 7
    v_bfrev_b32 v177, 1
    v_mfma_f32_16x16x32_bf16 v[244:247], v[228:231], v[20:23], 0
    s_add_u32 s24, s24, 104960
    v_lshrrev_b32 v176, v176, v177
    s_lshl_b32 s49, s25, 8
    v_lshlrev_b32 v177, 31, v6
    v_mfma_f32_16x16x32_bf16 v[184:187], v[236:239], v[104:107], v[184:187]
    s_add_u32 s49, s49, 104960
    v_lshl_add_u32 v5, v15, 8, s3
    s_mul_i32 s26, s20, 2304
    v_xor_b32 v253, v14, v15
    v_mfma_f32_16x16x32_bf16 v[244:247], v[228:231], v[24:27], v[244:247]
    s_add_u32 s26, s26, 105472
    v_xor_b32 v253, s48, v253
    s_xor_b32 s23, s20, 1
    v_xor_b32 v252, 0, v253
    v_mfma_f32_16x16x32_bf16 v[184:187], v[236:239], v[108:111], v[184:187]
    s_mulk_i32 s23, 2304
    v_lshl_add_u32 v6, v252, 4, v5
    s_add_u32 s23, s23, 105472
    v_xor_b32 v10, 0x1000, v6
    v_mfma_f32_16x16x32_bf16 v[244:247], v[228:231], v[28:31], v[244:247]
    s_mov_b32 s36, 0x22222222
    v_xor_b32 v252, 4, v253
    s_mov_b32 s37, s36
    v_lshl_add_u32 v7, v252, 4, v5
    v_mfma_f32_16x16x32_bf16 v[184:187], v[236:239], v[112:115], v[184:187]
    s_mov_b32 s38, 0x44444444
    v_xor_b32 v11, 0x1000, v7
    s_mov_b32 s39, s38
    v_xor_b32 v252, 8, v253
    v_mfma_f32_16x16x32_bf16 v[244:247], v[228:231], v[32:35], v[244:247]
    s_mov_b32 s44, 0x88888888
    v_lshl_add_u32 v8, v252, 4, v5
    s_mov_b32 s45, s44
    v_xor_b32 v12, 0x1000, v8
    v_mfma_f32_16x16x32_bf16 v[184:187], v[236:239], v[116:119], v[184:187]
    s_mov_b32 s42, 0x00f0000f
    v_xor_b32 v252, 12, v253
    s_mov_b32 s43, 0xf0000f00
    v_lshl_add_u32 v9, v252, 4, v5
    v_mfma_f32_16x16x32_bf16 v[244:247], v[228:231], v[36:39], v[244:247]
    s_lshl_b32 s27, s52, 7
    v_xor_b32 v13, 0x1000, v9
    s_sub_u32 s27, s27, 8192
    v_mfma_f32_16x16x32_bf16 v[184:187], v[236:239], v[120:123], v[184:187]
    s_mov_b32 s46, 0x05040100
    s_mov_b32 s47, 0x07060302
    v_mfma_f32_16x16x32_bf16 v[244:247], v[228:231], v[40:43], v[244:247]
    s_mov_b32 s12, s6
    s_mov_b32 s13, s7
    v_mfma_f32_16x16x32_bf16 v[184:187], v[236:239], v[124:127], v[184:187]
    s_mov_b32 s14, 0x1000000
    s_mov_b32 s15, 0x20000
    v_mfma_f32_16x16x32_bf16 v[244:247], v[228:231], v[44:47], v[244:247]
    s_mul_i32 s57, s20, 20480
    s_mul_i32 s54, s25, -6912
    v_mfma_f32_16x16x32_bf16 v[184:187], v[236:239], v[128:131], v[184:187]
    s_add_u32 s54, s54, 3456
    s_mul_i32 s55, s25, 1299456
    v_mfma_f32_16x16x32_bf16 v[244:247], v[228:231], v[48:51], v[244:247]
    s_mul_i32 s40, s25, 908928
    s_mul_i32 s41, s48, 10
    v_mfma_f32_16x16x32_bf16 v[184:187], v[236:239], v[132:135], v[184:187]
    s_mul_i32 s41, s41, s54
    s_add_u32 s40, s40, s41
    v_mfma_f32_16x16x32_bf16 v[244:247], v[228:231], v[52:55], v[244:247]
    s_min_u32 s41, s22, 14
    s_lshl_b32 s41, s41, 7
    v_mfma_f32_16x16x32_bf16 v[184:187], v[236:239], v[136:139], v[184:187]
    s_add_u32 s40, s40, s41
    v_mfma_f32_16x16x32_bf16 v[244:247], v[228:231], v[56:59], v[244:247]
    s_cmp_eq_u32 s20, 3
    s_cbranch_scc1 P1_w3
    s_waitcnt vmcnt(8)
    s_branch P1_wx
P1_w3:
    s_waitcnt vmcnt(10)
    s_cmp_gt_u32 s2, 247
    s_cbranch_scc1 P1_wx
    s_waitcnt vmcnt(9)
    s_cmp_lg_u32 s2, 247
    s_cbranch_scc1 P1_wx
    s_mov_b64 s[8:9], s[18:19]
    s_mov_b32 s10, 4
    buffer_store_dword v236, v251, s[8:11], 0 offen sc1
    s_mov_b32 s10, 0
P1_wx:
    s_barrier
    ds_read_b128 a[0:3], v6 offset:0
    ds_read_b128 a[4:7], v10 offset:0
    ds_read_b128 a[8:11], v7 offset:0
    ds_read_b128 a[12:15], v11 offset:0
    ds_read_b128 a[16:19], v6 offset:8192
    ds_read_b128 a[20:23], v10 offset:8192
    s_waitcnt lgkmcnt(5)
    v_mfma_f32_16x16x32_bf16 v[220:223], a[0:3], v[100:103], 0
    ds_read_b128 a[24:27], v7 offset:8192
    v_xor_b32 v60, v176, v20
    v_mfma_f32_16x16x32_bf16 v[228:231], v[236:239], a[0:3], 0
    v_xor_b32 v61, v176, v21
    v_xor_b32 v62, v176, v22
    v_mfma_f32_16x16x32_bf16 v[232:235], a[0:3], a[0:3], 0
    s_waitcnt lgkmcnt(5)
    ds_read_b128 a[28:31], v11 offset:8192
    v_xor_b32 v63, v176, v23
    v_mfma_f32_16x16x32_bf16 v[224:227], a[4:7], v[100:103], 0
    s_waitcnt lgkmcnt(5)
    v_xor_b32 v64, v176, v24
    v_xor_b32 v65, v176, v25
    v_mfma_f32_16x16x32_bf16 v[220:223], a[8:11], v[104:107], v[220:223]
    ds_read_b128 a[32:35], v6 offset:16384
    v_xor_b32 v66, v176, v26
    v_mfma_f32_16x16x32_bf16 v[228:231], v[236:239], a[8:11], v[228:231]
    v_xor_b32 v67, v176, v27
    v_lshl_add_u32 v2, v15, 2, s24
    v_mfma_f32_16x16x32_bf16 v[232:235], a[8:11], a[8:11], v[232:235]
    s_waitcnt lgkmcnt(5)
    ds_read_b128 a[36:39], v10 offset:16384
    v_lshl_add_u32 v3, v14, 4, s49
    v_mfma_f32_16x16x32_bf16 v[224:227], a[12:15], v[104:107], v[224:227]
    s_waitcnt lgkmcnt(5)
    v_xor_b32 v4, 0x100, v3
    v_add_u32 v5, s26, v251
    v_mfma_f32_16x16x32_bf16 v[220:223], a[16:19], v[108:111], v[220:223]
    ds_read_b128 a[40:43], v7 offset:16384
    v_add_u32 v252, s23, v251
    v_mfma_f32_16x16x32_bf16 v[228:231], v[236:239], a[16:19], v[228:231]
    v_lshl_add_u32 v253, v1, 2, s26
    v_lshl_add_u32 v255, v1, 2, s23
    v_mfma_f32_16x16x32_bf16 v[232:235], a[16:19], a[16:19], v[232:235]
    s_waitcnt lgkmcnt(5)
    ds_read_b128 a[44:47], v11 offset:16384
    ds_write_b32 v253, v184 offset:2048
    v_mfma_f32_16x16x32_bf16 v[224:227], a[20:23], v[108:111], v[224:227]
    s_waitcnt lgkmcnt(6)
    v_fma_f32 v240, v240, v16, v240
    v_fma_f32 v244, v244, v16, v244
    v_mfma_f32_16x16x32_bf16 v[220:223], a[24:27], v[112:115], v[220:223]
    ds_read_b128 a[48:51], v6 offset:24576
    v_xor_b32 v244, v177, v244
    v_mfma_f32_16x16x32_bf16 v[228:231], v[236:239], a[24:27], v[228:231]
    v_lshrrev_b32 v172, 5, v1
    v_bfe_u32 v173, v1, 3, 2
    v_mfma_f32_16x16x32_bf16 v[232:235], a[24:27], a[24:27], v[232:235]
    s_waitcnt lgkmcnt(6)
    ds_read_b128 a[52:55], v10 offset:24576
    v_mad_u32_u24 v172, v172, 20, v173
    v_mfma_f32_16x16x32_bf16 v[224:227], a[28:31], v[112:115], v[224:227]
    s_waitcnt lgkmcnt(6)
    v_mul_lo_u32 v172, v172, s54
    v_lshlrev_b32 v173, 1, v14
    v_mfma_f32_16x16x32_bf16 v[220:223], a[32:35], v[116:119], v[220:223]
    ds_read_b128 a[56:59], v7 offset:24576
    v_and_b32 v174, 7, v1
    v_mfma_f32_16x16x32_bf16 v[228:231], v[236:239], a[32:35], v[228:231]
    v_xor_b32 v173, v173, v174
    v_lshlrev_b32 v173, 4, v173
    v_mfma_f32_16x16x32_bf16 v[232:235], a[32:35], a[32:35], v[232:235]
    s_waitcnt lgkmcnt(6)
    ds_read_b128 a[60:63], v11 offset:24576
    v_add3_u32 v248, v172, v173, s40
    v_mfma_f32_16x16x32_bf16 v[224:227], a[36:39], v[116:119], v[224:227]
    s_waitcnt lgkmcnt(6)
    v_xor_b32 v68, v176, v28
    v_xor_b32 v69, v176, v29
    v_mfma_f32_16x16x32_bf16 v[220:223], a[40:43], v[120:123], v[220:223]
    ds_read_b128 a[64:67], v6 offset:32768
    v_xor_b32 v70, v176, v30
    v_mfma_f32_16x16x32_bf16 v[228:231], v[236:239], a[40:43], v[228:231]
    v_xor_b32 v71, v176, v31
    v_xor_b32 v72, v176, v32
    v_mfma_f32_16x16x32_bf16 v[232:235], a[40:43], a[40:43], v[232:235]
    s_waitcnt lgkmcnt(6)
    ds_read_b128 a[68:71], v10 offset:32768
    v_xor_b32 v73, v176, v33
    v_mfma_f32_16x16x32_bf16 v[224:227], a[44:47], v[120:123], v[224:227]
    s_waitcnt lgkmcnt(5)
    v_xor_b32 v74, v176, v34
    v_xor_b32 v75, v176, v35
    v_mfma_f32_16x16x32_bf16 v[220:223], a[48:51], v[124:127], v[220:223]
    ds_read_b128 a[72:75], v7 offset:32768
    v_xor_b32 v76, v176, v36
    v_mfma_f32_16x16x32_bf16 v[228:231], v[236:239], a[48:51], v[228:231]
    v_xor_b32 v77, v176, v37
    v_xor_b32 v78, v176, v38
    v_mfma_f32_16x16x32_bf16 v[232:235], a[48:51], a[48:51], v[232:235]
    s_waitcnt lgkmcnt(5)
    ds_read_b128 a[76:79], v11 offset:32768
    v_xor_b32 v79, v176, v39
    v_mfma_f32_16x16x32_bf16 v[224:227], a[52:55], v[124:127], v[224:227]
    s_waitcnt lgkmcnt(5)
    v_xor_b32 v80, v176, v40
    v_xor_b32 v81, v176, v41
    v_mfma_f32_16x16x32_bf16 v[220:223], a[56:59], v[128:131], v[220:223]
    ds_read_b128 a[80:83], v8 offset:0
    v_xor_b32 v82, v176, v42
    v_mfma_f32_16x16x32_bf16 v[228:231], v[236:239], a[56:59], v[228:231]
    v_xor_b32 v83, v176, v43
    v_xor_b32 v84, v176, v44
    v_mfma_f32_16x16x32_bf16 v[232:235], a[56:59], a[56:59], v[232:235]
    s_waitcnt lgkmcnt(5)
    ds_read_b128 a[84:87], v12 offset:0
    v_xor_b32 v85, v176, v45
    v_mfma_f32_16x16x32_bf16 v[224:227], a[60:63], v[128:131], v[224:227]
    s_waitcnt lgkmcnt(5)
    v_xor_b32 v86, v176, v46
    v_xor_b32 v87, v176, v47
    v_mfma_f32_16x16x32_bf16 v[220:223], a[64:67], v[132:135], v[220:223]
    ds_read_b128 a[88:91], v9 offset:0
    v_xor_b32 v88, v176, v48
    v_mfma_f32_16x16x32_bf16 v[228:231], v[236:239], a[64:67], v[228:231]
    v_xor_b32 v89, v176, v49
    v_xor_b32 v90, v176, v50
    v_mfma_f32_16x16x32_bf16 v[232:235], a[64:67], a[64:67], v[232:235]
    s_waitcnt lgkmcnt(5)
    ds_read_b128 a[92:95], v13 offset:0
    v_xor_b32 v91, v176, v51
    v_mfma_f32_16x16x32_bf16 v[224:227], a[68:71], v[132:135], v[224:227]
    s_waitcnt lgkmcnt(5)
    v_xor_b32 v92, v176, v52
    v_xor_b32 v93, v176, v53
    v_mfma_f32_16x16x32_bf16 v[220:223], a[72:75], v[136:139], v[220:223]
    ds_read_b128 a[96:99], v8 offset:8192
    v_xor_b32 v94, v176, v54
    v_mfma_f32_16x16x32_bf16 v[228:231], v[236:239], a[72:75], v[228:231]
    v_xor_b32 v95, v176, v55
    v_xor_b32 v96, v176, v56
    v_mfma_f32_16x16x32_bf16 v[232:235], a[72:75], a[72:75], v[232:235]
    s_waitcnt lgkmcnt(5)
    ds_read_b128 a[100:103], v12 offset:8192
    v_xor_b32 v97, v176, v57
    v_mfma_f32_16x16x32_bf16 v[224:227], a[76:79], v[136:139], v[224:227]
    v_xor_b32 v98, v176, v58
    v_xor_b32 v99, v176, v59
    v_mfma_f32_16x16x32_bf16 v[188:191], a[0:3], v[20:23], 0
    ds_read_b128 a[104:107], v9 offset:8192
    v_mfma_f32_16x16x32_bf16 v[204:207], a[0:3], v[60:63], 0
    ds_write_b128 v5, v[220:223]
    v_cndmask_b32 v232, v232, v233, s[36:37]
    v_mfma_f32_16x16x32_bf16 v[192:195], a[4:7], v[20:23], 0
    ds_write_b128 v5, v[224:227] offset:1024
    v_cndmask_b32 v232, v232, v234, s[38:39]
    v_mfma_f32_16x16x32_bf16 v[208:211], a[4:7], v[60:63], 0
    v_cndmask_b32 v232, v232, v235, s[44:45]
    v_mov_b32 v233, 0x36a7c5ac
    v_mfma_f32_16x16x32_bf16 v[188:191], a[8:11], v[24:27], v[188:191]
    v_mul_f32 v228, 0xbacccccd, v228
    v_fmac_f32 v233, 0x3acccccd, v232
    v_mfma_f32_16x16x32_bf16 v[204:207], a[8:11], v[64:67], v[204:207]
    s_mov_b64 exec, s[42:43]
    ds_write2_b32 v2, v228, v233 offset1:16
    s_mov_b64 exec, -1
    v_mfma_f32_16x16x32_bf16 v[192:195], a[12:15], v[24:27], v[192:195]
    v_and_b32 v229, 1, v15
    v_lshl_add_u32 v229, v229, 5, s27
    v_mfma_f32_16x16x32_bf16 v[208:211], a[12:15], v[64:67], v[208:211]
    v_and_b32 v230, 1, v14
    v_lshl_add_u32 v229, v230, 6, v229
    v_mfma_f32_16x16x32_bf16 v[188:191], a[16:19], v[28:31], v[188:191]
    v_lshrrev_b32 v231, 1, v14
    v_lshl_add_u32 v229, v231, 4, v229
    v_mfma_f32_16x16x32_bf16 v[204:207], a[16:19], v[68:71], v[204:207]
    v_lshlrev_b32 v231, 6, v231
    v_lshl_add_u32 v231, v230, 4, v231
    v_mfma_f32_16x16x32_bf16 v[192:195], a[20:23], v[28:31], v[192:195]
    v_lshl_add_u32 v230, v19, 13, v229
    v_sub_u32 v234, 0x140, v18
    v_mfma_f32_16x16x32_bf16 v[208:211], a[20:23], v[68:71], v[208:211]
    v_lshl_add_u32 v234, v234, 13, v229
    v_lshl_add_u32 v229, v18, 13, v229
    v_mfma_f32_16x16x32_bf16 v[188:191], a[24:27], v[32:35], v[188:191]
    v_mfma_f32_16x16x32_bf16 v[204:207], a[24:27], v[72:75], v[204:207]
    s_waitcnt lgkmcnt(0)
    s_barrier
    v_mfma_f32_16x16x32_bf16 v[192:195], a[28:31], v[32:35], v[192:195]
    ds_read_b128 v[100:103], v3 offset:0
    ds_read_b128 v[104:107], v3 offset:64
    v_mfma_f32_16x16x32_bf16 v[208:211], a[28:31], v[72:75], v[208:211]
    ds_read_b128 v[108:111], v3 offset:128
    ds_read_b128 v[112:115], v3 offset:192
    v_mfma_f32_16x16x32_bf16 v[188:191], a[32:35], v[36:39], v[188:191]
    ds_read_b128 v[116:119], v4 offset:0
    ds_read_b128 v[120:123], v4 offset:64
    v_mfma_f32_16x16x32_bf16 v[204:207], a[32:35], v[76:79], v[204:207]
    ds_read_b128 v[124:127], v4 offset:128
    ds_read_b128 v[128:131], v4 offset:192
    v_mfma_f32_16x16x32_bf16 v[192:195], a[36:39], v[36:39], v[192:195]
    ds_read_b128 v[132:135], v252 offset:0
    ds_read_b128 v[136:139], v252 offset:1024
    v_mfma_f32_16x16x32_bf16 v[208:211], a[36:39], v[76:79], v[208:211]
    ds_read_b32 v185, v255 offset:2048
    v_mfma_f32_16x16x32_bf16 v[188:191], a[40:43], v[40:43], v[188:191]
    ds_read_b128 a[108:111], v13 offset:8192
    v_mfma_f32_16x16x32_bf16 v[204:207], a[40:43], v[80:83], v[204:207]
    ds_read_b128 a[112:115], v8 offset:16384
    v_mfma_f32_16x16x32_bf16 v[192:195], a[44:47], v[40:43], v[192:195]
    ds_read_b128 a[116:119], v12 offset:16384
    v_mfma_f32_16x16x32_bf16 v[208:211], a[44:47], v[80:83], v[208:211]
    s_waitcnt lgkmcnt(11)
    ds_read_b128 a[120:123], v9 offset:16384
    v_add_f32 v100, v100, v108
    v_mfma_f32_16x16x32_bf16 v[188:191], a[48:51], v[44:47], v[188:191]
    ds_read_b128 a[124:127], v13 offset:16384
    v_add_f32 v101, v101, v109
    v_mfma_f32_16x16x32_bf16 v[204:207], a[48:51], v[84:87], v[204:207]
    ds_read_b128 a[128:131], v8 offset:24576
    v_add_f32 v102, v102, v110
    v_mfma_f32_16x16x32_bf16 v[192:195], a[52:55], v[44:47], v[192:195]
    ds_read_b128 a[132:135], v12 offset:24576
    v_add_f32 v103, v103, v111
    v_mfma_f32_16x16x32_bf16 v[208:211], a[52:55], v[84:87], v[208:211]
    s_waitcnt lgkmcnt(14)
    ds_read_b128 a[136:139], v9 offset:24576
    v_add_f32 v104, v104, v112
    v_mfma_f32_16x16x32_bf16 v[188:191], a[56:59], v[48:51], v[188:191]
    ds_read_b128 a[140:143], v13 offset:24576
    v_add_f32 v105, v105, v113
    v_mfma_f32_16x16x32_bf16 v[204:207], a[56:59], v[88:91], v[204:207]
    ds_read_b128 a[144:147], v8 offset:32768
    v_add_f32 v106, v106, v114
    v_mfma_f32_16x16x32_bf16 v[192:195], a[60:63], v[48:51], v[192:195]
    ds_read_b128 a[148:151], v12 offset:32768
    v_add_f32 v107, v107, v115
    v_mfma_f32_16x16x32_bf16 v[208:211], a[60:63], v[88:91], v[208:211]
    ds_read_b128 a[152:155], v9 offset:32768
    v_fma_f32 v104, -v100, v100, v104
    v_mfma_f32_16x16x32_bf16 v[188:191], a[64:67], v[52:55], v[188:191]
    ds_read_b128 a[156:159], v13 offset:32768
    v_fma_f32 v105, -v101, v101, v105
    v_mfma_f32_16x16x32_bf16 v[204:207], a[64:67], v[92:95], v[204:207]
    v_fma_f32 v106, -v102, v102, v106
    v_fma_f32 v107, -v103, v103, v107
    v_mfma_f32_16x16x32_bf16 v[192:195], a[68:71], v[52:55], v[192:195]
    v_max_f32 v104, 0x3727c5ac, v104
    v_max_f32 v105, 0x3727c5ac, v105
    v_mfma_f32_16x16x32_bf16 v[208:211], a[68:71], v[92:95], v[208:211]
    v_max_f32 v106, 0x3727c5ac, v106
    v_max_f32 v107, 0x3727c5ac, v107
    v_mfma_f32_16x16x32_bf16 v[188:191], a[72:75], v[56:59], v[188:191]
    v_rsq_f32 v104, v104
    v_mfma_f32_16x16x32_bf16 v[204:207], a[72:75], v[96:99], v[204:207]
    v_rsq_f32 v105, v105
    v_mfma_f32_16x16x32_bf16 v[192:195], a[76:79], v[56:59], v[192:195]
    v_rsq_f32 v106, v106
    v_mfma_f32_16x16x32_bf16 v[208:211], a[76:79], v[96:99], v[208:211]
    v_rsq_f32 v107, v107
    v_mfma_f32_16x16x32_bf16 v[196:199], a[80:83], v[20:23], 0
    s_waitcnt lgkmcnt(15)
    v_add_f32 v116, v116, v124
    v_add_f32 v117, v117, v125
    v_mfma_f32_16x16x32_bf16 v[212:215], a[80:83], v[60:63], 0
    v_add_f32 v118, v118, v126
    v_add_f32 v119, v119, v127
    v_mfma_f32_16x16x32_bf16 v[200:203], a[84:87], v[20:23], 0
    v_add_f32 v120, v120, v128
    v_add_f32 v121, v121, v129
    v_mfma_f32_16x16x32_bf16 v[216:219], a[84:87], v[60:63], 0
    v_add_f32 v122, v122, v130
    v_add_f32 v123, v123, v131
    v_mfma_f32_16x16x32_bf16 v[196:199], a[88:91], v[24:27], v[196:199]
    v_fma_f32 v120, -v116, v116, v120
    v_fma_f32 v121, -v117, v117, v121
    v_mfma_f32_16x16x32_bf16 v[212:215], a[88:91], v[64:67], v[212:215]
    v_fma_f32 v122, -v118, v118, v122
    v_fma_f32 v123, -v119, v119, v123
    v_mfma_f32_16x16x32_bf16 v[200:203], a[92:95], v[24:27], v[200:203]
    v_max_f32 v120, 0x3727c5ac, v120
    v_max_f32 v121, 0x3727c5ac, v121
    v_mfma_f32_16x16x32_bf16 v[216:219], a[92:95], v[64:67], v[216:219]
    v_max_f32 v122, 0x3727c5ac, v122
    v_max_f32 v123, 0x3727c5ac, v123
    v_mfma_f32_16x16x32_bf16 v[196:199], a[96:99], v[28:31], v[196:199]
    v_rsq_f32 v120, v120
    v_mfma_f32_16x16x32_bf16 v[212:215], a[96:99], v[68:71], v[212:215]
    v_rsq_f32 v121, v121
    v_mfma_f32_16x16x32_bf16 v[200:203], a[100:103], v[28:31], v[200:203]
    v_rsq_f32 v122, v122
    v_mfma_f32_16x16x32_bf16 v[216:219], a[100:103], v[68:71], v[216:219]
    v_rsq_f32 v123, v123
    v_mfma_f32_16x16x32_bf16 v[196:199], a[104:107], v[32:35], v[196:199]
    v_add_f32 v220, v220, v132
    v_add_f32 v221, v221, v133
    v_mfma_f32_16x16x32_bf16 v[212:215], a[104:107], v[72:75], v[212:215]
    s_waitcnt lgkmcnt(12)
    v_add_f32 v222, v222, v134
    v_add_f32 v223, v223, v135
    v_mfma_f32_16x16x32_bf16 v[200:203], a[108:111], v[32:35], v[200:203]
    v_add_f32 v224, v224, v136
    v_add_f32 v225, v225, v137
    v_mfma_f32_16x16x32_bf16 v[216:219], a[108:111], v[72:75], v[216:219]
    s_waitcnt lgkmcnt(11)
    v_add_f32 v226, v226, v138
    v_add_f32 v227, v227, v139
    v_mfma_f32_16x16x32_bf16 v[196:199], a[112:115], v[36:39], v[196:199]
    v_add_f32 v184, v184, v185
    v_mfma_f32_16x16x32_bf16 v[212:215], a[112:115], v[76:79], v[212:215]
    s_waitcnt lgkmcnt(10)
    v_mfma_f32_16x16x32_bf16 v[200:203], a[116:119], v[36:39], v[200:203]
    v_mfma_f32_16x16x32_bf16 v[216:219], a[116:119], v[76:79], v[216:219]
    s_waitcnt lgkmcnt(9)
    v_mfma_f32_16x16x32_bf16 v[196:199], a[120:123], v[40:43], v[196:199]
    s_waitcnt vmcnt(0)
    v_perm_b32 v140, v142, v140, v182
    v_perm_b32 v144, v146, v144, v182
    v_mfma_f32_16x16x32_bf16 v[212:215], a[120:123], v[80:83], v[212:215]
    s_waitcnt lgkmcnt(8)
    v_perm_b32 v148, v150, v148, v182
    v_perm_b32 v152, v154, v152, v182
    v_mfma_f32_16x16x32_bf16 v[200:203], a[124:127], v[40:43], v[200:203]
    v_perm_b32 v156, v158, v156, v182
    v_perm_b32 v160, v162, v160, v182
    v_mfma_f32_16x16x32_bf16 v[216:219], a[124:127], v[80:83], v[216:219]
    s_waitcnt lgkmcnt(7)
    v_perm_b32 v164, v166, v164, v182
    v_perm_b32 v168, v170, v168, v182
    v_mfma_f32_16x16x32_bf16 v[196:199], a[128:131], v[44:47], v[196:199]
    v_perm_b32 v172, v156, v140, s46
    v_perm_b32 v173, v160, v144, s46
    v_mfma_f32_16x16x32_bf16 v[212:215], a[128:131], v[84:87], v[212:215]
    s_waitcnt lgkmcnt(6)
    v_perm_b32 v174, v164, v148, s46
    v_perm_b32 v175, v168, v152, s46
    v_mfma_f32_16x16x32_bf16 v[200:203], a[132:135], v[44:47], v[200:203]
    buffer_store_dwordx4 v[172:175], v180, s[8:11], s60 offen sc1
    v_perm_b32 v176, v156, v140, s47
    v_mfma_f32_16x16x32_bf16 v[216:219], a[132:135], v[84:87], v[216:219]
    s_waitcnt lgkmcnt(5)
    v_perm_b32 v177, v160, v144, s47
    v_perm_b32 v178, v164, v148, s47
    v_mfma_f32_16x16x32_bf16 v[196:199], a[136:139], v[48:51], v[196:199]
    s_add_u32 s60, s60, s63
    v_perm_b32 v179, v168, v152, s47
    buffer_store_dwordx4 v[176:179], v180, s[8:11], s60 offen sc1
    v_mfma_f32_16x16x32_bf16 v[212:215], a[136:139], v[88:91], v[212:215]
    s_waitcnt lgkmcnt(4)
    v_perm_b32 v172, v157, v141, s46
    v_perm_b32 v173, v161, v145, s46
    v_mfma_f32_16x16x32_bf16 v[200:203], a[140:143], v[48:51], v[200:203]
    s_lshl2_add_u32 s21, s2, s20
    s_mulk_i32 s21, 3456
    v_lshlrev_b32 v183, 7, v1
    s_mov_b64 exec, 0x7fff
    buffer_load_dword v254, v183, s[32:35], s21 offen
    s_mov_b64 exec, -1
    v_perm_b32 v174, v165, v149, s46
    v_perm_b32 v175, v169, v153, s46
    v_mfma_f32_16x16x32_bf16 v[216:219], a[140:143], v[88:91], v[216:219]
    s_add_u32 s60, s60, s63
    buffer_store_dwordx4 v[172:175], v180, s[8:11], s60 offen sc1
    v_perm_b32 v176, v157, v141, s47
    s_waitcnt lgkmcnt(3)
    v_mfma_f32_16x16x32_bf16 v[196:199], a[144:147], v[52:55], v[196:199]
    v_perm_b32 v177, v161, v145, s47
    v_perm_b32 v178, v165, v149, s47
    v_mfma_f32_16x16x32_bf16 v[212:215], a[144:147], v[92:95], v[212:215]
    s_add_u32 s60, s60, s63
    v_perm_b32 v179, v169, v153, s47
    buffer_store_dwordx4 v[176:179], v180, s[8:11], s60 offen sc1
    s_waitcnt lgkmcnt(2)
    v_mfma_f32_16x16x32_bf16 v[200:203], a[148:151], v[52:55], v[200:203]
    v_perm_b32 v172, v158, v142, s46
    v_perm_b32 v173, v162, v146, s46
    v_mfma_f32_16x16x32_bf16 v[216:219], a[148:151], v[92:95], v[216:219]
    s_waitcnt lgkmcnt(1)
    v_perm_b32 v174, v166, v150, s46
    v_perm_b32 v175, v170, v154, s46
    v_mfma_f32_16x16x32_bf16 v[196:199], a[152:155], v[56:59], v[196:199]
    s_add_u32 s60, s60, s63
    buffer_store_dwordx4 v[172:175], v180, s[8:11], s60 offen sc1
    v_perm_b32 v176, v158, v142, s47
    v_mfma_f32_16x16x32_bf16 v[212:215], a[152:155], v[96:99], v[212:215]
    s_waitcnt lgkmcnt(0)
    v_perm_b32 v177, v162, v146, s47
    v_perm_b32 v178, v166, v150, s47
    v_mfma_f32_16x16x32_bf16 v[200:203], a[156:159], v[56:59], v[200:203]
    s_add_u32 s60, s60, s63
    v_perm_b32 v179, v170, v154, s47
    s_mov_b32 s10, s62
    buffer_store_dwordx4 v[176:179], v180, s[8:11], s60 offen sc1
    v_mfma_f32_16x16x32_bf16 v[216:219], a[156:159], v[96:99], v[216:219]
    s_mul_i32 s24, s25, 0x80008000
    v_perm_b32 v172, v159, v143, s46
    v_perm_b32 v173, v163, v147, s46
    v_pk_fma_f32 v[220:221], v[100:101], v[184:185], v[220:221] op_sel_hi:[1,0,1]
    v_pk_fma_f32 v[224:225], v[116:117], v[184:185], v[224:225] op_sel_hi:[1,0,1]
    v_pk_fma_f32 v[222:223], v[102:103], v[184:185], v[222:223] op_sel_hi:[1,0,1]
    v_pk_fma_f32 v[226:227], v[118:119], v[184:185], v[226:227] op_sel_hi:[1,0,1]
    v_pk_mul_f32 v[220:221], v[220:221], v[104:105]
    v_pk_mul_f32 v[222:223], v[222:223], v[106:107]
    v_pk_fma_f32 v[24:25], v[120:121], v[224:225], v[220:221]
    v_pk_fma_f32 v[224:225], v[120:121], v[224:225], v[220:221] neg_lo:[1,0,0] neg_hi:[1,0,0]
    v_pk_fma_f32 v[26:27], v[122:123], v[226:227], v[222:223]
    v_pk_fma_f32 v[226:227], v[122:123], v[226:227], v[222:223] neg_lo:[1,0,0] neg_hi:[1,0,0]
    v_cvt_pk_bf16_f32 v22, v224, v225
    v_cvt_pk_bf16_f32 v23, v226, v227
    v_cvt_pk_bf16_f32 v20, v24, v25
    v_cvt_pk_bf16_f32 v21, v26, v27
    v_xor_b32 v22, s24, v22
    v_xor_b32 v23, s24, v23
    s_nop 0
    v_permlane16_swap_b32 v20, v22
    v_permlane16_swap_b32 v21, v23
    s_lshl_b32 exec_lo, 0x00ff00ff, s48
    s_mov_b32 exec_hi, exec_lo
    buffer_store_dwordx4 v[20:23], v230, s[12:15], 0 offen sc1
    s_mov_b64 exec, -1
    s_nop 0
    v_pk_fma_f32 v[188:189], v[16:17], v[196:197], v[188:189] op_sel_hi:[0,1,1]
    v_pk_fma_f32 v[190:191], v[16:17], v[198:199], v[190:191] op_sel_hi:[0,1,1]
    v_pk_fma_f32 v[192:193], v[16:17], v[200:201], v[192:193] op_sel_hi:[0,1,1]
    v_pk_fma_f32 v[194:195], v[16:17], v[202:203], v[194:195] op_sel_hi:[0,1,1]
    v_pk_fma_f32 v[188:189], v[100:101], v[240:241], v[188:189] op_sel_hi:[1,0,1]
    v_pk_fma_f32 v[192:193], v[116:117], v[240:241], v[192:193] op_sel_hi:[1,0,1]
    v_pk_fma_f32 v[190:191], v[102:103], v[240:241], v[190:191] op_sel_hi:[1,0,1]
    v_pk_fma_f32 v[194:195], v[118:119], v[240:241], v[194:195] op_sel_hi:[1,0,1]
    v_pk_mul_f32 v[188:189], v[188:189], v[104:105]
    v_pk_mul_f32 v[190:191], v[190:191], v[106:107]
    v_pk_fma_f32 v[32:33], v[120:121], v[192:193], v[188:189]
    v_pk_fma_f32 v[192:193], v[120:121], v[192:193], v[188:189] neg_lo:[1,0,0] neg_hi:[1,0,0]
    v_pk_fma_f32 v[34:35], v[122:123], v[194:195], v[190:191]
    v_pk_fma_f32 v[194:195], v[122:123], v[194:195], v[190:191] neg_lo:[1,0,0] neg_hi:[1,0,0]
    v_cvt_pk_bf16_f32 v30, v192, v193
    v_cvt_pk_bf16_f32 v31, v194, v195
    v_cvt_pk_bf16_f32 v28, v32, v33
    v_cvt_pk_bf16_f32 v29, v34, v35
    v_xor_b32 v30, s24, v30
    v_xor_b32 v31, s24, v31
    s_nop 0
    v_permlane16_swap_b32 v28, v30
    v_permlane16_swap_b32_e64 v29, v31
    buffer_store_dwordx4 v[28:31], v229, s[12:15], 0 offen sc1
    v_pk_fma_f32 v[204:205], v[16:17], v[212:213], v[204:205] op_sel_hi:[0,1,1]
    v_pk_fma_f32 v[206:207], v[16:17], v[214:215], v[206:207] op_sel_hi:[0,1,1]
    v_pk_fma_f32 v[208:209], v[16:17], v[216:217], v[208:209] op_sel_hi:[0,1,1]
    v_pk_fma_f32 v[210:211], v[16:17], v[218:219], v[210:211] op_sel_hi:[0,1,1]
    v_pk_fma_f32 v[204:205], v[100:101], v[244:245], v[204:205] op_sel_hi:[1,0,1]
    v_pk_fma_f32 v[208:209], v[116:117], v[244:245], v[208:209] op_sel_hi:[1,0,1]
    v_pk_fma_f32 v[206:207], v[102:103], v[244:245], v[206:207] op_sel_hi:[1,0,1]
    v_pk_fma_f32 v[210:211], v[118:119], v[244:245], v[210:211] op_sel_hi:[1,0,1]
    v_pk_mul_f32 v[204:205], v[204:205], v[104:105]
    v_pk_mul_f32 v[206:207], v[206:207], v[106:107]
    v_pk_fma_f32 v[40:41], v[120:121], v[208:209], v[204:205]
    v_pk_fma_f32 v[208:209], v[120:121], v[208:209], v[204:205] neg_lo:[1,0,0] neg_hi:[1,0,0]
    v_pk_fma_f32 v[42:43], v[122:123], v[210:211], v[206:207]
    v_pk_fma_f32 v[210:211], v[122:123], v[210:211], v[206:207] neg_lo:[1,0,0] neg_hi:[1,0,0]
    v_cvt_pk_bf16_f32 v38, v208, v209
    v_cvt_pk_bf16_f32 v39, v210, v211
    v_cvt_pk_bf16_f32 v36, v40, v41
    v_cvt_pk_bf16_f32 v37, v42, v43
    v_xor_b32 v38, s24, v38
    v_xor_b32 v39, s24, v39
    s_nop 0
    v_permlane16_swap_b32 v36, v38
    v_permlane16_swap_b32 v37, v39
    buffer_store_dwordx4 v[36:39], v234, s[12:15], 0 offen sc1
    s_or_b32 s3, s48, s53
    s_cbranch_scc1 P1_nm
    s_lshl_b32 s3, s52, 7
    s_lshl_b32 s26, s25, 5
    s_add_u32 s3, s3, s26
    s_add_u32 s3, s3, 12582912
    s_mov_b32 exec_lo, 0x00010001
    s_mov_b32 exec_hi, 0x00010001
    buffer_store_dwordx4 v[100:103], v231, s[12:15], s3 offen sc1
    s_mov_b64 exec, -1
P1_nm:
    v_perm_b32 v174, v167, v151, s46
    v_perm_b32 v175, v171, v155, s46
    s_add_u32 s60, s60, s63
    buffer_store_dwordx4 v[172:175], v180, s[8:11], s60 offen sc1
    v_perm_b32 v176, v159, v143, s47
    v_perm_b32 v177, v163, v147, s47
    v_perm_b32 v178, v167, v151, s47
    v_perm_b32 v179, v171, v155, s47
    s_add_u32 s60, s60, s63
    buffer_store_dwordx4 v[176:179], v180, s[8:11], s60 offen sc1
    s_add_u32 s40, s6, 6291456
    s_addc_u32 s41, s7, 0
    s_mov_b32 s42, 6291456
    s_mov_b32 s43, 0x20000
    s_mul_i32 s58, s20, 15360
    s_add_u32 s58, s58, 81920
    s_mul_i32 s56, s20, 245760
    s_lshl_b32 s3, s22, 10
    s_add_u32 s59, s56, s3
    s_add_u32 s56, s59, s3
    s_add_u32 s59, s59, 30720
    s_and_b32 s3, s22, 7
    s_mulk_i32 s3, 5120
    s_add_u32 s3, s3, 3145728
    s_mul_i32 s97, s20, 81920
    s_lshl2_add_u32 s62, s97, s3
    s_lshl1_add_u32 s96, s97, s3
    s_add_u32 s96, s96, 1310720
    s_add_u32 s97, s97, s3
    s_add_u32 s97, s97, 1966080
    s_and_b32 s21, s2, 7
    s_lshl_b32 s21, s21, 1
    s_lshr_b32 s3, s2, 7
    s_add_u32 s21, s21, s3
    s_add_u32 s3, s3, s20
    s_cmp_ge_u32 s20, 2
    s_cselect_b32 s3, s3, 0
    s_cmp_ge_u32 s3, 3
    s_cbranch_scc1 P2_free
    v_and_b32 v2, 31, v1
    v_lshrrev_b32 v3, 5, v1
    s_lshl_b32 s24, s2, 1
    s_add_u32 s24, s24, s20
    s_and_b32 s3, s2, 0x70
    s_add_u32 s3, s3, s21
    s_bfe_u32 s26, s2, 0x10003
    s_add_u32 s3, s3, s26
    s_add_u32 s3, s3, 512
    s_cmp_eq_u32 s20, 2
    s_cselect_b32 s24, s3, s24
    s_lshr_b32 s26, s24, 1
    s_and_b32 s23, s24, 1
    s_lshl_b32 s27, s24, 6
    s_add_u32 s27, s27, 13631488
    s_lshr_b32 s25, s26, 3
    s_lshl1_add_u32 s25, s25, s23
    s_lshl_b32 s25, s25, 12
    s_and_b32 s3, s26, 7
    s_mul_i32 s3, s3, 327680
    s_add_u32 s25, s25, s3
    s_add_u32 s25, s25, 3145728
    s_lshl_b32 s24, s26, 13
    s_lshl_b32 s3, s23, 6
    s_add_u32 s24, s24, s3
    s_add_u32 s38, s24, 4096
    v_lshrrev_b32 v4, 1, v2
    v_lshlrev_b32 v4, 7, v4
    v_lshl_add_u32 v4, v3, 11, v4
    v_and_b32 v6, 1, v2
    v_lshl_add_u32 v4, v6, 4, v4
    s_add_u32 s26, s26, 1
    v_lshl_add_u32 v6, v2, 1, s23
    v_cvt_f32_u32 v6, v6
    v_cvt_f32_u32 v7, v2
    v_cvt_f32_u32 v8, v3
    v_lshl_add_u32 v9, v3, 3, s23
    v_cvt_f32_u32 v9, v9
    v_cvt_f32_u32 v10, s26
    s_load_dwordx2 s[8:9], s[0:1], 40
    s_lshl_b32 s44, s20, 8
    s_add_u32 s44, s44, s2
    s_and_b32 s45, s44, 7
    s_mul_i32 s45, s45, 56
    s_lshr_b32 s48, s44, 3
    s_add_u32 s48, s48, s45
    s_mul_i32 s60, s48, 5120
    s_add_u32 s60, s60, 9437184
    s_lshr_b32 s45, s48, 3
    s_and_b32 s48, s48, 7
    s_lshr_b32 s3, s45, 2
    s_mulk_i32 s3, 120
    s_lshl1_add_u32 s3, s45, s3
    s_sub_u32 s3, s3, 64
    s_lshl_b32 s23, s45, 5
    s_cmp_ge_u32 s45, 32
    s_cselect_b32 s23, s3, s23
    s_movk_i32 s26, 1280
    s_cselect_b32 s26, 10240, s26
    s_movk_i32 s39, 16640
    s_cselect_b32 s39, -29440, s39
    s_mulk_i32 s23, 1280
    s_mulk_i32 s48, 160
    s_add_u32 s23, s23, s48
    s_lshl_b32 s3, s26, 2
    v_lshrrev_b32 v184, 4, v1
    v_mul_u32_u24 v184, s3, v184
    v_and_b32 v185, 15, v1
    v_mad_u32_u24 v184, v185, 10, v184
    v_and_b32 v184, -4, v184
    v_and_b32 v185, 1, v1
    v_mul_u32_u24 v185, 0x606, v185
    v_or_b32 v185, 0x03020100, v185
    s_lshr_b32 s3, s45, 1
    s_cmp_eq_u32 s3, 15
    s_cselect_b32 s10, 0, 2211840
    s_cmp_lt_u32 s44, 448
    s_cselect_b32 s10, s10, 0
    s_cselect_b32 s49, 0x1000000, 0
    s_bfe_u32 s44, s2, 0x30003
    s_lshl_b32 s44, s44, 8
    s_add_u32 s44, s44, 32896
    s_waitcnt lgkmcnt(0)
    s_mov_b32 s36, 0x80008000
    s_mov_b32 s37, 0xffff0000
    v_mul_f32 v12, 0x3a000000, v6
    v_mul_f32 v13, v12, v8
    v_mul_f32 v13, 4.0, v13
    v_cos_f32 v120, v13
    v_sin_f32 v136, v13
    v_fmamk_f32 v137, v12, 0x3f800000, v13
    buffer_load_dwordx3 v[16:18], v184, s[8:11], s23 offen
    v_cos_f32 v121, v137
    v_sin_f32 v137, v137
    v_fmamk_f32 v138, v12, 0x40000000, v13
    v_cos_f32 v122, v138
    v_sin_f32 v138, v138
    v_fmamk_f32 v139, v12, 0x40400000, v13
    s_add_u32 s23, s23, s26
    buffer_load_dwordx3 v[32:34], v184, s[8:11], s23 offen
    v_cos_f32 v123, v139
    v_sin_f32 v139, v139
    v_fmamk_f32 v140, v12, 0x41000000, v13
    v_cos_f32 v124, v140
    v_sin_f32 v140, v140
    v_fmamk_f32 v141, v12, 0x41100000, v13
    s_add_u32 s23, s23, s26
    buffer_load_dwordx3 v[20:22], v184, s[8:11], s23 offen
    v_cos_f32 v125, v141
    v_sin_f32 v141, v141
    v_fmamk_f32 v142, v12, 0x41200000, v13
    v_cos_f32 v126, v142
    v_sin_f32 v142, v142
    v_fmamk_f32 v143, v12, 0x41300000, v13
    s_add_u32 s23, s23, s26
    buffer_load_dwordx3 v[36:38], v184, s[8:11], s23 offen
    v_cos_f32 v127, v143
    v_sin_f32 v143, v143
    v_fmamk_f32 v144, v12, 0x41800000, v13
    v_cos_f32 v128, v144
    v_sin_f32 v144, v144
    v_fmamk_f32 v145, v12, 0x41880000, v13
    s_add_u32 s23, s23, s39
    buffer_load_dwordx3 v[24:26], v184, s[8:11], s23 offen
    v_cos_f32 v129, v145
    v_sin_f32 v145, v145
    v_fmamk_f32 v146, v12, 0x41900000, v13
    v_cos_f32 v130, v146
    v_sin_f32 v146, v146
    v_fmamk_f32 v147, v12, 0x41980000, v13
    s_add_u32 s23, s23, s26
    buffer_load_dwordx3 v[40:42], v184, s[8:11], s23 offen
    v_cos_f32 v131, v147
    v_sin_f32 v147, v147
    v_fmamk_f32 v148, v12, 0x41c00000, v13
    v_cos_f32 v132, v148
    v_sin_f32 v148, v148
    v_fmamk_f32 v149, v12, 0x41c80000, v13
    s_add_u32 s23, s23, s26
    buffer_load_dwordx3 v[28:30], v184, s[8:11], s23 offen
    v_cos_f32 v133, v149
    v_sin_f32 v149, v149
    v_fmamk_f32 v150, v12, 0x41d00000, v13
    v_cos_f32 v134, v150
    v_sin_f32 v150, v150
    v_fmamk_f32 v151, v12, 0x41d80000, v13
    s_add_u32 s23, s23, s26
    buffer_load_dwordx3 v[44:46], v184, s[8:11], s23 offen
    v_cos_f32 v135, v151
    v_sin_f32 v151, v151
    v_mul_f32 v13, v7, v9
    v_mul_f32 v14, 0x3a800000, v7
    v_mul_f32 v15, 0x3a000000, v13
    v_fmamk_f32 v15, v10, 0xba4ccccd, v15
    v_cos_f32 v152, v15
    v_sin_f32 v168, v15
    v_fmamk_f32 v169, v14, 0x3f800000, v15
    v_cos_f32 v153, v169
    v_sin_f32 v169, v169
    v_fmamk_f32 v170, v14, 0x40000000, v15
    v_cos_f32 v154, v170
    v_sin_f32 v170, v170
    v_fmamk_f32 v171, v14, 0x40400000, v15
    v_cos_f32 v155, v171
    v_sin_f32 v171, v171
    v_fmamk_f32 v172, v14, 0x41000000, v15
    v_cos_f32 v156, v172
    v_sin_f32 v172, v172
    v_fmamk_f32 v173, v14, 0x41100000, v15
    v_cos_f32 v157, v173
    v_sin_f32 v173, v173
    v_fmamk_f32 v174, v14, 0x41200000, v15
    v_cos_f32 v158, v174
    v_sin_f32 v174, v174
    v_fmamk_f32 v175, v14, 0x41300000, v15
    v_cos_f32 v159, v175
    v_sin_f32 v175, v175
    v_fmamk_f32 v176, v14, 0x41800000, v15
    v_cos_f32 v160, v176
    v_sin_f32 v176, v176
    v_fmamk_f32 v177, v14, 0x41880000, v15
    v_cos_f32 v161, v177
    v_sin_f32 v177, v177
    v_fmamk_f32 v178, v14, 0x41900000, v15
    v_cos_f32 v162, v178
    v_sin_f32 v178, v178
    v_fmamk_f32 v179, v14, 0x41980000, v15
    v_cos_f32 v163, v179
    v_sin_f32 v179, v179
    v_fmamk_f32 v180, v14, 0x41c00000, v15
    v_cos_f32 v164, v180
    v_sin_f32 v180, v180
    v_fmamk_f32 v181, v14, 0x41c80000, v15
    v_cos_f32 v165, v181
    v_sin_f32 v181, v181
    v_fmamk_f32 v182, v14, 0x41d00000, v15
    v_cos_f32 v166, v182
    v_sin_f32 v182, v182
    v_fmamk_f32 v183, v14, 0x41d80000, v15
    v_cos_f32 v167, v183
    v_sin_f32 v183, v183
    v_mul_f32 v12, 0x3d000000, v7
    v_mul_f32 v13, 0x3c800000, v13
    s_waitcnt lgkmcnt(0)
    s_waitcnt vmcnt(8)
    s_barrier
    v_cos_f32 v216, v13
    v_sin_f32 v232, v13
    v_fmamk_f32 v233, v12, 0x3f800000, v13
    v_cos_f32 v217, v233
    v_sin_f32 v233, v233
    v_fmamk_f32 v234, v12, 0x40000000, v13
    v_cos_f32 v218, v234
    v_sin_f32 v234, v234
    v_fmamk_f32 v235, v12, 0x40400000, v13
    v_cos_f32 v219, v235
    s_add_u32 m0, s57, 0
    s_nop 0
    buffer_load_dwordx4 v248, s[32:35], s55 offen lds
    v_sin_f32 v235, v235
    v_fmamk_f32 v236, v12, 0x41000000, v13
    v_cos_f32 v220, v236
    v_sin_f32 v236, v236
    v_fmamk_f32 v237, v12, 0x41100000, v13
    v_cos_f32 v221, v237
    v_sin_f32 v237, v237
    v_fmamk_f32 v238, v12, 0x41200000, v13
    v_cos_f32 v222, v238
    v_sin_f32 v238, v238
    s_add_u32 m0, s57, 1024
    s_mul_i32 s61, s54, 40
    s_add_u32 s61, s61, s55
    buffer_load_dwordx4 v248, s[32:35], s61 offen lds
    v_fmamk_f32 v239, v12, 0x41300000, v13
    v_cos_f32 v223, v239
    v_sin_f32 v239, v239
    v_fmamk_f32 v240, v12, 0x41800000, v13
    v_cos_f32 v224, v240
    v_sin_f32 v240, v240
    v_fmamk_f32 v241, v12, 0x41880000, v13
    v_cos_f32 v225, v241
    v_sin_f32 v241, v241
    v_fmamk_f32 v242, v12, 0x41900000, v13
    s_add_u32 m0, s57, 2048
    s_mul_i32 s61, s54, 320
    s_add_u32 s61, s61, s55
    buffer_load_dwordx4 v248, s[32:35], s61 offen lds
    v_cos_f32 v226, v242
    v_sin_f32 v242, v242
    v_fmamk_f32 v243, v12, 0x41980000, v13
    v_cos_f32 v227, v243
    v_sin_f32 v243, v243
    v_fmamk_f32 v244, v12, 0x41c00000, v13
    v_cos_f32 v228, v244
    v_sin_f32 v244, v244
    v_fmamk_f32 v245, v12, 0x41c80000, v13
    v_cos_f32 v229, v245
    s_add_u32 m0, s57, 3072
    s_mul_i32 s61, s54, 360
    s_add_u32 s61, s61, s55
    buffer_load_dwordx4 v248, s[32:35], s61 offen lds
    v_sin_f32 v245, v245
    v_fmamk_f32 v246, v12, 0x41d00000, v13
    v_cos_f32 v230, v246
    v_sin_f32 v246, v246
    v_fmamk_f32 v247, v12, 0x41d80000, v13
    v_cos_f32 v231, v247
    v_sin_f32 v247, v247
    v_cvt_pk_bf16_f32 v96, v216, v217
    v_cvt_pk_bf16_f32 v104, v232, v233
    v_xor_b32 v112, s36, v104
    v_cvt_pk_bf16_f32 v97, v218, v219
    s_add_u32 m0, s57, 4096
    s_mul_i32 s61, s54, 4
    s_add_u32 s61, s61, s55
    buffer_load_dwordx4 v248, s[32:35], s61 offen lds
    v_cvt_pk_bf16_f32 v105, v234, v235
    v_xor_b32 v113, s36, v105
    v_cvt_pk_bf16_f32 v98, v220, v221
    v_cvt_pk_bf16_f32 v106, v236, v237
    v_xor_b32 v114, s36, v106
    v_cvt_pk_bf16_f32 v99, v222, v223
    v_cvt_pk_bf16_f32 v107, v238, v239
    v_xor_b32 v115, s36, v107
    v_cvt_pk_bf16_f32 v100, v224, v225
    v_cvt_pk_bf16_f32 v108, v240, v241
    v_xor_b32 v116, s36, v108
    v_cvt_pk_bf16_f32 v101, v226, v227
    v_cvt_pk_bf16_f32 v109, v242, v243
    v_xor_b32 v117, s36, v109
    v_cvt_pk_bf16_f32 v102, v228, v229
    v_cvt_pk_bf16_f32 v110, v244, v245
    s_add_u32 m0, s57, 5120
    s_mul_i32 s61, s54, 44
    s_add_u32 s61, s61, s55
    buffer_load_dwordx4 v248, s[32:35], s61 offen lds
    v_xor_b32 v118, s36, v110
    v_cvt_pk_bf16_f32 v103, v230, v231
    v_cvt_pk_bf16_f32 v111, v246, v247
    v_xor_b32 v119, s36, v111
    s_mov_b64 s[8:9], s[6:7]
    s_mov_b32 s10, s49
    s_waitcnt vmcnt(6)
    v_perm_b32 v16, v18, v16, v185
    v_perm_b32 v20, v22, v20, v185
    v_perm_b32 v24, v26, v24, v185
    v_perm_b32 v28, v30, v28, v185
    v_perm_b32 v32, v34, v32, v185
    v_perm_b32 v36, v38, v36, v185
    v_perm_b32 v40, v42, v40, v185
    v_perm_b32 v44, v46, v44, v185
    v_perm_b32 v188, v32, v16, s46
    s_add_u32 m0, s57, 6144
    s_mul_i32 s61, s54, 324
    s_add_u32 s61, s61, s55
    s_nop 0
    buffer_load_dwordx4 v248, s[32:35], s61 offen lds
    v_perm_b32 v189, v36, v20, s46
    v_perm_b32 v190, v40, v24, s46
    v_perm_b32 v191, v44, v28, s46
    buffer_store_dwordx4 v[188:191], v251, s[8:11], s60 offen offset:0 sc1
    v_perm_b32 v192, v32, v16, s47
    v_perm_b32 v193, v36, v20, s47
    v_perm_b32 v194, v40, v24, s47
    v_perm_b32 v195, v44, v28, s47
    buffer_store_dwordx4 v[192:195], v251, s[8:11], s60 offen offset:1024 sc1
    v_perm_b32 v196, v33, v17, s46
    v_perm_b32 v197, v37, v21, s46
    v_perm_b32 v198, v41, v25, s46
    v_perm_b32 v199, v45, v29, s46
    buffer_store_dwordx4 v[196:199], v251, s[8:11], s60 offen offset:2048 sc1
    v_perm_b32 v200, v33, v17, s47
    v_perm_b32 v201, v37, v21, s47
    s_add_u32 m0, s57, 7168
    s_mul_i32 s61, s54, 364
    s_add_u32 s61, s61, s55
    buffer_load_dwordx4 v248, s[32:35], s61 offen lds
    v_perm_b32 v202, v41, v25, s47
    v_perm_b32 v203, v45, v29, s47
    buffer_store_dwordx4 v[200:203], v251, s[8:11], s60 offen offset:3072 sc1
    v_perm_b32 v204, v34, v18, s46
    v_perm_b32 v205, v38, v22, s46
    v_perm_b32 v206, v42, v26, s46
    v_perm_b32 v207, v46, v30, s46
    s_add_u32 s60, s60, 4096
    buffer_store_dwordx4 v[204:207], v251, s[8:11], s60 offen offset:0 sc1
    v_mul_f32 v13, v12, v8
    v_mul_f32 v13, 4.0, v13
    v_cos_f32 v216, v13
    v_sin_f32 v232, v13
    v_fmamk_f32 v233, v12, 0x3f800000, v13
    s_add_u32 m0, s57, 8192
    s_mul_i32 s61, s54, 8
    s_add_u32 s61, s61, s55
    buffer_load_dwordx4 v248, s[32:35], s61 offen lds
    v_cos_f32 v217, v233
    v_sin_f32 v233, v233
    v_fmamk_f32 v234, v12, 0x40000000, v13
    v_cos_f32 v218, v234
    v_sin_f32 v234, v234
    v_fmamk_f32 v235, v12, 0x40400000, v13
    v_cos_f32 v219, v235
    v_sin_f32 v235, v235
    v_fmamk_f32 v236, v12, 0x41000000, v13
    v_cos_f32 v220, v236
    s_add_u32 m0, s57, 9216
    s_mul_i32 s61, s54, 48
    s_add_u32 s61, s61, s55
    buffer_load_dwordx4 v248, s[32:35], s61 offen lds
    v_sin_f32 v236, v236
    v_fmamk_f32 v237, v12, 0x41100000, v13
    v_cos_f32 v221, v237
    v_sin_f32 v237, v237
    v_fmamk_f32 v238, v12, 0x41200000, v13
    v_cos_f32 v222, v238
    v_sin_f32 v238, v238
    v_fmamk_f32 v239, v12, 0x41300000, v13
    v_cos_f32 v223, v239
    v_sin_f32 v239, v239
    s_add_u32 m0, s57, 10240
    s_mul_i32 s61, s54, 328
    s_add_u32 s61, s61, s55
    buffer_load_dwordx4 v248, s[32:35], s61 offen lds
    v_fmamk_f32 v240, v12, 0x41800000, v13
    v_cos_f32 v224, v240
    v_sin_f32 v240, v240
    v_fmamk_f32 v241, v12, 0x41880000, v13
    v_cos_f32 v225, v241
    v_sin_f32 v241, v241
    v_fmamk_f32 v242, v12, 0x41900000, v13
    v_cos_f32 v226, v242
    v_sin_f32 v242, v242
    v_fmamk_f32 v243, v12, 0x41980000, v13
    s_add_u32 m0, s57, 11264
    s_mul_i32 s61, s54, 368
    s_add_u32 s61, s61, s55
    buffer_load_dwordx4 v248, s[32:35], s61 offen lds
    v_cos_f32 v227, v243
    v_sin_f32 v243, v243
    v_fmamk_f32 v244, v12, 0x41c00000, v13
    v_cos_f32 v228, v244
    v_sin_f32 v244, v244
    v_fmamk_f32 v245, v12, 0x41c80000, v13
    v_cos_f32 v229, v245
    v_sin_f32 v245, v245
    v_fmamk_f32 v246, v12, 0x41d00000, v13
    v_cos_f32 v230, v246
    s_add_u32 m0, s57, 12288
    s_mul_i32 s61, s54, 12
    s_add_u32 s61, s61, s55
    buffer_load_dwordx4 v248, s[32:35], s61 offen lds
    v_sin_f32 v246, v246
    v_fmamk_f32 v247, v12, 0x41d80000, v13
    v_cos_f32 v231, v247
    v_sin_f32 v247, v247
    v_cvt_pk_bf16_f32 v72, v216, v217
    v_cvt_pk_bf16_f32 v80, v232, v233
    v_xor_b32 v88, s36, v80
    v_cvt_pk_bf16_f32 v73, v218, v219
    v_cvt_pk_bf16_f32 v81, v234, v235
    v_xor_b32 v89, s36, v81
    v_cvt_pk_bf16_f32 v74, v220, v221
    v_cvt_pk_bf16_f32 v82, v236, v237
    v_xor_b32 v90, s36, v82
    s_add_u32 m0, s57, 13312
    s_mul_i32 s61, s54, 52
    s_add_u32 s61, s61, s55
    buffer_load_dwordx4 v248, s[32:35], s61 offen lds
    v_cvt_pk_bf16_f32 v75, v222, v223
    v_cvt_pk_bf16_f32 v83, v238, v239
    v_xor_b32 v91, s36, v83
    v_cvt_pk_bf16_f32 v76, v224, v225
    v_cvt_pk_bf16_f32 v84, v240, v241
    v_xor_b32 v92, s36, v84
    v_cvt_pk_bf16_f32 v77, v226, v227
    v_cvt_pk_bf16_f32 v85, v242, v243
    v_xor_b32 v93, s36, v85
    v_cvt_pk_bf16_f32 v78, v228, v229
    v_cvt_pk_bf16_f32 v86, v244, v245
    v_xor_b32 v94, s36, v86
    v_cvt_pk_bf16_f32 v79, v230, v231
    v_cvt_pk_bf16_f32 v87, v246, v247
    v_xor_b32 v95, s36, v87
    s_add_u32 m0, s57, 14336
    s_mul_i32 s61, s54, 332
    s_add_u32 s61, s61, s55
    buffer_load_dwordx4 v248, s[32:35], s61 offen lds
    s_add_u32 m0, s57, 15360
    s_mul_i32 s61, s54, 372
    s_add_u32 s61, s61, s55
    buffer_load_dwordx4 v248, s[32:35], s61 offen lds
    s_add_u32 m0, s57, 16384
    s_mul_i32 s61, s54, 16
    s_add_u32 s61, s61, s55
    buffer_load_dwordx4 v248, s[32:35], s61 offen lds
    s_waitcnt vmcnt(9)
    s_barrier
    buffer_load_dwordx4 v[16:19], v4, s[12:15], s24 offen sc1
    buffer_load_dwordx4 v[24:27], v4, s[12:15], s24 offen offset:32 sc1
    buffer_load_dwordx4 v[20:23], v4, s[12:15], s38 offen sc1
    buffer_load_dwordx4 v[28:31], v4, s[12:15], s38 offen offset:32 sc1
    buffer_load_dwordx4 v[32:35], v251, s[12:15], s25 offen offset:0 sc1
    buffer_load_dwordx4 v[36:39], v251, s[12:15], s25 offen offset:1024 sc1
    buffer_load_dwordx4 v[40:43], v251, s[12:15], s25 offen offset:2048 sc1
    buffer_load_dwordx4 v[44:47], v251, s[12:15], s25 offen offset:3072 sc1
    v_mul_f32 v12, 0x3c800000, v6
    v_mul_f32 v13, v12, v8
    v_mul_f32 v13, 0x41000000, v13
    v_cos_f32 v216, v13
    v_sin_f32 v232, v13
    v_fmamk_f32 v233, v12, 0x3f800000, v13
    v_cos_f32 v217, v233
    v_sin_f32 v233, v233
    v_fmamk_f32 v234, v12, 0x40000000, v13
    v_cos_f32 v218, v234
    v_sin_f32 v234, v234
    v_fmamk_f32 v235, v12, 0x40400000, v13
    v_cos_f32 v219, v235
    v_sin_f32 v235, v235
    v_fmamk_f32 v236, v12, 0x40800000, v13
    v_cos_f32 v220, v236
    v_sin_f32 v236, v236
    v_fmamk_f32 v237, v12, 0x40a00000, v13
    v_cos_f32 v221, v237
    v_sin_f32 v237, v237
    v_fmamk_f32 v238, v12, 0x40c00000, v13
    v_cos_f32 v222, v238
    v_sin_f32 v238, v238
    v_fmamk_f32 v239, v12, 0x40e00000, v13
    v_cos_f32 v223, v239
    v_sin_f32 v239, v239
    v_fmamk_f32 v240, v12, 0x41800000, v13
    v_cos_f32 v224, v240
    v_sin_f32 v240, v240
    v_fmamk_f32 v241, v12, 0x41880000, v13
    v_cos_f32 v225, v241
    v_sin_f32 v241, v241
    v_fmamk_f32 v242, v12, 0x41900000, v13
    v_cos_f32 v226, v242
    v_sin_f32 v242, v242
    v_fmamk_f32 v243, v12, 0x41980000, v13
    v_cos_f32 v227, v243
    v_sin_f32 v243, v243
    v_fmamk_f32 v244, v12, 0x41a00000, v13
    v_cos_f32 v228, v244
    v_sin_f32 v244, v244
    v_fmamk_f32 v245, v12, 0x41a80000, v13
    v_cos_f32 v229, v245
    v_sin_f32 v245, v245
    v_fmamk_f32 v246, v12, 0x41b00000, v13
    v_cos_f32 v230, v246
    v_sin_f32 v246, v246
    v_fmamk_f32 v247, v12, 0x41b80000, v13
    v_cos_f32 v231, v247
    v_sin_f32 v247, v247
    v_cvt_pk_bf16_f32 v48, v216, v217
    v_cvt_pk_bf16_f32 v56, v232, v233
    v_xor_b32 v64, s36, v56
    v_cvt_pk_bf16_f32 v49, v218, v219
    v_cvt_pk_bf16_f32 v57, v234, v235
    v_xor_b32 v65, s36, v57
    v_cvt_pk_bf16_f32 v50, v220, v221
    v_cvt_pk_bf16_f32 v58, v236, v237
    v_xor_b32 v66, s36, v58
    v_cvt_pk_bf16_f32 v51, v222, v223
    v_cvt_pk_bf16_f32 v59, v238, v239
    v_xor_b32 v67, s36, v59
    v_cvt_pk_bf16_f32 v52, v224, v225
    v_cvt_pk_bf16_f32 v60, v240, v241
    v_xor_b32 v68, s36, v60
    v_cvt_pk_bf16_f32 v53, v226, v227
    v_cvt_pk_bf16_f32 v61, v242, v243
    v_xor_b32 v69, s36, v61
    v_cvt_pk_bf16_f32 v54, v228, v229
    v_cvt_pk_bf16_f32 v62, v244, v245
    v_xor_b32 v70, s36, v62
    v_cvt_pk_bf16_f32 v55, v230, v231
    v_cvt_pk_bf16_f32 v63, v246, v247
    v_xor_b32 v71, s36, v63
    v_lshrrev_b32 v5, 1, v2
    v_mul_u32_u24 v5, 40960, v5
    v_and_b32 v6, 1, v2
    v_lshl_add_u32 v5, v6, 5, v5
    v_lshl_add_u32 v5, v3, 4, v5
    s_waitcnt vmcnt(4)
    v_mfma_f32_32x32x16_bf16 v[184:199], v[16:19], v[48:51], 0
    s_add_u32 m0, s57, 17408
    s_mul_i32 s61, s54, 56
    s_add_u32 s61, s61, s55
    buffer_load_dwordx4 v248, s[32:35], s61 offen lds
    v_mfma_f32_32x32x16_bf16 v[200:215], v[24:27], v[48:51], 0
    s_add_u32 m0, s57, 18432
    s_mul_i32 s61, s54, 336
    s_add_u32 s61, s61, s55
    buffer_load_dwordx4 v248, s[32:35], s61 offen lds
    v_mfma_f32_32x32x16_bf16 v[184:199], v[24:27], v[56:59], v[184:199]
    s_add_u32 m0, s57, 19456
    s_mul_i32 s61, s54, 376
    s_add_u32 s61, s61, s55
    buffer_load_dwordx4 v248, s[32:35], s61 offen lds
    v_mfma_f32_32x32x16_bf16 v[200:215], v[16:19], v[64:67], v[200:215]
    s_add_u32 m0, s58, 0
    s_add_u32 s61, s56, 0
    buffer_load_dwordx4 v251, s[40:43], s61 offen offset:0 sc1 lds
    v_mfma_f32_32x32x16_bf16 v[184:199], v[20:23], v[52:55], v[184:199]
    buffer_load_dwordx4 v251, s[40:43], s61 offen offset:1024 sc1 lds
    v_mfma_f32_32x32x16_bf16 v[200:215], v[28:31], v[52:55], v[200:215]
    s_add_u32 s61, s59, 0
    buffer_load_dwordx4 v251, s[40:43], s61 offen offset:2048 sc1 lds
    v_mfma_f32_32x32x16_bf16 v[184:199], v[28:31], v[60:63], v[184:199]
    s_add_u32 m0, s58, 3072
    s_add_u32 s61, s56, 49152
    buffer_load_dwordx4 v251, s[40:43], s61 offen offset:0 sc1 lds
    v_mfma_f32_32x32x16_bf16 v[200:215], v[20:23], v[68:71], v[200:215]
    buffer_load_dwordx4 v251, s[40:43], s61 offen offset:1024 sc1 lds
    s_nop 6
    s_nop 0
    v_pk_mul_f32 v[216:217], v[184:185], v[120:121]
    v_pk_mul_f32 v[218:219], v[186:187], v[122:123]
    v_pk_mul_f32 v[220:221], v[188:189], v[124:125]
    v_pk_mul_f32 v[222:223], v[190:191], v[126:127]
    v_pk_mul_f32 v[224:225], v[192:193], v[128:129]
    v_pk_mul_f32 v[226:227], v[194:195], v[130:131]
    v_pk_mul_f32 v[228:229], v[196:197], v[132:133]
    v_pk_mul_f32 v[230:231], v[198:199], v[134:135]
    s_add_u32 s61, s59, 49152
    buffer_load_dwordx4 v251, s[40:43], s61 offen offset:2048 sc1 lds
    v_pk_mul_f32 v[232:233], v[200:201], v[120:121]
    v_pk_mul_f32 v[234:235], v[202:203], v[122:123]
    v_pk_mul_f32 v[236:237], v[204:205], v[124:125]
    v_pk_mul_f32 v[238:239], v[206:207], v[126:127]
    v_pk_mul_f32 v[240:241], v[208:209], v[128:129]
    v_pk_mul_f32 v[242:243], v[210:211], v[130:131]
    v_pk_mul_f32 v[244:245], v[212:213], v[132:133]
    v_pk_mul_f32 v[246:247], v[214:215], v[134:135]
    s_add_u32 m0, s58, 6144
    s_add_u32 s61, s56, 98304
    buffer_load_dwordx4 v251, s[40:43], s61 offen offset:0 sc1 lds
    v_pk_fma_f32 v[216:217], v[200:201], v[136:137], v[216:217]
    v_pk_fma_f32 v[232:233], v[184:185], v[136:137], v[232:233] neg_lo:[0,1,0] neg_hi:[0,1,0]
    v_pk_fma_f32 v[218:219], v[202:203], v[138:139], v[218:219]
    v_pk_fma_f32 v[234:235], v[186:187], v[138:139], v[234:235] neg_lo:[0,1,0] neg_hi:[0,1,0]
    v_pk_fma_f32 v[220:221], v[204:205], v[140:141], v[220:221]
    v_pk_fma_f32 v[236:237], v[188:189], v[140:141], v[236:237] neg_lo:[0,1,0] neg_hi:[0,1,0]
    v_pk_fma_f32 v[222:223], v[206:207], v[142:143], v[222:223]
    v_pk_fma_f32 v[238:239], v[190:191], v[142:143], v[238:239] neg_lo:[0,1,0] neg_hi:[0,1,0]
    v_pk_fma_f32 v[224:225], v[208:209], v[144:145], v[224:225]
    v_pk_fma_f32 v[240:241], v[192:193], v[144:145], v[240:241] neg_lo:[0,1,0] neg_hi:[0,1,0]
    v_pk_fma_f32 v[226:227], v[210:211], v[146:147], v[226:227]
    v_pk_fma_f32 v[242:243], v[194:195], v[146:147], v[242:243] neg_lo:[0,1,0] neg_hi:[0,1,0]
    v_pk_fma_f32 v[228:229], v[212:213], v[148:149], v[228:229]
    v_pk_fma_f32 v[244:245], v[196:197], v[148:149], v[244:245] neg_lo:[0,1,0] neg_hi:[0,1,0]
    v_pk_fma_f32 v[230:231], v[214:215], v[150:151], v[230:231]
    v_pk_fma_f32 v[246:247], v[198:199], v[150:151], v[246:247] neg_lo:[0,1,0] neg_hi:[0,1,0]
    v_cvt_pk_bf16_f32 v16, v216, v217
    v_cvt_pk_bf16_f32 v24, v232, v233
    v_cvt_pk_bf16_f32 v17, v218, v219
    v_cvt_pk_bf16_f32 v25, v234, v235
    v_cvt_pk_bf16_f32 v18, v220, v221
    v_cvt_pk_bf16_f32 v26, v236, v237
    v_cvt_pk_bf16_f32 v19, v222, v223
    v_cvt_pk_bf16_f32 v27, v238, v239
    v_cvt_pk_bf16_f32 v20, v224, v225
    v_cvt_pk_bf16_f32 v28, v240, v241
    v_cvt_pk_bf16_f32 v21, v226, v227
    v_cvt_pk_bf16_f32 v29, v242, v243
    v_cvt_pk_bf16_f32 v22, v228, v229
    v_cvt_pk_bf16_f32 v30, v244, v245
    v_cvt_pk_bf16_f32 v23, v230, v231
    v_cvt_pk_bf16_f32 v31, v246, v247
    s_waitcnt vmcnt(10)
    v_mfma_f32_32x32x16_bf16 v[184:199], v[72:75], v[16:19], 0
    v_lshlrev_b32 v120, 16, v32
    v_and_b32 v136, s37, v32
    v_lshlrev_b32 v121, 16, v33
    v_and_b32 v137, s37, v33
    v_mfma_f32_32x32x16_bf16 v[200:215], v[72:75], v[24:27], 0
    v_lshlrev_b32 v122, 16, v34
    v_and_b32 v138, s37, v34
    v_lshlrev_b32 v123, 16, v35
    v_and_b32 v139, s37, v35
    v_mfma_f32_32x32x16_bf16 v[184:199], v[80:83], v[24:27], v[184:199]
    v_lshlrev_b32 v124, 16, v36
    v_and_b32 v140, s37, v36
    v_lshlrev_b32 v125, 16, v37
    v_and_b32 v141, s37, v37
    v_mfma_f32_32x32x16_bf16 v[200:215], v[88:91], v[16:19], v[200:215]
    v_lshlrev_b32 v126, 16, v38
    v_and_b32 v142, s37, v38
    v_lshlrev_b32 v127, 16, v39
    v_and_b32 v143, s37, v39
    v_mfma_f32_32x32x16_bf16 v[184:199], v[76:79], v[20:23], v[184:199]
    v_lshlrev_b32 v128, 16, v40
    v_and_b32 v144, s37, v40
    v_lshlrev_b32 v129, 16, v41
    v_and_b32 v145, s37, v41
    v_mfma_f32_32x32x16_bf16 v[200:215], v[76:79], v[28:31], v[200:215]
    v_lshlrev_b32 v130, 16, v42
    v_and_b32 v146, s37, v42
    v_lshlrev_b32 v131, 16, v43
    v_and_b32 v147, s37, v43
    v_mfma_f32_32x32x16_bf16 v[184:199], v[84:87], v[28:31], v[184:199]
    v_lshlrev_b32 v132, 16, v44
    v_and_b32 v148, s37, v44
    v_lshlrev_b32 v133, 16, v45
    v_and_b32 v149, s37, v45
    v_mfma_f32_32x32x16_bf16 v[200:215], v[92:95], v[20:23], v[200:215]
    v_lshlrev_b32 v134, 16, v46
    v_and_b32 v150, s37, v46
    v_lshlrev_b32 v135, 16, v47
    v_and_b32 v151, s37, v47
    s_nop 2
    v_pk_mul_f32 v[216:217], v[184:185], v[120:121]
    v_pk_mul_f32 v[218:219], v[186:187], v[122:123]
    v_pk_mul_f32 v[220:221], v[188:189], v[124:125]
    v_pk_mul_f32 v[222:223], v[190:191], v[126:127]
    v_pk_mul_f32 v[224:225], v[192:193], v[128:129]
    v_pk_mul_f32 v[226:227], v[194:195], v[130:131]
    v_pk_mul_f32 v[228:229], v[196:197], v[132:133]
    v_pk_mul_f32 v[230:231], v[198:199], v[134:135]
    v_pk_mul_f32 v[232:233], v[200:201], v[120:121]
    v_pk_mul_f32 v[234:235], v[202:203], v[122:123]
    v_pk_mul_f32 v[236:237], v[204:205], v[124:125]
    v_pk_mul_f32 v[238:239], v[206:207], v[126:127]
    v_pk_mul_f32 v[240:241], v[208:209], v[128:129]
    v_pk_mul_f32 v[242:243], v[210:211], v[130:131]
    v_pk_mul_f32 v[244:245], v[212:213], v[132:133]
    v_pk_mul_f32 v[246:247], v[214:215], v[134:135]
    v_pk_fma_f32 v[216:217], v[200:201], v[136:137], v[216:217] neg_lo:[0,1,0] neg_hi:[0,1,0]
    v_pk_fma_f32 v[232:233], v[184:185], v[136:137], v[232:233]
    v_pk_fma_f32 v[218:219], v[202:203], v[138:139], v[218:219] neg_lo:[0,1,0] neg_hi:[0,1,0]
    v_pk_fma_f32 v[234:235], v[186:187], v[138:139], v[234:235]
    v_pk_fma_f32 v[220:221], v[204:205], v[140:141], v[220:221] neg_lo:[0,1,0] neg_hi:[0,1,0]
    v_pk_fma_f32 v[236:237], v[188:189], v[140:141], v[236:237]
    v_pk_fma_f32 v[222:223], v[206:207], v[142:143], v[222:223] neg_lo:[0,1,0] neg_hi:[0,1,0]
    v_pk_fma_f32 v[238:239], v[190:191], v[142:143], v[238:239]
    v_pk_fma_f32 v[224:225], v[208:209], v[144:145], v[224:225] neg_lo:[0,1,0] neg_hi:[0,1,0]
    v_pk_fma_f32 v[240:241], v[192:193], v[144:145], v[240:241]
    v_pk_fma_f32 v[226:227], v[210:211], v[146:147], v[226:227] neg_lo:[0,1,0] neg_hi:[0,1,0]
    v_pk_fma_f32 v[242:243], v[194:195], v[146:147], v[242:243]
    v_pk_fma_f32 v[228:229], v[212:213], v[148:149], v[228:229] neg_lo:[0,1,0] neg_hi:[0,1,0]
    v_pk_fma_f32 v[244:245], v[196:197], v[148:149], v[244:245]
    v_pk_fma_f32 v[230:231], v[214:215], v[150:151], v[230:231] neg_lo:[0,1,0] neg_hi:[0,1,0]
    v_pk_fma_f32 v[246:247], v[198:199], v[150:151], v[246:247]
    v_cvt_pk_bf16_f32 v16, v216, v217
    v_cvt_pk_bf16_f32 v24, v232, v233
    v_cvt_pk_bf16_f32 v17, v218, v219
    v_cvt_pk_bf16_f32 v25, v234, v235
    v_cvt_pk_bf16_f32 v18, v220, v221
    v_cvt_pk_bf16_f32 v26, v236, v237
    v_cvt_pk_bf16_f32 v19, v222, v223
    v_cvt_pk_bf16_f32 v27, v238, v239
    v_cvt_pk_bf16_f32 v20, v224, v225
    v_cvt_pk_bf16_f32 v28, v240, v241
    v_cvt_pk_bf16_f32 v21, v226, v227
    v_cvt_pk_bf16_f32 v29, v242, v243
    v_cvt_pk_bf16_f32 v22, v228, v229
    v_cvt_pk_bf16_f32 v30, v244, v245
    v_cvt_pk_bf16_f32 v23, v230, v231
    v_cvt_pk_bf16_f32 v31, v246, v247
    v_mfma_f32_32x32x16_bf16 v[184:199], v[16:19], v[72:75], 0
    v_mfma_f32_32x32x16_bf16 v[200:215], v[24:27], v[72:75], 0
    v_mfma_f32_32x32x16_bf16 v[184:199], v[24:27], v[88:91], v[184:199]
    v_mfma_f32_32x32x16_bf16 v[200:215], v[16:19], v[80:83], v[200:215]
    v_mfma_f32_32x32x16_bf16 v[184:199], v[20:23], v[76:79], v[184:199]
    v_mfma_f32_32x32x16_bf16 v[200:215], v[28:31], v[76:79], v[200:215]
    v_mfma_f32_32x32x16_bf16 v[184:199], v[28:31], v[92:95], v[184:199]
    v_mfma_f32_32x32x16_bf16 v[200:215], v[20:23], v[84:87], v[200:215]
    s_nop 10
    s_nop 0
    v_pk_mul_f32 v[216:217], v[184:185], v[152:153]
    v_pk_mul_f32 v[218:219], v[186:187], v[154:155]
    v_pk_mul_f32 v[220:221], v[188:189], v[156:157]
    v_pk_mul_f32 v[222:223], v[190:191], v[158:159]
    v_pk_mul_f32 v[224:225], v[192:193], v[160:161]
    v_pk_mul_f32 v[226:227], v[194:195], v[162:163]
    v_pk_mul_f32 v[228:229], v[196:197], v[164:165]
    v_pk_mul_f32 v[230:231], v[198:199], v[166:167]
    v_pk_mul_f32 v[232:233], v[200:201], v[152:153]
    v_pk_mul_f32 v[234:235], v[202:203], v[154:155]
    v_pk_mul_f32 v[236:237], v[204:205], v[156:157]
    v_pk_mul_f32 v[238:239], v[206:207], v[158:159]
    v_pk_mul_f32 v[240:241], v[208:209], v[160:161]
    v_pk_mul_f32 v[242:243], v[210:211], v[162:163]
    v_pk_mul_f32 v[244:245], v[212:213], v[164:165]
    v_pk_mul_f32 v[246:247], v[214:215], v[166:167]
    v_pk_fma_f32 v[216:217], v[200:201], v[168:169], v[216:217] neg_lo:[0,1,0] neg_hi:[0,1,0]
    v_pk_fma_f32 v[232:233], v[184:185], v[168:169], v[232:233]
    v_pk_fma_f32 v[218:219], v[202:203], v[170:171], v[218:219] neg_lo:[0,1,0] neg_hi:[0,1,0]
    v_pk_fma_f32 v[234:235], v[186:187], v[170:171], v[234:235]
    v_pk_fma_f32 v[220:221], v[204:205], v[172:173], v[220:221] neg_lo:[0,1,0] neg_hi:[0,1,0]
    v_pk_fma_f32 v[236:237], v[188:189], v[172:173], v[236:237]
    v_pk_fma_f32 v[222:223], v[206:207], v[174:175], v[222:223] neg_lo:[0,1,0] neg_hi:[0,1,0]
    v_pk_fma_f32 v[238:239], v[190:191], v[174:175], v[238:239]
    v_pk_fma_f32 v[224:225], v[208:209], v[176:177], v[224:225] neg_lo:[0,1,0] neg_hi:[0,1,0]
    v_pk_fma_f32 v[240:241], v[192:193], v[176:177], v[240:241]
    v_pk_fma_f32 v[226:227], v[210:211], v[178:179], v[226:227] neg_lo:[0,1,0] neg_hi:[0,1,0]
    v_pk_fma_f32 v[242:243], v[194:195], v[178:179], v[242:243]
    v_pk_fma_f32 v[228:229], v[212:213], v[180:181], v[228:229] neg_lo:[0,1,0] neg_hi:[0,1,0]
    v_pk_fma_f32 v[244:245], v[196:197], v[180:181], v[244:245]
    v_pk_fma_f32 v[230:231], v[214:215], v[182:183], v[230:231] neg_lo:[0,1,0] neg_hi:[0,1,0]
    v_pk_fma_f32 v[246:247], v[198:199], v[182:183], v[246:247]
    v_cvt_pk_bf16_f32 v16, v216, v217
    v_cvt_pk_bf16_f32 v24, v232, v233
    v_cvt_pk_bf16_f32 v17, v218, v219
    v_cvt_pk_bf16_f32 v25, v234, v235
    v_cvt_pk_bf16_f32 v18, v220, v221
    v_cvt_pk_bf16_f32 v26, v236, v237
    v_cvt_pk_bf16_f32 v19, v222, v223
    v_cvt_pk_bf16_f32 v27, v238, v239
    v_cvt_pk_bf16_f32 v20, v224, v225
    v_cvt_pk_bf16_f32 v28, v240, v241
    v_cvt_pk_bf16_f32 v21, v226, v227
    v_cvt_pk_bf16_f32 v29, v242, v243
    v_cvt_pk_bf16_f32 v22, v228, v229
    v_cvt_pk_bf16_f32 v30, v244, v245
    v_cvt_pk_bf16_f32 v23, v230, v231
    v_cvt_pk_bf16_f32 v31, v246, v247
    v_mfma_f32_32x32x16_bf16 v[184:199], v[96:99], v[16:19], 0
    v_mfma_f32_32x32x16_bf16 v[200:215], v[96:99], v[24:27], 0
    v_mfma_f32_32x32x16_bf16 v[184:199], v[112:115], v[24:27], v[184:199]
    v_mfma_f32_32x32x16_bf16 v[200:215], v[104:107], v[16:19], v[200:215]
    v_mfma_f32_32x32x16_bf16 v[184:199], v[100:103], v[20:23], v[184:199]
    v_mfma_f32_32x32x16_bf16 v[200:215], v[100:103], v[28:31], v[200:215]
    v_mfma_f32_32x32x16_bf16 v[184:199], v[116:119], v[28:31], v[184:199]
    v_mfma_f32_32x32x16_bf16 v[200:215], v[108:111], v[20:23], v[200:215]
    s_nop 10
    v_cvt_pk_bf16_f32 v216, v184, v185
    v_cvt_pk_bf16_f32 v217, v186, v187
    v_cvt_pk_bf16_f32 v218, v200, v201
    v_cvt_pk_bf16_f32 v219, v202, v203
    s_nop 0
    v_permlane32_swap_b32 v216, v218
    v_permlane32_swap_b32 v217, v219
    buffer_store_dwordx4 v[216:219], v5, s[12:15], s27 offen sc1
    s_add_u32 s27, s27, 655360
    v_cvt_pk_bf16_f32 v220, v188, v189
    v_cvt_pk_bf16_f32 v221, v190, v191
    v_cvt_pk_bf16_f32 v222, v204, v205
    v_cvt_pk_bf16_f32 v223, v206, v207
    s_nop 0
    v_permlane32_swap_b32 v220, v222
    v_permlane32_swap_b32_e64 v221, v223
    buffer_store_dwordx4 v[220:223], v5, s[12:15], s27 offen sc1
    s_add_u32 s27, s27, 655360
    v_cvt_pk_bf16_f32 v224, v192, v193
    v_cvt_pk_bf16_f32 v225, v194, v195
    v_cvt_pk_bf16_f32 v226, v208, v209
    v_cvt_pk_bf16_f32 v227, v210, v211
    s_nop 0
    v_permlane32_swap_b32 v224, v226
    v_permlane32_swap_b32_e64 v225, v227
    buffer_store_dwordx4 v[224:227], v5, s[12:15], s27 offen sc1
    s_add_u32 s27, s27, 655360
    v_cvt_pk_bf16_f32 v228, v196, v197
    v_cvt_pk_bf16_f32 v229, v198, v199
    v_cvt_pk_bf16_f32 v230, v212, v213
    v_cvt_pk_bf16_f32 v231, v214, v215
    s_nop 0
    v_permlane32_swap_b32 v228, v230
    v_permlane32_swap_b32 v229, v231
    buffer_store_dwordx4 v[228:231], v5, s[12:15], s27 offen sc1
    v_and_b32 v2, 15, v1
    v_lshrrev_b32 v3, 4, v1
    v_lshlrev_b32 v4, 4, v1
    s_lshr_b32 s23, s22, 1
    s_lshl_b32 s52, s21, 3
    s_add_u32 s52, s52, s23
    s_and_b32 s53, s22, 1
    s_lshr_b32 s23, s52, 5
    s_lshl_b32 s23, s23, 8
    s_and_b32 s3, s52, 31
    s_add_u32 s23, s23, s3
    s_mul_i32 s23, s23, 1280
    s_and_b32 s36, s20, 1
    s_lshr_b32 s37, s20, 1
    s_lshl_b32 s3, s36, 2
    s_add_u32 s3, s3, s53
    s_mul_i32 s38, s37, 7
    s_xor_b32 s3, s3, s38
    s_mul_i32 s3, s3, 160
    s_add_u32 s23, s23, s3
    s_mul_i32 s38, s37, 3
    v_xor_b32 v5, s38, v3
    v_mul_u32_u24 v5, 40, v5
    v_and_b32 v6, 7, v1
    v_mul_u32_u24 v6, 40960, v6
    v_bfe_u32 v7, v1, 3, 1
    v_mul_u32_u24 v7, 1310720, v7
    v_add3_u32 v5, v5, v6, v7
    v_lshlrev_b32 v6, 2, v2
    s_lshl_b32 s3, s52, 6
    s_add_u32 s3, s3, 12582912
    s_mov_b32 s8, s4
    s_mov_b32 s9, s5
    s_mov_b32 s10, 2621440
    s_mov_b32 s11, 0x20000
    buffer_load_dwordx4 v[148:151], v5, s[8:11], s23 offen
    buffer_load_dwordx4 v[152:155], v5, s[8:11], s23 offen offset:16
    buffer_load_dwordx2 v[156:157], v5, s[8:11], s23 offen offset:32
    buffer_load_dword v158, v6, s[12:15], s3 offen sc1
    s_lshl_b32 s3, s21, 7
    s_add_u32 s3, s3, 98304
    buffer_load_ubyte v159, v2, s[28:31], s3 offen sc1
    v_lshrrev_b32 v5, 2, v2
    v_and_b32 v6, 3, v2
    v_mad_u32_u24 v5, v5, 20, v6
    s_mul_i32 s3, s53, 80
    v_add_u32 v5, s3, v5
    v_cvt_f32_u32 v8, v5
    s_add_u32 s3, s36, 1
    v_lshl_add_u32 v5, v3, 4, s3
    v_cvt_f32_u32 v9, v5
    v_cvt_f32_u32 v10, s37
    v_mul_f32 v10, 0xbe800000, v10
    v_lshrrev_b32 v5, 1, v3
    v_and_b32 v5, v5, v3
    v_and_b32 v5, s36, v5
    v_lshlrev_b32 v5, 23, v5
    v_sub_u32 v11, 1.0, v5
    v_add_f32 v12, 0x3f000000, v8
    v_mul_f32 v12, 0x3acccccd, v12
    v_mul_f32 v5, 0x42800000, v12
    v_cos_f32 v14, v5
    v_fma_f32 v13, v9, v12, v10
    v_add_f32 v14, v14, v14
    v_cos_f32 v132, v13
    v_fmamk_f32 v133, v12, 0x40000000, v13
    v_cos_f32 v133, v133
    v_fmamk_f32 v134, v12, 0x40800000, v13
    v_cos_f32 v134, v134
    v_fmamk_f32 v135, v12, 0x40c00000, v13
    v_cos_f32 v135, v135
    v_fmamk_f32 v136, v12, 0x41000000, v13
    v_cos_f32 v136, v136
    v_fmamk_f32 v137, v12, 0x41200000, v13
    v_cos_f32 v137, v137
    v_fmamk_f32 v138, v12, 0x41400000, v13
    v_cos_f32 v138, v138
    v_fmamk_f32 v139, v12, 0x41600000, v13
    v_cos_f32 v139, v139
    v_fmamk_f32 v140, v12, 0x42800000, v13
    v_cos_f32 v140, v140
    v_fmamk_f32 v141, v12, 0x42840000, v13
    v_cos_f32 v141, v141
    v_fmamk_f32 v142, v12, 0x42880000, v13
    v_cos_f32 v142, v142
    v_fmamk_f32 v143, v12, 0x428c0000, v13
    v_cos_f32 v143, v143
    v_fmamk_f32 v144, v12, 0x42900000, v13
    v_cos_f32 v144, v144
    v_fmamk_f32 v145, v12, 0x42940000, v13
    v_cos_f32 v145, v145
    v_fmamk_f32 v146, v12, 0x42980000, v13
    v_cos_f32 v146, v146
    v_fmamk_f32 v147, v12, 0x429c0000, v13
    v_cos_f32_e64 v147, v147
    v_cvt_pk_bf16_f32 v32, v132, v133
    v_cvt_pk_bf16_f32 v33, v134, v135
    v_cvt_pk_bf16_f32 v34, v136, v137
    v_cvt_pk_bf16_f32 v35, v138, v139
    v_cvt_pk_bf16_f32 v36, v140, v141
    v_cvt_pk_bf16_f32 v37, v142, v143
    v_cvt_pk_bf16_f32 v38, v144, v145
    v_cvt_pk_bf16_f32 v39, v146, v147
    v_pk_fma_f32 v[132:133], v[14:15], v[140:141], v[132:133] op_sel_hi:[0,1,1] neg_lo:[0,0,1] neg_hi:[0,0,1]
    v_pk_fma_f32 v[134:135], v[14:15], v[142:143], v[134:135] op_sel_hi:[0,1,1] neg_lo:[0,0,1] neg_hi:[0,0,1]
    v_pk_fma_f32 v[136:137], v[14:15], v[144:145], v[136:137] op_sel_hi:[0,1,1] neg_lo:[0,0,1] neg_hi:[0,0,1]
    v_pk_fma_f32 v[138:139], v[14:15], v[146:147], v[138:139] op_sel_hi:[0,1,1] neg_lo:[0,0,1] neg_hi:[0,0,1]
    v_cvt_pk_bf16_f32 v40, v132, v133
    v_cvt_pk_bf16_f32 v41, v134, v135
    v_cvt_pk_bf16_f32 v42, v136, v137
    v_cvt_pk_bf16_f32 v43, v138, v139
    v_pk_fma_f32 v[140:141], v[14:15], v[132:133], v[140:141] op_sel_hi:[0,1,1] neg_lo:[0,0,1] neg_hi:[0,0,1]
    v_pk_fma_f32 v[142:143], v[14:15], v[134:135], v[142:143] op_sel_hi:[0,1,1] neg_lo:[0,0,1] neg_hi:[0,0,1]
    v_pk_fma_f32 v[144:145], v[14:15], v[136:137], v[144:145] op_sel_hi:[0,1,1] neg_lo:[0,0,1] neg_hi:[0,0,1]
    v_pk_fma_f32 v[146:147], v[14:15], v[138:139], v[146:147] op_sel_hi:[0,1,1] neg_lo:[0,0,1] neg_hi:[0,0,1]
    v_cvt_pk_bf16_f32 v44, v140, v141
    v_cvt_pk_bf16_f32 v45, v142, v143
    v_cvt_pk_bf16_f32 v46, v144, v145
    v_cvt_pk_bf16_f32 v47, v146, v147
    v_pk_fma_f32 v[132:133], v[14:15], v[140:141], v[132:133] op_sel_hi:[0,1,1] neg_lo:[0,0,1] neg_hi:[0,0,1]
    v_pk_fma_f32 v[134:135], v[14:15], v[142:143], v[134:135] op_sel_hi:[0,1,1] neg_lo:[0,0,1] neg_hi:[0,0,1]
    v_pk_fma_f32 v[136:137], v[14:15], v[144:145], v[136:137] op_sel_hi:[0,1,1] neg_lo:[0,0,1] neg_hi:[0,0,1]
    v_pk_fma_f32 v[138:139], v[14:15], v[146:147], v[138:139] op_sel_hi:[0,1,1] neg_lo:[0,0,1] neg_hi:[0,0,1]
    v_mul_f32_e64 v139, v139, v11
    v_cvt_pk_bf16_f32 v48, v132, v133
    v_cvt_pk_bf16_f32 v49, v134, v135
    v_cvt_pk_bf16_f32 v50, v136, v137
    v_cvt_pk_bf16_f32 v51, v138, v139
    v_add_f32 v12, 0x40900000, v8
    v_mul_f32 v12, 0x3acccccd, v12
    v_mul_f32 v5, 0x42800000, v12
    v_cos_f32 v14, v5
    v_fma_f32 v13, v9, v12, v10
    v_add_f32 v14, v14, v14
    v_cos_f32 v132, v13
    v_fmamk_f32 v133, v12, 0x40000000, v13
    v_cos_f32 v133, v133
    v_fmamk_f32 v134, v12, 0x40800000, v13
    v_cos_f32 v134, v134
    v_fmamk_f32 v135, v12, 0x40c00000, v13
    v_cos_f32 v135, v135
    v_fmamk_f32 v136, v12, 0x41000000, v13
    v_cos_f32 v136, v136
    v_fmamk_f32 v137, v12, 0x41200000, v13
    v_cos_f32 v137, v137
    v_fmamk_f32 v138, v12, 0x41400000, v13
    v_cos_f32 v138, v138
    v_fmamk_f32 v139, v12, 0x41600000, v13
    v_cos_f32 v139, v139
    v_fmamk_f32 v140, v12, 0x42800000, v13
    v_cos_f32 v140, v140
    v_fmamk_f32 v141, v12, 0x42840000, v13
    v_cos_f32 v141, v141
    v_fmamk_f32 v142, v12, 0x42880000, v13
    v_cos_f32 v142, v142
    v_fmamk_f32 v143, v12, 0x428c0000, v13
    v_cos_f32 v143, v143
    v_fmamk_f32 v144, v12, 0x42900000, v13
    v_cos_f32 v144, v144
    v_fmamk_f32 v145, v12, 0x42940000, v13
    v_cos_f32 v145, v145
    v_fmamk_f32 v146, v12, 0x42980000, v13
    v_cos_f32 v146, v146
    v_fmamk_f32 v147, v12, 0x429c0000, v13
    v_cos_f32 v147, v147
    v_cvt_pk_bf16_f32 v52, v132, v133
    v_cvt_pk_bf16_f32 v53, v134, v135
    v_cvt_pk_bf16_f32 v54, v136, v137
    v_cvt_pk_bf16_f32 v55, v138, v139
    v_cvt_pk_bf16_f32 v56, v140, v141
    v_cvt_pk_bf16_f32 v57, v142, v143
    v_cvt_pk_bf16_f32 v58, v144, v145
    v_cvt_pk_bf16_f32 v59, v146, v147
    v_pk_fma_f32 v[132:133], v[14:15], v[140:141], v[132:133] op_sel_hi:[0,1,1] neg_lo:[0,0,1] neg_hi:[0,0,1]
    v_pk_fma_f32 v[134:135], v[14:15], v[142:143], v[134:135] op_sel_hi:[0,1,1] neg_lo:[0,0,1] neg_hi:[0,0,1]
    v_pk_fma_f32 v[136:137], v[14:15], v[144:145], v[136:137] op_sel_hi:[0,1,1] neg_lo:[0,0,1] neg_hi:[0,0,1]
    v_pk_fma_f32 v[138:139], v[14:15], v[146:147], v[138:139] op_sel_hi:[0,1,1] neg_lo:[0,0,1] neg_hi:[0,0,1]
    v_cvt_pk_bf16_f32 v60, v132, v133
    v_cvt_pk_bf16_f32 v61, v134, v135
    v_cvt_pk_bf16_f32 v62, v136, v137
    v_cvt_pk_bf16_f32 v63, v138, v139
    v_pk_fma_f32 v[140:141], v[14:15], v[132:133], v[140:141] op_sel_hi:[0,1,1] neg_lo:[0,0,1] neg_hi:[0,0,1]
    v_pk_fma_f32 v[142:143], v[14:15], v[134:135], v[142:143] op_sel_hi:[0,1,1] neg_lo:[0,0,1] neg_hi:[0,0,1]
    v_pk_fma_f32 v[144:145], v[14:15], v[136:137], v[144:145] op_sel_hi:[0,1,1] neg_lo:[0,0,1] neg_hi:[0,0,1]
    v_pk_fma_f32 v[146:147], v[14:15], v[138:139], v[146:147] op_sel_hi:[0,1,1] neg_lo:[0,0,1] neg_hi:[0,0,1]
    v_cvt_pk_bf16_f32 v64, v140, v141
    v_cvt_pk_bf16_f32 v65, v142, v143
    v_cvt_pk_bf16_f32 v66, v144, v145
    v_cvt_pk_bf16_f32 v67, v146, v147
    v_pk_fma_f32 v[132:133], v[14:15], v[140:141], v[132:133] op_sel_hi:[0,1,1] neg_lo:[0,0,1] neg_hi:[0,0,1]
    v_pk_fma_f32 v[134:135], v[14:15], v[142:143], v[134:135] op_sel_hi:[0,1,1] neg_lo:[0,0,1] neg_hi:[0,0,1]
    v_pk_fma_f32 v[136:137], v[14:15], v[144:145], v[136:137] op_sel_hi:[0,1,1] neg_lo:[0,0,1] neg_hi:[0,0,1]
    v_pk_fma_f32 v[138:139], v[14:15], v[146:147], v[138:139] op_sel_hi:[0,1,1] neg_lo:[0,0,1] neg_hi:[0,0,1]
    v_mul_f32 v139, v139, v11
    v_cvt_pk_bf16_f32 v68, v132, v133
    v_cvt_pk_bf16_f32 v69, v134, v135
    v_cvt_pk_bf16_f32 v70, v136, v137
    v_cvt_pk_bf16_f32 v71, v138, v139
    s_waitcnt vmcnt(5)
    s_barrier
    v_add_f32 v12, 0x41080000, v8
    v_mul_f32 v12, 0x3acccccd, v12
    v_mul_f32 v5, 0x42800000, v12
    v_cos_f32 v14, v5
    v_fma_f32 v13, v9, v12, v10
    v_add_f32 v14, v14, v14
    v_cos_f32 v132, v13
    v_fmamk_f32 v133, v12, 0x40000000, v13
    v_cos_f32 v133, v133
    v_fmamk_f32 v134, v12, 0x40800000, v13
    v_cos_f32 v134, v134
    v_fmamk_f32 v135, v12, 0x40c00000, v13
    buffer_load_dwordx4 v251, s[40:43], s61 offen offset:1024 sc1 lds
    v_cos_f32 v135, v135
    v_fmamk_f32 v136, v12, 0x41000000, v13
    v_cos_f32 v136, v136
    v_fmamk_f32 v137, v12, 0x41200000, v13
    v_cos_f32 v137, v137
    v_fmamk_f32 v138, v12, 0x41400000, v13
    v_cos_f32 v138, v138
    v_fmamk_f32 v139, v12, 0x41600000, v13
    v_cos_f32 v139, v139
    v_fmamk_f32 v140, v12, 0x42800000, v13
    v_cos_f32 v140, v140
    s_add_u32 s61, s59, 98304
    buffer_load_dwordx4 v251, s[40:43], s61 offen offset:2048 sc1 lds
    v_fmamk_f32 v141, v12, 0x42840000, v13
    v_cos_f32 v141, v141
    v_fmamk_f32 v142, v12, 0x42880000, v13
    v_cos_f32 v142, v142
    v_fmamk_f32 v143, v12, 0x428c0000, v13
    v_cos_f32 v143, v143
    v_fmamk_f32 v144, v12, 0x42900000, v13
    v_cos_f32 v144, v144
    v_fmamk_f32 v145, v12, 0x42940000, v13
    v_cos_f32 v145, v145
    v_fmamk_f32 v146, v12, 0x42980000, v13
    s_add_u32 m0, s58, 9216
    s_add_u32 s61, s56, 147456
    buffer_load_dwordx4 v251, s[40:43], s61 offen offset:0 sc1 lds
    v_cos_f32 v146, v146
    v_fmamk_f32 v147, v12, 0x429c0000, v13
    v_cos_f32_e64 v147, v147
    v_cvt_pk_bf16_f32 v72, v132, v133
    v_cvt_pk_bf16_f32 v73, v134, v135
    v_cvt_pk_bf16_f32 v74, v136, v137
    v_cvt_pk_bf16_f32 v75, v138, v139
    v_cvt_pk_bf16_f32 v76, v140, v141
    v_cvt_pk_bf16_f32 v77, v142, v143
    v_cvt_pk_bf16_f32 v78, v144, v145
    v_cvt_pk_bf16_f32 v79, v146, v147
    v_pk_fma_f32 v[132:133], v[14:15], v[140:141], v[132:133] op_sel_hi:[0,1,1] neg_lo:[0,0,1] neg_hi:[0,0,1]
    v_pk_fma_f32 v[134:135], v[14:15], v[142:143], v[134:135] op_sel_hi:[0,1,1] neg_lo:[0,0,1] neg_hi:[0,0,1]
    v_pk_fma_f32 v[136:137], v[14:15], v[144:145], v[136:137] op_sel_hi:[0,1,1] neg_lo:[0,0,1] neg_hi:[0,0,1]
    buffer_load_dwordx4 v251, s[40:43], s61 offen offset:1024 sc1 lds
    v_pk_fma_f32 v[138:139], v[14:15], v[146:147], v[138:139] op_sel_hi:[0,1,1] neg_lo:[0,0,1] neg_hi:[0,0,1]
    v_cvt_pk_bf16_f32 v80, v132, v133
    v_cvt_pk_bf16_f32 v81, v134, v135
    v_cvt_pk_bf16_f32 v82, v136, v137
    v_cvt_pk_bf16_f32 v83, v138, v139
    v_pk_fma_f32 v[140:141], v[14:15], v[132:133], v[140:141] op_sel_hi:[0,1,1] neg_lo:[0,0,1] neg_hi:[0,0,1]
    v_pk_fma_f32 v[142:143], v[14:15], v[134:135], v[142:143] op_sel_hi:[0,1,1] neg_lo:[0,0,1] neg_hi:[0,0,1]
    v_pk_fma_f32 v[144:145], v[14:15], v[136:137], v[144:145] op_sel_hi:[0,1,1] neg_lo:[0,0,1] neg_hi:[0,0,1]
    v_pk_fma_f32 v[146:147], v[14:15], v[138:139], v[146:147] op_sel_hi:[0,1,1] neg_lo:[0,0,1] neg_hi:[0,0,1]
    v_cvt_pk_bf16_f32 v84, v140, v141
    v_cvt_pk_bf16_f32 v85, v142, v143
    v_cvt_pk_bf16_f32 v86, v144, v145
    v_cvt_pk_bf16_f32 v87, v146, v147
    v_pk_fma_f32 v[132:133], v[14:15], v[140:141], v[132:133] op_sel_hi:[0,1,1] neg_lo:[0,0,1] neg_hi:[0,0,1]
    v_pk_fma_f32 v[134:135], v[14:15], v[142:143], v[134:135] op_sel_hi:[0,1,1] neg_lo:[0,0,1] neg_hi:[0,0,1]
    v_pk_fma_f32 v[136:137], v[14:15], v[144:145], v[136:137] op_sel_hi:[0,1,1] neg_lo:[0,0,1] neg_hi:[0,0,1]
    s_add_u32 s61, s59, 147456
    buffer_load_dwordx4 v251, s[40:43], s61 offen offset:2048 sc1 lds
    v_pk_fma_f32 v[138:139], v[14:15], v[146:147], v[138:139] op_sel_hi:[0,1,1] neg_lo:[0,0,1] neg_hi:[0,0,1]
    v_mul_f32_e64 v139, v139, v11
    v_cvt_pk_bf16_f32 v88, v132, v133
    v_cvt_pk_bf16_f32 v89, v134, v135
    v_cvt_pk_bf16_f32 v90, v136, v137
    v_cvt_pk_bf16_f32 v91, v138, v139
    v_add_f32 v12, 0x41480000, v8
    v_mul_f32 v12, 0x3acccccd, v12
    v_mul_f32 v5, 0x42800000, v12
    v_cos_f32 v14, v5
    v_fma_f32 v13, v9, v12, v10
    v_add_f32 v14, v14, v14
    v_cos_f32 v132, v13
    v_fmamk_f32 v133, v12, 0x40000000, v13
    s_add_u32 m0, s58, 12288
    s_add_u32 s61, s56, 196608
    buffer_load_dwordx4 v251, s[40:43], s61 offen offset:0 sc1 lds
    v_cos_f32 v133, v133
    v_fmamk_f32 v134, v12, 0x40800000, v13
    v_cos_f32 v134, v134
    v_fmamk_f32 v135, v12, 0x40c00000, v13
    v_cos_f32 v135, v135
    v_fmamk_f32 v136, v12, 0x41000000, v13
    v_cos_f32 v136, v136
    v_fmamk_f32 v137, v12, 0x41200000, v13
    v_cos_f32 v137, v137
    v_fmamk_f32 v138, v12, 0x41400000, v13
    v_cos_f32 v138, v138
    buffer_load_dwordx4 v251, s[40:43], s61 offen offset:1024 sc1 lds
    v_fmamk_f32 v139, v12, 0x41600000, v13
    v_cos_f32 v139, v139
    v_fmamk_f32 v140, v12, 0x42800000, v13
    v_cos_f32 v140, v140
    v_fmamk_f32 v141, v12, 0x42840000, v13
    v_cos_f32 v141, v141
    v_fmamk_f32 v142, v12, 0x42880000, v13
    v_cos_f32 v142, v142
    v_fmamk_f32 v143, v12, 0x428c0000, v13
    v_cos_f32 v143, v143
    v_fmamk_f32 v144, v12, 0x42900000, v13
    s_add_u32 s61, s59, 196608
    buffer_load_dwordx4 v251, s[40:43], s61 offen offset:2048 sc1 lds
    v_cos_f32 v144, v144
    v_fmamk_f32 v145, v12, 0x42940000, v13
    v_cos_f32 v145, v145
    v_fmamk_f32 v146, v12, 0x42980000, v13
    v_cos_f32 v146, v146
    v_fmamk_f32 v147, v12, 0x429c0000, v13
    v_cos_f32 v147, v147
    v_cvt_pk_bf16_f32 v92, v132, v133
    v_cvt_pk_bf16_f32 v93, v134, v135
    v_cvt_pk_bf16_f32 v94, v136, v137
    v_cvt_pk_bf16_f32 v95, v138, v139
    v_cvt_pk_bf16_f32 v96, v140, v141
    s_add_u32 s63, s62, 0
    s_nop 0
    buffer_load_dwordx4 a[0:3], v251, s[40:43], s63 offen offset:0 sc1
    v_cvt_pk_bf16_f32 v97, v142, v143
    v_cvt_pk_bf16_f32 v98, v144, v145
    v_cvt_pk_bf16_f32 v99, v146, v147
    v_pk_fma_f32 v[132:133], v[14:15], v[140:141], v[132:133] op_sel_hi:[0,1,1] neg_lo:[0,0,1] neg_hi:[0,0,1]
    v_pk_fma_f32 v[134:135], v[14:15], v[142:143], v[134:135] op_sel_hi:[0,1,1] neg_lo:[0,0,1] neg_hi:[0,0,1]
    v_pk_fma_f32 v[136:137], v[14:15], v[144:145], v[136:137] op_sel_hi:[0,1,1] neg_lo:[0,0,1] neg_hi:[0,0,1]
    v_pk_fma_f32 v[138:139], v[14:15], v[146:147], v[138:139] op_sel_hi:[0,1,1] neg_lo:[0,0,1] neg_hi:[0,0,1]
    v_cvt_pk_bf16_f32 v100, v132, v133
    v_cvt_pk_bf16_f32 v101, v134, v135
    v_cvt_pk_bf16_f32 v102, v136, v137
    v_cvt_pk_bf16_f32 v103, v138, v139
    v_pk_fma_f32 v[140:141], v[14:15], v[132:133], v[140:141] op_sel_hi:[0,1,1] neg_lo:[0,0,1] neg_hi:[0,0,1]
    v_pk_fma_f32 v[142:143], v[14:15], v[134:135], v[142:143] op_sel_hi:[0,1,1] neg_lo:[0,0,1] neg_hi:[0,0,1]
    v_pk_fma_f32 v[144:145], v[14:15], v[136:137], v[144:145] op_sel_hi:[0,1,1] neg_lo:[0,0,1] neg_hi:[0,0,1]
    v_pk_fma_f32 v[146:147], v[14:15], v[138:139], v[146:147] op_sel_hi:[0,1,1] neg_lo:[0,0,1] neg_hi:[0,0,1]
    v_cvt_pk_bf16_f32 v104, v140, v141
    buffer_load_dwordx4 a[4:7], v251, s[40:43], s63 offen offset:1024 sc1
    v_cvt_pk_bf16_f32 v105, v142, v143
    v_cvt_pk_bf16_f32 v106, v144, v145
    v_cvt_pk_bf16_f32 v107, v146, v147
    v_pk_fma_f32 v[132:133], v[14:15], v[140:141], v[132:133] op_sel_hi:[0,1,1] neg_lo:[0,0,1] neg_hi:[0,0,1]
    v_pk_fma_f32 v[134:135], v[14:15], v[142:143], v[134:135] op_sel_hi:[0,1,1] neg_lo:[0,0,1] neg_hi:[0,0,1]
    v_pk_fma_f32 v[136:137], v[14:15], v[144:145], v[136:137] op_sel_hi:[0,1,1] neg_lo:[0,0,1] neg_hi:[0,0,1]
    v_pk_fma_f32 v[138:139], v[14:15], v[146:147], v[138:139] op_sel_hi:[0,1,1] neg_lo:[0,0,1] neg_hi:[0,0,1]
    v_mul_f32_e64 v139, v139, v11
    v_cvt_pk_bf16_f32 v108, v132, v133
    v_cvt_pk_bf16_f32 v109, v134, v135
    v_cvt_pk_bf16_f32 v110, v136, v137
    v_cvt_pk_bf16_f32 v111, v138, v139
    v_add_f32 v12, 0x41840000, v8
    v_mul_f32 v12, 0x3acccccd, v12
    v_mul_f32 v5, 0x42800000, v12
    v_cos_f32 v14, v5
    buffer_load_dwordx4 a[8:11], v251, s[40:43], s63 offen offset:2048 sc1
    v_fma_f32 v13, v9, v12, v10
    v_add_f32 v14, v14, v14
    v_cos_f32 v132, v13
    v_fmamk_f32 v133, v12, 0x40000000, v13
    v_cos_f32 v133, v133
    v_fmamk_f32 v134, v12, 0x40800000, v13
    v_cos_f32 v134, v134
    v_fmamk_f32 v135, v12, 0x40c00000, v13
    v_cos_f32 v135, v135
    v_fmamk_f32 v136, v12, 0x41000000, v13
    v_cos_f32 v136, v136
    buffer_load_dwordx4 a[12:15], v251, s[40:43], s63 offen offset:3072 sc1
    v_fmamk_f32 v137, v12, 0x41200000, v13
    v_cos_f32 v137, v137
    v_fmamk_f32 v138, v12, 0x41400000, v13
    v_cos_f32 v138, v138
    v_fmamk_f32 v139, v12, 0x41600000, v13
    v_cos_f32 v139, v139
    v_fmamk_f32 v140, v12, 0x42800000, v13
    v_cos_f32 v140, v140
    v_fmamk_f32 v141, v12, 0x42840000, v13
    v_cos_f32 v141, v141
    v_fmamk_f32 v142, v12, 0x42880000, v13
    s_add_u32 s63, s63, 4096
    buffer_load_dwordx4 a[16:19], v251, s[40:43], s63 offen offset:0 sc1
    v_cos_f32 v142, v142
    v_fmamk_f32 v143, v12, 0x428c0000, v13
    v_cos_f32 v143, v143
    v_fmamk_f32 v144, v12, 0x42900000, v13
    v_cos_f32 v144, v144
    v_fmamk_f32 v145, v12, 0x42940000, v13
    v_cos_f32 v145, v145
    v_fmamk_f32 v146, v12, 0x42980000, v13
    v_cos_f32 v146, v146
    v_fmamk_f32 v147, v12, 0x429c0000, v13
    v_cos_f32 v147, v147
    s_add_u32 s63, s62, 40960
    buffer_load_dwordx4 a[20:23], v251, s[40:43], s63 offen offset:0 sc1
    v_cvt_pk_bf16_f32 v112, v132, v133
    v_cvt_pk_bf16_f32 v113, v134, v135
    v_cvt_pk_bf16_f32 v114, v136, v137
    v_cvt_pk_bf16_f32 v115, v138, v139
    v_cvt_pk_bf16_f32 v116, v140, v141
    v_cvt_pk_bf16_f32 v117, v142, v143
    v_cvt_pk_bf16_f32 v118, v144, v145
    v_cvt_pk_bf16_f32 v119, v146, v147
    v_pk_fma_f32 v[132:133], v[14:15], v[140:141], v[132:133] op_sel_hi:[0,1,1] neg_lo:[0,0,1] neg_hi:[0,0,1]
    v_pk_fma_f32 v[134:135], v[14:15], v[142:143], v[134:135] op_sel_hi:[0,1,1] neg_lo:[0,0,1] neg_hi:[0,0,1]
    v_pk_fma_f32 v[136:137], v[14:15], v[144:145], v[136:137] op_sel_hi:[0,1,1] neg_lo:[0,0,1] neg_hi:[0,0,1]
    v_pk_fma_f32 v[138:139], v[14:15], v[146:147], v[138:139] op_sel_hi:[0,1,1] neg_lo:[0,0,1] neg_hi:[0,0,1]
    v_cvt_pk_bf16_f32 v120, v132, v133
    v_cvt_pk_bf16_f32 v121, v134, v135
    v_cvt_pk_bf16_f32 v122, v136, v137
    v_cvt_pk_bf16_f32 v123, v138, v139
    buffer_load_dwordx4 a[24:27], v251, s[40:43], s63 offen offset:1024 sc1
    v_pk_fma_f32 v[140:141], v[14:15], v[132:133], v[140:141] op_sel_hi:[0,1,1] neg_lo:[0,0,1] neg_hi:[0,0,1]
    v_pk_fma_f32 v[142:143], v[14:15], v[134:135], v[142:143] op_sel_hi:[0,1,1] neg_lo:[0,0,1] neg_hi:[0,0,1]
    v_pk_fma_f32 v[144:145], v[14:15], v[136:137], v[144:145] op_sel_hi:[0,1,1] neg_lo:[0,0,1] neg_hi:[0,0,1]
    v_pk_fma_f32 v[146:147], v[14:15], v[138:139], v[146:147] op_sel_hi:[0,1,1] neg_lo:[0,0,1] neg_hi:[0,0,1]
    v_cvt_pk_bf16_f32 v124, v140, v141
    v_cvt_pk_bf16_f32 v125, v142, v143
    v_cvt_pk_bf16_f32 v126, v144, v145
    v_cvt_pk_bf16_f32 v127, v146, v147
    v_pk_fma_f32 v[132:133], v[14:15], v[140:141], v[132:133] op_sel_hi:[0,1,1] neg_lo:[0,0,1] neg_hi:[0,0,1]
    v_pk_fma_f32 v[134:135], v[14:15], v[142:143], v[134:135] op_sel_hi:[0,1,1] neg_lo:[0,0,1] neg_hi:[0,0,1]
    v_pk_fma_f32 v[136:137], v[14:15], v[144:145], v[136:137] op_sel_hi:[0,1,1] neg_lo:[0,0,1] neg_hi:[0,0,1]
    v_pk_fma_f32 v[138:139], v[14:15], v[146:147], v[138:139] op_sel_hi:[0,1,1] neg_lo:[0,0,1] neg_hi:[0,0,1]
    v_mul_f32 v139, v139, v11
    v_cvt_pk_bf16_f32 v128, v132, v133
    v_cvt_pk_bf16_f32 v129, v134, v135
    v_cvt_pk_bf16_f32 v130, v136, v137
    buffer_load_dwordx4 a[28:31], v251, s[40:43], s63 offen offset:2048 sc1
    v_cvt_pk_bf16_f32 v131, v138, v139
    buffer_load_dwordx4 a[32:35], v251, s[40:43], s63 offen offset:3072 sc1
    s_add_u32 s63, s63, 4096
    buffer_load_dwordx4 a[36:39], v251, s[40:43], s63 offen offset:0 sc1
    s_add_u32 s63, s62, 81920
    buffer_load_dwordx4 a[40:43], v251, s[40:43], s63 offen offset:0 sc1
    buffer_load_dwordx4 a[44:47], v251, s[40:43], s63 offen offset:1024 sc1
    v_lshrrev_b32 v5, 2, v1
    v_lshlrev_b32 v5, 8, v5
    v_bfe_u32 v6, v1, 1, 1
    v_lshl_add_u32 v5, v6, 6, v5
    v_lshrrev_b32 v6, 5, v1
    v_xor_b32 v6, v6, v1
    v_and_b32 v6, 1, v6
    v_lshl_add_u32 v5, v6, 4, v5
    s_lshr_b32 s23, s52, 1
    s_lshl_b32 s23, s23, 1
    s_add_u32 s23, s23, s37
    s_mul_i32 s23, s23, 20480
    s_lshl_b32 s3, s36, 7
    s_add_u32 s23, s23, s3
    s_and_b32 s3, s52, 1
    s_lshl_b32 s3, s3, 5
    s_add_u32 s23, s23, s3
    s_add_u32 s23, s23, 13631488
    s_mul_i32 s38, s36, 10240
    s_add_u32 s38, s38, 143360
    s_mul_i32 s39, s37, 5120
    s_add_u32 s39, s39, s38
    v_lshl_add_u32 v6, v3, 9, s38
    v_lshrrev_b32 v7, 2, v2
    v_lshl_add_u32 v6, v7, 6, v6
    v_bfe_u32 v7, v1, 1, 1
    v_lshl_add_u32 v6, v7, 5, v6
    v_and_b32 v7, 1, v1
    v_lshl_add_u32 v6, v7, 3, v6
    v_xor_b32 v7, s37, v3
    v_and_b32 v7, 1, v7
    v_lshl_add_u32 v6, v7, 4, v6
    v_lshlrev_b32 v15, 28, v1
    v_and_b32 v15, 0x80000000, v15
    v_xor_b32 v12, 0x35cccccd, v15
    v_or_b32 v15, 1.0, v15
    s_lshl_b32 s3, s20, 2
    s_lshr_b32 s3, 41068, s3
    s_lshl_b32 s44, s3, 31
    s_and_b32 s44, s44, 0x80000000
    v_xor_b32 v220, s44, v12
    s_xor_b32 s44, s20, 0
    s_mul_i32 s44, s44, 5120
    s_add_u32 s44, s44, 143360
    v_add_u32 v7, s44, v4
    s_lshl_b32 s44, s3, 30
    s_and_b32 s44, s44, 0x80000000
    v_xor_b32 v222, s44, v12
    s_xor_b32 s44, s20, 1
    s_mul_i32 s44, s44, 5120
    s_add_u32 s44, s44, 143360
    v_add_u32 v8, s44, v4
    s_lshl_b32 s44, s3, 29
    s_and_b32 s44, s44, 0x80000000
    v_xor_b32 v224, s44, v12
    s_xor_b32 s44, s20, 2
    s_mul_i32 s44, s44, 5120
    s_add_u32 s44, s44, 143360
    v_add_u32 v9, s44, v4
    s_lshl_b32 s44, s3, 28
    s_and_b32 s44, s44, 0x80000000
    v_xor_b32 v226, s44, v12
    s_xor_b32 s44, s20, 3
    s_mul_i32 s44, s44, 5120
    s_add_u32 s44, s44, 143360
    v_add_u32 v10, s44, v4
    s_mov_b32 s3, 0xffff0000
    s_waitcnt vmcnt(20)
    s_cmp_ge_u32 s20, 2
    s_cbranch_scc1 P2_x_d
    v_lshlrev_b32 v160, 16, v148
    v_and_b32 v161, s3, v148
    v_lshlrev_b32 v162, 16, v149
    v_and_b32 v163, s3, v149
    v_lshlrev_b32 v164, 16, v150
    v_and_b32 v165, s3, v150
    v_lshlrev_b32 v166, 16, v151
    v_and_b32 v167, s3, v151
    v_lshlrev_b32 v168, 16, v152
    v_and_b32 v169, s3, v152
    v_lshlrev_b32 v170, 16, v153
    v_and_b32 v171, s3, v153
    v_lshlrev_b32 v172, 16, v154
    v_and_b32 v173, s3, v154
    v_lshlrev_b32 v174, 16, v155
    v_and_b32 v175, s3, v155
    v_lshlrev_b32 v176, 16, v156
    v_and_b32 v177, s3, v156
    v_lshlrev_b32 v178, 16, v157
    v_and_b32 v179, s3, v157
    s_branch P2_x_j
P2_x_d:
    v_lshlrev_b32 v179, 16, v148
    v_and_b32 v178, s3, v148
    v_lshlrev_b32 v177, 16, v149
    v_and_b32 v176, s3, v149
    v_lshlrev_b32 v175, 16, v150
    v_and_b32 v174, s3, v150
    v_lshlrev_b32 v173, 16, v151
    v_and_b32 v172, s3, v151
    v_lshlrev_b32 v171, 16, v152
    v_and_b32 v170, s3, v152
    v_lshlrev_b32 v169, 16, v153
    v_and_b32 v168, s3, v153
    v_lshlrev_b32 v167, 16, v154
    v_and_b32 v166, s3, v154
    v_lshlrev_b32 v165, 16, v155
    v_and_b32 v164, s3, v155
    v_lshlrev_b32 v163, 16, v156
    v_and_b32 v162, s3, v156
    v_lshlrev_b32 v161, 16, v157
    v_and_b32 v160, s3, v157
P2_x_j:
    v_pk_add_f32 v[160:161], v[160:161], v[158:159] op_sel_hi:[1,0]
    v_pk_add_f32 v[162:163], v[162:163], v[158:159] op_sel_hi:[1,0]
    v_pk_add_f32 v[164:165], v[164:165], v[158:159] op_sel_hi:[1,0]
    v_pk_add_f32 v[166:167], v[166:167], v[158:159] op_sel_hi:[1,0]
    v_pk_add_f32 v[168:169], v[168:169], v[158:159] op_sel_hi:[1,0]
    v_pk_add_f32 v[170:171], v[170:171], v[158:159] op_sel_hi:[1,0]
    v_pk_add_f32 v[172:173], v[172:173], v[158:159] op_sel_hi:[1,0]
    v_pk_add_f32 v[174:175], v[174:175], v[158:159] op_sel_hi:[1,0]
    v_pk_add_f32 v[176:177], v[176:177], v[158:159] op_sel_hi:[1,0]
    v_pk_add_f32 v[178:179], v[178:179], v[158:159] op_sel_hi:[1,0]
    s_getreg_b32 s3, hwreg(HW_REG_XCC_ID, 0, 4)
    s_add_u32 s3, s3, 1
    v_cmp_ne_u32 vcc, s3, v159
    s_nop 0
    s_or_b64 vcc, vcc, vcc
    s_cselect_b32 s51, 0, 1
    s_branch P2_join
P2_free:
    s_mov_b32 s8, s18
    s_mov_b32 s9, s19
    s_mov_b32 s10, 256
    s_mov_b32 s11, 0x20000
    s_mov_b32 s50, 0x20000
    v_mov_b32 v252, 0
    s_mov_b64 exec, 1
P2_a1_rd:
    buffer_load_dword v253, v252, s[8:11], 0 offen sc1
    s_sub_u32 s50, s50, 1
    s_cbranch_scc1 P2_a1_rx
    s_waitcnt vmcnt(0)
    v_cmp_eq_u32 vcc, 0, v253
    s_cbranch_vccnz P2_a1_rd
P2_a1_rx:
    s_mov_b64 exec, -1
    s_waitcnt vmcnt(0)
    s_bfe_u32 s44, s2, 0x30003
    s_lshl_b32 s44, s44, 8
    s_add_u32 s44, s44, 65536
    s_and_b32 s45, s2, 15
    s_lshl_b32 s45, s45, 11
    s_add_u32 s45, s45, 65536
    v_lshlrev_b32 v252, 11, v1
    v_lshlrev_b32 v253, 8, v1
    v_mov_b32 v254, 1
    s_waitcnt vmcnt(0)
    s_barrier
    s_cmp_lg_u32 s20, 3
    s_cbranch_scc1 P2_a1_na
    s_mov_b64 exec, 0xffff
    buffer_atomic_add v254, v252, s[28:31], s44 offen sc1
    s_mov_b64 exec, -1
P2_a1_na:
    s_add_u32 m0, s57, 0
    s_nop 0
    buffer_load_dwordx4 v248, s[32:35], s55 offen lds
    s_add_u32 m0, s57, 1024
    s_mul_i32 s61, s54, 40
    s_add_u32 s61, s61, s55
    buffer_load_dwordx4 v248, s[32:35], s61 offen lds
    s_add_u32 m0, s57, 2048
    s_mul_i32 s61, s54, 320
    s_add_u32 s61, s61, s55
    buffer_load_dwordx4 v248, s[32:35], s61 offen lds
    s_add_u32 m0, s57, 3072
    s_mul_i32 s61, s54, 360
    s_add_u32 s61, s61, s55
    buffer_load_dwordx4 v248, s[32:35], s61 offen lds
    s_add_u32 m0, s57, 4096
    s_mul_i32 s61, s54, 4
    s_add_u32 s61, s61, s55
    buffer_load_dwordx4 v248, s[32:35], s61 offen lds
    s_add_u32 m0, s57, 5120
    s_mul_i32 s61, s54, 44
    s_add_u32 s61, s61, s55
    buffer_load_dwordx4 v248, s[32:35], s61 offen lds
    s_add_u32 m0, s57, 6144
    s_mul_i32 s61, s54, 324
    s_add_u32 s61, s61, s55
    buffer_load_dwordx4 v248, s[32:35], s61 offen lds
    s_add_u32 m0, s57, 7168
    s_mul_i32 s61, s54, 364
    s_add_u32 s61, s61, s55
    buffer_load_dwordx4 v248, s[32:35], s61 offen lds
    s_add_u32 m0, s57, 8192
    s_mul_i32 s61, s54, 8
    s_add_u32 s61, s61, s55
    buffer_load_dwordx4 v248, s[32:35], s61 offen lds
    s_add_u32 m0, s57, 9216
    s_mul_i32 s61, s54, 48
    s_add_u32 s61, s61, s55
    buffer_load_dwordx4 v248, s[32:35], s61 offen lds
    s_add_u32 m0, s57, 10240
    s_mul_i32 s61, s54, 328
    s_add_u32 s61, s61, s55
    buffer_load_dwordx4 v248, s[32:35], s61 offen lds
    s_add_u32 m0, s57, 11264
    s_mul_i32 s61, s54, 368
    s_add_u32 s61, s61, s55
    buffer_load_dwordx4 v248, s[32:35], s61 offen lds
    s_add_u32 m0, s57, 12288
    s_mul_i32 s61, s54, 12
    s_add_u32 s61, s61, s55
    buffer_load_dwordx4 v248, s[32:35], s61 offen lds
    s_add_u32 m0, s57, 13312
    s_mul_i32 s61, s54, 52
    s_add_u32 s61, s61, s55
    buffer_load_dwordx4 v248, s[32:35], s61 offen lds
    s_add_u32 m0, s57, 14336
    s_mul_i32 s61, s54, 332
    s_add_u32 s61, s61, s55
    buffer_load_dwordx4 v248, s[32:35], s61 offen lds
    s_add_u32 m0, s57, 15360
    s_mul_i32 s61, s54, 372
    s_add_u32 s61, s61, s55
    buffer_load_dwordx4 v248, s[32:35], s61 offen lds
    s_add_u32 m0, s57, 16384
    s_mul_i32 s61, s54, 16
    s_add_u32 s61, s61, s55
    buffer_load_dwordx4 v248, s[32:35], s61 offen lds
    s_cmp_lg_u32 s20, 3
    s_cbranch_scc1 P2_a1_np
    s_mov_b64 exec, 0xff
    s_mov_b32 s50, 0x20000
P2_a1:
    v_mov_b32 v254, 0
    buffer_atomic_add v254, v253, s[28:31], s45 offen sc0 sc1
    s_sub_u32 s50, s50, 1
    s_cbranch_scc1 P2_a1_x
    s_waitcnt vmcnt(0)
    v_cmp_ne_u32 vcc, 32, v254
    s_cbranch_vccnz P2_a1
P2_a1_x:
    s_mov_b64 exec, -1
    s_waitcnt vmcnt(0)
P2_a1_np:
    s_barrier
    s_bfe_u32 s44, s2, 0x30003
    s_lshl_b32 s44, s44, 8
    s_add_u32 s44, s44, 32896
    s_and_b32 s45, s2, 15
    s_lshl_b32 s45, s45, 11
    s_add_u32 s45, s45, 32896
    v_lshlrev_b32 v252, 11, v1
    v_lshlrev_b32 v253, 8, v1
    v_mov_b32 v254, 1
    s_cmp_lg_u32 s20, 3
    s_cbranch_scc1 P2_a4_na
    s_mov_b64 exec, 0xffff
    buffer_atomic_add v254, v252, s[28:31], s44 offen sc1
    s_mov_b64 exec, -1
P2_a4_na:
    v_and_b32 v2, 15, v1
    v_lshrrev_b32 v3, 4, v1
    v_lshlrev_b32 v4, 4, v1
    s_lshr_b32 s23, s22, 1
    s_lshl_b32 s52, s21, 3
    s_add_u32 s52, s52, s23
    s_and_b32 s53, s22, 1
    s_lshr_b32 s23, s52, 5
    s_lshl_b32 s23, s23, 8
    s_and_b32 s3, s52, 31
    s_add_u32 s23, s23, s3
    s_mul_i32 s23, s23, 1280
    s_and_b32 s36, s20, 1
    s_lshr_b32 s37, s20, 1
    s_lshl_b32 s3, s36, 2
    s_add_u32 s3, s3, s53
    s_mul_i32 s38, s37, 7
    s_xor_b32 s3, s3, s38
    s_mul_i32 s3, s3, 160
    s_add_u32 s23, s23, s3
    s_mul_i32 s38, s37, 3
    v_xor_b32 v5, s38, v3
    v_mul_u32_u24 v5, 40, v5
    v_and_b32 v6, 7, v1
    v_mul_u32_u24 v6, 40960, v6
    v_bfe_u32 v7, v1, 3, 1
    v_mul_u32_u24 v7, 1310720, v7
    v_add3_u32 v5, v5, v6, v7
    v_lshlrev_b32 v6, 2, v2
    s_lshl_b32 s3, s52, 6
    s_add_u32 s3, s3, 12582912
    s_mov_b32 s8, s4
    s_mov_b32 s9, s5
    s_mov_b32 s10, 2621440
    s_mov_b32 s11, 0x20000
    buffer_load_dwordx4 v[148:151], v5, s[8:11], s23 offen
    buffer_load_dwordx4 v[152:155], v5, s[8:11], s23 offen offset:16
    buffer_load_dwordx2 v[156:157], v5, s[8:11], s23 offen offset:32
    buffer_load_dword v158, v6, s[12:15], s3 offen sc1
    s_lshl_b32 s3, s21, 7
    s_add_u32 s3, s3, 98304
    buffer_load_ubyte v159, v2, s[28:31], s3 offen sc1
    v_lshlrev_b32 v252, 7, v1
    s_lshl_b32 s3, s21, 9
    s_mov_b64 exec, 15
    buffer_load_dword v255, v252, s[28:31], s3 offen sc1
    s_lshl_b32 s3, s21, 10
    s_add_u32 s3, s3, 8192
    s_mov_b64 exec, 0xff
    buffer_load_dword v255, v252, s[28:31], s3 offen sc1
    s_mov_b64 exec, -1
    v_lshrrev_b32 v5, 2, v2
    v_and_b32 v6, 3, v2
    v_mad_u32_u24 v5, v5, 20, v6
    s_mul_i32 s3, s53, 80
    v_add_u32 v5, s3, v5
    v_cvt_f32_u32 v8, v5
    s_add_u32 s3, s36, 1
    v_lshl_add_u32 v5, v3, 4, s3
    v_cvt_f32_u32 v9, v5
    v_cvt_f32_u32 v10, s37
    v_mul_f32 v10, 0xbe800000, v10
    v_lshrrev_b32 v5, 1, v3
    v_and_b32 v5, v5, v3
    v_and_b32 v5, s36, v5
    v_lshlrev_b32 v5, 23, v5
    v_sub_u32 v11, 1.0, v5
    v_add_f32 v12, 0x3f000000, v8
    v_mul_f32 v12, 0x3acccccd, v12
    v_mul_f32 v5, 0x42800000, v12
    v_cos_f32 v14, v5
    v_fma_f32 v13, v9, v12, v10
    v_add_f32 v14, v14, v14
    v_cos_f32 v132, v13
    v_fmamk_f32 v133, v12, 0x40000000, v13
    v_cos_f32 v133, v133
    v_fmamk_f32 v134, v12, 0x40800000, v13
    v_cos_f32 v134, v134
    v_fmamk_f32 v135, v12, 0x40c00000, v13
    v_cos_f32 v135, v135
    v_fmamk_f32 v136, v12, 0x41000000, v13
    v_cos_f32 v136, v136
    v_fmamk_f32 v137, v12, 0x41200000, v13
    v_cos_f32 v137, v137
    v_fmamk_f32 v138, v12, 0x41400000, v13
    v_cos_f32 v138, v138
    v_fmamk_f32 v139, v12, 0x41600000, v13
    v_cos_f32 v139, v139
    v_fmamk_f32 v140, v12, 0x42800000, v13
    v_cos_f32 v140, v140
    v_fmamk_f32 v141, v12, 0x42840000, v13
    v_cos_f32 v141, v141
    v_fmamk_f32 v142, v12, 0x42880000, v13
    v_cos_f32 v142, v142
    v_fmamk_f32 v143, v12, 0x428c0000, v13
    v_cos_f32 v143, v143
    v_fmamk_f32 v144, v12, 0x42900000, v13
    v_cos_f32 v144, v144
    v_fmamk_f32 v145, v12, 0x42940000, v13
    v_cos_f32 v145, v145
    v_fmamk_f32 v146, v12, 0x42980000, v13
    v_cos_f32 v146, v146
    v_fmamk_f32 v147, v12, 0x429c0000, v13
    v_cos_f32 v147, v147
    v_cvt_pk_bf16_f32 v32, v132, v133
    v_cvt_pk_bf16_f32 v33, v134, v135
    v_cvt_pk_bf16_f32 v34, v136, v137
    v_cvt_pk_bf16_f32 v35, v138, v139
    v_cvt_pk_bf16_f32 v36, v140, v141
    v_cvt_pk_bf16_f32 v37, v142, v143
    v_cvt_pk_bf16_f32 v38, v144, v145
    v_cvt_pk_bf16_f32 v39, v146, v147
    v_pk_fma_f32 v[132:133], v[14:15], v[140:141], v[132:133] op_sel_hi:[0,1,1] neg_lo:[0,0,1] neg_hi:[0,0,1]
    v_pk_fma_f32 v[134:135], v[14:15], v[142:143], v[134:135] op_sel_hi:[0,1,1] neg_lo:[0,0,1] neg_hi:[0,0,1]
    v_pk_fma_f32 v[136:137], v[14:15], v[144:145], v[136:137] op_sel_hi:[0,1,1] neg_lo:[0,0,1] neg_hi:[0,0,1]
    v_pk_fma_f32 v[138:139], v[14:15], v[146:147], v[138:139] op_sel_hi:[0,1,1] neg_lo:[0,0,1] neg_hi:[0,0,1]
    v_cvt_pk_bf16_f32 v40, v132, v133
    v_cvt_pk_bf16_f32 v41, v134, v135
    v_cvt_pk_bf16_f32 v42, v136, v137
    v_cvt_pk_bf16_f32 v43, v138, v139
    v_pk_fma_f32 v[140:141], v[14:15], v[132:133], v[140:141] op_sel_hi:[0,1,1] neg_lo:[0,0,1] neg_hi:[0,0,1]
    v_pk_fma_f32 v[142:143], v[14:15], v[134:135], v[142:143] op_sel_hi:[0,1,1] neg_lo:[0,0,1] neg_hi:[0,0,1]
    v_pk_fma_f32 v[144:145], v[14:15], v[136:137], v[144:145] op_sel_hi:[0,1,1] neg_lo:[0,0,1] neg_hi:[0,0,1]
    v_pk_fma_f32 v[146:147], v[14:15], v[138:139], v[146:147] op_sel_hi:[0,1,1] neg_lo:[0,0,1] neg_hi:[0,0,1]
    v_cvt_pk_bf16_f32 v44, v140, v141
    v_cvt_pk_bf16_f32 v45, v142, v143
    v_cvt_pk_bf16_f32 v46, v144, v145
    v_cvt_pk_bf16_f32 v47, v146, v147
    v_pk_fma_f32 v[132:133], v[14:15], v[140:141], v[132:133] op_sel_hi:[0,1,1] neg_lo:[0,0,1] neg_hi:[0,0,1]
    v_pk_fma_f32 v[134:135], v[14:15], v[142:143], v[134:135] op_sel_hi:[0,1,1] neg_lo:[0,0,1] neg_hi:[0,0,1]
    v_pk_fma_f32 v[136:137], v[14:15], v[144:145], v[136:137] op_sel_hi:[0,1,1] neg_lo:[0,0,1] neg_hi:[0,0,1]
    v_pk_fma_f32 v[138:139], v[14:15], v[146:147], v[138:139] op_sel_hi:[0,1,1] neg_lo:[0,0,1] neg_hi:[0,0,1]
    v_mul_f32_e64 v139, v139, v11
    v_cvt_pk_bf16_f32 v48, v132, v133
    v_cvt_pk_bf16_f32 v49, v134, v135
    v_cvt_pk_bf16_f32 v50, v136, v137
    v_cvt_pk_bf16_f32 v51, v138, v139
    v_add_f32 v12, 0x40900000, v8
    v_mul_f32 v12, 0x3acccccd, v12
    v_mul_f32 v5, 0x42800000, v12
    v_cos_f32 v14, v5
    v_fma_f32 v13, v9, v12, v10
    v_add_f32 v14, v14, v14
    v_cos_f32 v132, v13
    v_fmamk_f32 v133, v12, 0x40000000, v13
    v_cos_f32 v133, v133
    v_fmamk_f32 v134, v12, 0x40800000, v13
    v_cos_f32 v134, v134
    v_fmamk_f32 v135, v12, 0x40c00000, v13
    v_cos_f32 v135, v135
    v_fmamk_f32 v136, v12, 0x41000000, v13
    v_cos_f32 v136, v136
    v_fmamk_f32 v137, v12, 0x41200000, v13
    v_cos_f32 v137, v137
    v_fmamk_f32 v138, v12, 0x41400000, v13
    v_cos_f32 v138, v138
    v_fmamk_f32 v139, v12, 0x41600000, v13
    v_cos_f32 v139, v139
    v_fmamk_f32 v140, v12, 0x42800000, v13
    v_cos_f32 v140, v140
    v_fmamk_f32 v141, v12, 0x42840000, v13
    v_cos_f32 v141, v141
    v_fmamk_f32 v142, v12, 0x42880000, v13
    v_cos_f32 v142, v142
    v_fmamk_f32 v143, v12, 0x428c0000, v13
    v_cos_f32 v143, v143
    v_fmamk_f32 v144, v12, 0x42900000, v13
    v_cos_f32 v144, v144
    v_fmamk_f32 v145, v12, 0x42940000, v13
    v_cos_f32 v145, v145
    v_fmamk_f32 v146, v12, 0x42980000, v13
    v_cos_f32 v146, v146
    v_fmamk_f32 v147, v12, 0x429c0000, v13
    v_cos_f32 v147, v147
    v_cvt_pk_bf16_f32 v52, v132, v133
    v_cvt_pk_bf16_f32 v53, v134, v135
    v_cvt_pk_bf16_f32 v54, v136, v137
    v_cvt_pk_bf16_f32 v55, v138, v139
    v_cvt_pk_bf16_f32 v56, v140, v141
    v_cvt_pk_bf16_f32 v57, v142, v143
    v_cvt_pk_bf16_f32 v58, v144, v145
    v_cvt_pk_bf16_f32 v59, v146, v147
    v_pk_fma_f32 v[132:133], v[14:15], v[140:141], v[132:133] op_sel_hi:[0,1,1] neg_lo:[0,0,1] neg_hi:[0,0,1]
    v_pk_fma_f32 v[134:135], v[14:15], v[142:143], v[134:135] op_sel_hi:[0,1,1] neg_lo:[0,0,1] neg_hi:[0,0,1]
    v_pk_fma_f32 v[136:137], v[14:15], v[144:145], v[136:137] op_sel_hi:[0,1,1] neg_lo:[0,0,1] neg_hi:[0,0,1]
    v_pk_fma_f32 v[138:139], v[14:15], v[146:147], v[138:139] op_sel_hi:[0,1,1] neg_lo:[0,0,1] neg_hi:[0,0,1]
    v_cvt_pk_bf16_f32 v60, v132, v133
    v_cvt_pk_bf16_f32 v61, v134, v135
    v_cvt_pk_bf16_f32 v62, v136, v137
    v_cvt_pk_bf16_f32 v63, v138, v139
    v_pk_fma_f32 v[140:141], v[14:15], v[132:133], v[140:141] op_sel_hi:[0,1,1] neg_lo:[0,0,1] neg_hi:[0,0,1]
    v_pk_fma_f32 v[142:143], v[14:15], v[134:135], v[142:143] op_sel_hi:[0,1,1] neg_lo:[0,0,1] neg_hi:[0,0,1]
    v_pk_fma_f32 v[144:145], v[14:15], v[136:137], v[144:145] op_sel_hi:[0,1,1] neg_lo:[0,0,1] neg_hi:[0,0,1]
    v_pk_fma_f32 v[146:147], v[14:15], v[138:139], v[146:147] op_sel_hi:[0,1,1] neg_lo:[0,0,1] neg_hi:[0,0,1]
    v_cvt_pk_bf16_f32 v64, v140, v141
    v_cvt_pk_bf16_f32 v65, v142, v143
    v_cvt_pk_bf16_f32 v66, v144, v145
    v_cvt_pk_bf16_f32 v67, v146, v147
    v_pk_fma_f32 v[132:133], v[14:15], v[140:141], v[132:133] op_sel_hi:[0,1,1] neg_lo:[0,0,1] neg_hi:[0,0,1]
    v_pk_fma_f32 v[134:135], v[14:15], v[142:143], v[134:135] op_sel_hi:[0,1,1] neg_lo:[0,0,1] neg_hi:[0,0,1]
    v_pk_fma_f32 v[136:137], v[14:15], v[144:145], v[136:137] op_sel_hi:[0,1,1] neg_lo:[0,0,1] neg_hi:[0,0,1]
    v_pk_fma_f32 v[138:139], v[14:15], v[146:147], v[138:139] op_sel_hi:[0,1,1] neg_lo:[0,0,1] neg_hi:[0,0,1]
    v_mul_f32 v139, v139, v11
    v_cvt_pk_bf16_f32 v68, v132, v133
    v_cvt_pk_bf16_f32 v69, v134, v135
    v_cvt_pk_bf16_f32 v70, v136, v137
    v_cvt_pk_bf16_f32 v71, v138, v139
    s_waitcnt vmcnt(2)
    v_add_f32 v12, 0x41080000, v8
    v_mul_f32 v12, 0x3acccccd, v12
    v_mul_f32 v5, 0x42800000, v12
    v_cos_f32 v14, v5
    v_fma_f32 v13, v9, v12, v10
    v_add_f32 v14, v14, v14
    v_cos_f32 v132, v13
    v_fmamk_f32 v133, v12, 0x40000000, v13
    s_add_u32 m0, s57, 17408
    s_mul_i32 s61, s54, 56
    s_add_u32 s61, s61, s55
    buffer_load_dwordx4 v248, s[32:35], s61 offen lds
    v_cos_f32 v133, v133
    v_fmamk_f32 v134, v12, 0x40800000, v13
    v_cos_f32 v134, v134
    v_fmamk_f32 v135, v12, 0x40c00000, v13
    v_cos_f32 v135, v135
    v_fmamk_f32 v136, v12, 0x41000000, v13
    v_cos_f32 v136, v136
    s_add_u32 m0, s57, 18432
    s_mul_i32 s61, s54, 336
    s_add_u32 s61, s61, s55
    buffer_load_dwordx4 v248, s[32:35], s61 offen lds
    v_fmamk_f32 v137, v12, 0x41200000, v13
    v_cos_f32 v137, v137
    v_fmamk_f32 v138, v12, 0x41400000, v13
    v_cos_f32 v138, v138
    v_fmamk_f32 v139, v12, 0x41600000, v13
    v_cos_f32 v139, v139
    v_fmamk_f32 v140, v12, 0x42800000, v13
    s_add_u32 m0, s57, 19456
    s_mul_i32 s61, s54, 376
    s_add_u32 s61, s61, s55
    buffer_load_dwordx4 v248, s[32:35], s61 offen lds
    v_cos_f32 v140, v140
    v_fmamk_f32 v141, v12, 0x42840000, v13
    v_cos_f32 v141, v141
    v_fmamk_f32 v142, v12, 0x42880000, v13
    v_cos_f32 v142, v142
    v_fmamk_f32 v143, v12, 0x428c0000, v13
    v_cos_f32 v143, v143
    s_add_u32 m0, s58, 0
    s_add_u32 s61, s56, 0
    buffer_load_dwordx4 v251, s[40:43], s61 offen offset:0 sc1 lds
    v_fmamk_f32 v144, v12, 0x42900000, v13
    v_cos_f32 v144, v144
    v_fmamk_f32 v145, v12, 0x42940000, v13
    v_cos_f32 v145, v145
    v_fmamk_f32 v146, v12, 0x42980000, v13
    v_cos_f32 v146, v146
    v_fmamk_f32 v147, v12, 0x429c0000, v13
    buffer_load_dwordx4 v251, s[40:43], s61 offen offset:1024 sc1 lds
    v_cos_f32 v147, v147
    v_cvt_pk_bf16_f32 v72, v132, v133
    v_cvt_pk_bf16_f32 v73, v134, v135
    v_cvt_pk_bf16_f32 v74, v136, v137
    v_cvt_pk_bf16_f32 v75, v138, v139
    v_cvt_pk_bf16_f32 v76, v140, v141
    v_cvt_pk_bf16_f32 v77, v142, v143
    v_cvt_pk_bf16_f32 v78, v144, v145
    v_cvt_pk_bf16_f32 v79, v146, v147
    s_add_u32 s61, s59, 0
    s_nop 0
    buffer_load_dwordx4 v251, s[40:43], s61 offen offset:2048 sc1 lds
    v_pk_fma_f32 v[132:133], v[14:15], v[140:141], v[132:133] op_sel_hi:[0,1,1] neg_lo:[0,0,1] neg_hi:[0,0,1]
    v_pk_fma_f32 v[134:135], v[14:15], v[142:143], v[134:135] op_sel_hi:[0,1,1] neg_lo:[0,0,1] neg_hi:[0,0,1]
    v_pk_fma_f32 v[136:137], v[14:15], v[144:145], v[136:137] op_sel_hi:[0,1,1] neg_lo:[0,0,1] neg_hi:[0,0,1]
    v_pk_fma_f32 v[138:139], v[14:15], v[146:147], v[138:139] op_sel_hi:[0,1,1] neg_lo:[0,0,1] neg_hi:[0,0,1]
    v_cvt_pk_bf16_f32 v80, v132, v133
    v_cvt_pk_bf16_f32 v81, v134, v135
    v_cvt_pk_bf16_f32 v82, v136, v137
    v_cvt_pk_bf16_f32 v83, v138, v139
    v_pk_fma_f32 v[140:141], v[14:15], v[132:133], v[140:141] op_sel_hi:[0,1,1] neg_lo:[0,0,1] neg_hi:[0,0,1]
    v_pk_fma_f32 v[142:143], v[14:15], v[134:135], v[142:143] op_sel_hi:[0,1,1] neg_lo:[0,0,1] neg_hi:[0,0,1]
    s_add_u32 m0, s58, 3072
    s_add_u32 s61, s56, 49152
    buffer_load_dwordx4 v251, s[40:43], s61 offen offset:0 sc1 lds
    v_pk_fma_f32 v[144:145], v[14:15], v[136:137], v[144:145] op_sel_hi:[0,1,1] neg_lo:[0,0,1] neg_hi:[0,0,1]
    v_pk_fma_f32 v[146:147], v[14:15], v[138:139], v[146:147] op_sel_hi:[0,1,1] neg_lo:[0,0,1] neg_hi:[0,0,1]
    v_cvt_pk_bf16_f32 v84, v140, v141
    v_cvt_pk_bf16_f32 v85, v142, v143
    v_cvt_pk_bf16_f32 v86, v144, v145
    v_cvt_pk_bf16_f32 v87, v146, v147
    v_pk_fma_f32 v[132:133], v[14:15], v[140:141], v[132:133] op_sel_hi:[0,1,1] neg_lo:[0,0,1] neg_hi:[0,0,1]
    v_pk_fma_f32 v[134:135], v[14:15], v[142:143], v[134:135] op_sel_hi:[0,1,1] neg_lo:[0,0,1] neg_hi:[0,0,1]
    v_pk_fma_f32 v[136:137], v[14:15], v[144:145], v[136:137] op_sel_hi:[0,1,1] neg_lo:[0,0,1] neg_hi:[0,0,1]
    v_pk_fma_f32 v[138:139], v[14:15], v[146:147], v[138:139] op_sel_hi:[0,1,1] neg_lo:[0,0,1] neg_hi:[0,0,1]
    buffer_load_dwordx4 v251, s[40:43], s61 offen offset:1024 sc1 lds
    v_mul_f32_e64 v139, v139, v11
    v_cvt_pk_bf16_f32 v88, v132, v133
    v_cvt_pk_bf16_f32 v89, v134, v135
    v_cvt_pk_bf16_f32 v90, v136, v137
    v_cvt_pk_bf16_f32 v91, v138, v139
    v_add_f32 v12, 0x41480000, v8
    v_mul_f32 v12, 0x3acccccd, v12
    v_mul_f32 v5, 0x42800000, v12
    v_cos_f32 v14, v5
    s_add_u32 s61, s59, 49152
    buffer_load_dwordx4 v251, s[40:43], s61 offen offset:2048 sc1 lds
    v_fma_f32 v13, v9, v12, v10
    v_add_f32 v14, v14, v14
    v_cos_f32 v132, v13
    v_fmamk_f32 v133, v12, 0x40000000, v13
    v_cos_f32 v133, v133
    v_fmamk_f32 v134, v12, 0x40800000, v13
    v_cos_f32 v134, v134
    s_add_u32 m0, s58, 6144
    s_add_u32 s61, s56, 98304
    buffer_load_dwordx4 v251, s[40:43], s61 offen offset:0 sc1 lds
    v_fmamk_f32 v135, v12, 0x40c00000, v13
    v_cos_f32 v135, v135
    v_fmamk_f32 v136, v12, 0x41000000, v13
    v_cos_f32 v136, v136
    v_fmamk_f32 v137, v12, 0x41200000, v13
    v_cos_f32 v137, v137
    v_fmamk_f32 v138, v12, 0x41400000, v13
    v_cos_f32 v138, v138
    v_fmamk_f32 v139, v12, 0x41600000, v13
    v_cos_f32 v139, v139
    v_fmamk_f32 v140, v12, 0x42800000, v13
    v_cos_f32 v140, v140
    v_fmamk_f32 v141, v12, 0x42840000, v13
    v_cos_f32 v141, v141
    v_fmamk_f32 v142, v12, 0x42880000, v13
    v_cos_f32 v142, v142
    v_fmamk_f32 v143, v12, 0x428c0000, v13
    v_cos_f32 v143, v143
    v_fmamk_f32 v144, v12, 0x42900000, v13
    v_cos_f32 v144, v144
    v_fmamk_f32 v145, v12, 0x42940000, v13
    v_cos_f32 v145, v145
    v_fmamk_f32 v146, v12, 0x42980000, v13
    v_cos_f32 v146, v146
    v_fmamk_f32 v147, v12, 0x429c0000, v13
    v_cos_f32 v147, v147
    v_cvt_pk_bf16_f32 v92, v132, v133
    v_cvt_pk_bf16_f32 v93, v134, v135
    v_cvt_pk_bf16_f32 v94, v136, v137
    v_cvt_pk_bf16_f32 v95, v138, v139
    v_cvt_pk_bf16_f32 v96, v140, v141
    v_cvt_pk_bf16_f32 v97, v142, v143
    v_cvt_pk_bf16_f32 v98, v144, v145
    v_cvt_pk_bf16_f32 v99, v146, v147
    v_pk_fma_f32 v[132:133], v[14:15], v[140:141], v[132:133] op_sel_hi:[0,1,1] neg_lo:[0,0,1] neg_hi:[0,0,1]
    v_pk_fma_f32 v[134:135], v[14:15], v[142:143], v[134:135] op_sel_hi:[0,1,1] neg_lo:[0,0,1] neg_hi:[0,0,1]
    v_pk_fma_f32 v[136:137], v[14:15], v[144:145], v[136:137] op_sel_hi:[0,1,1] neg_lo:[0,0,1] neg_hi:[0,0,1]
    v_pk_fma_f32 v[138:139], v[14:15], v[146:147], v[138:139] op_sel_hi:[0,1,1] neg_lo:[0,0,1] neg_hi:[0,0,1]
    v_cvt_pk_bf16_f32 v100, v132, v133
    v_cvt_pk_bf16_f32 v101, v134, v135
    v_cvt_pk_bf16_f32 v102, v136, v137
    v_cvt_pk_bf16_f32 v103, v138, v139
    v_pk_fma_f32 v[140:141], v[14:15], v[132:133], v[140:141] op_sel_hi:[0,1,1] neg_lo:[0,0,1] neg_hi:[0,0,1]
    v_pk_fma_f32 v[142:143], v[14:15], v[134:135], v[142:143] op_sel_hi:[0,1,1] neg_lo:[0,0,1] neg_hi:[0,0,1]
    v_pk_fma_f32 v[144:145], v[14:15], v[136:137], v[144:145] op_sel_hi:[0,1,1] neg_lo:[0,0,1] neg_hi:[0,0,1]
    v_pk_fma_f32 v[146:147], v[14:15], v[138:139], v[146:147] op_sel_hi:[0,1,1] neg_lo:[0,0,1] neg_hi:[0,0,1]
    v_cvt_pk_bf16_f32 v104, v140, v141
    v_cvt_pk_bf16_f32 v105, v142, v143
    v_cvt_pk_bf16_f32 v106, v144, v145
    v_cvt_pk_bf16_f32 v107, v146, v147
    v_pk_fma_f32 v[132:133], v[14:15], v[140:141], v[132:133] op_sel_hi:[0,1,1] neg_lo:[0,0,1] neg_hi:[0,0,1]
    v_pk_fma_f32 v[134:135], v[14:15], v[142:143], v[134:135] op_sel_hi:[0,1,1] neg_lo:[0,0,1] neg_hi:[0,0,1]
    v_pk_fma_f32 v[136:137], v[14:15], v[144:145], v[136:137] op_sel_hi:[0,1,1] neg_lo:[0,0,1] neg_hi:[0,0,1]
    v_pk_fma_f32 v[138:139], v[14:15], v[146:147], v[138:139] op_sel_hi:[0,1,1] neg_lo:[0,0,1] neg_hi:[0,0,1]
    v_mul_f32 v139, v139, v11
    v_cvt_pk_bf16_f32 v108, v132, v133
    v_cvt_pk_bf16_f32 v109, v134, v135
    v_cvt_pk_bf16_f32 v110, v136, v137
    v_cvt_pk_bf16_f32 v111, v138, v139
    s_cmp_lg_u32 s20, 3
    s_cbranch_scc1 P2_a5
    s_mov_b64 exec, 0xff
    v_mov_b32 v254, 0
    buffer_atomic_add v254, v253, s[28:31], s45 offen sc0 sc1
    s_mov_b64 exec, -1
P2_a5:
    v_add_f32 v12, 0x41840000, v8
    v_mul_f32 v12, 0x3acccccd, v12
    v_mul_f32 v5, 0x42800000, v12
    v_cos_f32 v14, v5
    v_fma_f32 v13, v9, v12, v10
    v_add_f32 v14, v14, v14
    v_cos_f32 v132, v13
    v_fmamk_f32 v133, v12, 0x40000000, v13
    v_cos_f32 v133, v133
    v_fmamk_f32 v134, v12, 0x40800000, v13
    v_cos_f32 v134, v134
    v_fmamk_f32 v135, v12, 0x40c00000, v13
    v_cos_f32 v135, v135
    v_fmamk_f32 v136, v12, 0x41000000, v13
    v_cos_f32 v136, v136
    v_fmamk_f32 v137, v12, 0x41200000, v13
    v_cos_f32 v137, v137
    v_fmamk_f32 v138, v12, 0x41400000, v13
    v_cos_f32 v138, v138
    v_fmamk_f32 v139, v12, 0x41600000, v13
    v_cos_f32 v139, v139
    v_fmamk_f32 v140, v12, 0x42800000, v13
    v_cos_f32 v140, v140
    v_fmamk_f32 v141, v12, 0x42840000, v13
    v_cos_f32 v141, v141
    v_fmamk_f32 v142, v12, 0x42880000, v13
    v_cos_f32 v142, v142
    v_fmamk_f32 v143, v12, 0x428c0000, v13
    v_cos_f32 v143, v143
    v_fmamk_f32 v144, v12, 0x42900000, v13
    v_cos_f32 v144, v144
    v_fmamk_f32 v145, v12, 0x42940000, v13
    v_cos_f32 v145, v145
    v_fmamk_f32 v146, v12, 0x42980000, v13
    v_cos_f32 v146, v146
    v_fmamk_f32 v147, v12, 0x429c0000, v13
    v_cos_f32_e64 v147, v147
    v_cvt_pk_bf16_f32 v112, v132, v133
    v_cvt_pk_bf16_f32 v113, v134, v135
    v_cvt_pk_bf16_f32 v114, v136, v137
    v_cvt_pk_bf16_f32 v115, v138, v139
    v_cvt_pk_bf16_f32 v116, v140, v141
    v_cvt_pk_bf16_f32 v117, v142, v143
    v_cvt_pk_bf16_f32 v118, v144, v145
    v_cvt_pk_bf16_f32 v119, v146, v147
    v_pk_fma_f32 v[132:133], v[14:15], v[140:141], v[132:133] op_sel_hi:[0,1,1] neg_lo:[0,0,1] neg_hi:[0,0,1]
    v_pk_fma_f32 v[134:135], v[14:15], v[142:143], v[134:135] op_sel_hi:[0,1,1] neg_lo:[0,0,1] neg_hi:[0,0,1]
    v_pk_fma_f32 v[136:137], v[14:15], v[144:145], v[136:137] op_sel_hi:[0,1,1] neg_lo:[0,0,1] neg_hi:[0,0,1]
    v_pk_fma_f32 v[138:139], v[14:15], v[146:147], v[138:139] op_sel_hi:[0,1,1] neg_lo:[0,0,1] neg_hi:[0,0,1]
    v_cvt_pk_bf16_f32 v120, v132, v133
    v_cvt_pk_bf16_f32 v121, v134, v135
    v_cvt_pk_bf16_f32 v122, v136, v137
    v_cvt_pk_bf16_f32 v123, v138, v139
    v_pk_fma_f32 v[140:141], v[14:15], v[132:133], v[140:141] op_sel_hi:[0,1,1] neg_lo:[0,0,1] neg_hi:[0,0,1]
    v_pk_fma_f32 v[142:143], v[14:15], v[134:135], v[142:143] op_sel_hi:[0,1,1] neg_lo:[0,0,1] neg_hi:[0,0,1]
    v_pk_fma_f32 v[144:145], v[14:15], v[136:137], v[144:145] op_sel_hi:[0,1,1] neg_lo:[0,0,1] neg_hi:[0,0,1]
    v_pk_fma_f32 v[146:147], v[14:15], v[138:139], v[146:147] op_sel_hi:[0,1,1] neg_lo:[0,0,1] neg_hi:[0,0,1]
    v_cvt_pk_bf16_f32 v124, v140, v141
    v_cvt_pk_bf16_f32 v125, v142, v143
    v_cvt_pk_bf16_f32 v126, v144, v145
    v_cvt_pk_bf16_f32 v127, v146, v147
    v_pk_fma_f32 v[132:133], v[14:15], v[140:141], v[132:133] op_sel_hi:[0,1,1] neg_lo:[0,0,1] neg_hi:[0,0,1]
    v_pk_fma_f32 v[134:135], v[14:15], v[142:143], v[134:135] op_sel_hi:[0,1,1] neg_lo:[0,0,1] neg_hi:[0,0,1]
    v_pk_fma_f32 v[136:137], v[14:15], v[144:145], v[136:137] op_sel_hi:[0,1,1] neg_lo:[0,0,1] neg_hi:[0,0,1]
    v_pk_fma_f32 v[138:139], v[14:15], v[146:147], v[138:139] op_sel_hi:[0,1,1] neg_lo:[0,0,1] neg_hi:[0,0,1]
    v_mul_f32 v139, v139, v11
    v_cvt_pk_bf16_f32 v128, v132, v133
    v_cvt_pk_bf16_f32 v129, v134, v135
    v_cvt_pk_bf16_f32 v130, v136, v137
    v_cvt_pk_bf16_f32 v131, v138, v139
    v_lshrrev_b32 v5, 2, v1
    v_lshlrev_b32 v5, 8, v5
    v_bfe_u32 v6, v1, 1, 1
    v_lshl_add_u32 v5, v6, 6, v5
    v_lshrrev_b32 v6, 5, v1
    v_xor_b32 v6, v6, v1
    v_and_b32 v6, 1, v6
    v_lshl_add_u32 v5, v6, 4, v5
    s_lshr_b32 s23, s52, 1
    s_lshl_b32 s23, s23, 1
    s_add_u32 s23, s23, s37
    s_mul_i32 s23, s23, 20480
    s_lshl_b32 s3, s36, 7
    s_add_u32 s23, s23, s3
    s_and_b32 s3, s52, 1
    s_lshl_b32 s3, s3, 5
    s_add_u32 s23, s23, s3
    s_add_u32 s23, s23, 13631488
    s_mul_i32 s38, s36, 10240
    s_add_u32 s38, s38, 143360
    s_mul_i32 s39, s37, 5120
    s_add_u32 s39, s39, s38
    v_lshl_add_u32 v6, v3, 9, s38
    v_lshrrev_b32 v7, 2, v2
    v_lshl_add_u32 v6, v7, 6, v6
    v_bfe_u32 v7, v1, 1, 1
    v_lshl_add_u32 v6, v7, 5, v6
    v_and_b32 v7, 1, v1
    v_lshl_add_u32 v6, v7, 3, v6
    v_xor_b32 v7, s37, v3
    v_and_b32 v7, 1, v7
    v_lshl_add_u32 v6, v7, 4, v6
    v_lshlrev_b32 v15, 28, v1
    v_and_b32 v15, 0x80000000, v15
    v_xor_b32 v12, 0x35cccccd, v15
    v_or_b32 v15, 1.0, v15
    s_lshl_b32 s3, s20, 2
    s_lshr_b32 s3, 41068, s3
    s_lshl_b32 s44, s3, 31
    s_and_b32 s44, s44, 0x80000000
    v_xor_b32 v220, s44, v12
    s_xor_b32 s44, s20, 0
    s_mul_i32 s44, s44, 5120
    s_add_u32 s44, s44, 143360
    v_add_u32 v7, s44, v4
    s_lshl_b32 s44, s3, 30
    s_and_b32 s44, s44, 0x80000000
    v_xor_b32 v222, s44, v12
    s_xor_b32 s44, s20, 1
    s_mul_i32 s44, s44, 5120
    s_add_u32 s44, s44, 143360
    v_add_u32 v8, s44, v4
    s_lshl_b32 s44, s3, 29
    s_and_b32 s44, s44, 0x80000000
    v_xor_b32 v224, s44, v12
    s_xor_b32 s44, s20, 2
    s_mul_i32 s44, s44, 5120
    s_add_u32 s44, s44, 143360
    v_add_u32 v9, s44, v4
    s_lshl_b32 s44, s3, 28
    s_and_b32 s44, s44, 0x80000000
    v_xor_b32 v226, s44, v12
    s_xor_b32 s44, s20, 3
    s_mul_i32 s44, s44, 5120
    s_add_u32 s44, s44, 143360
    v_add_u32 v10, s44, v4
    s_mov_b32 s3, 0xffff0000
    s_cmp_ge_u32 s20, 2
    s_cbranch_scc1 P2_y_d
    v_lshlrev_b32 v160, 16, v148
    v_and_b32 v161, s3, v148
    v_lshlrev_b32 v162, 16, v149
    v_and_b32 v163, s3, v149
    v_lshlrev_b32 v164, 16, v150
    v_and_b32 v165, s3, v150
    v_lshlrev_b32 v166, 16, v151
    v_and_b32 v167, s3, v151
    v_lshlrev_b32 v168, 16, v152
    v_and_b32 v169, s3, v152
    v_lshlrev_b32 v170, 16, v153
    v_and_b32 v171, s3, v153
    v_lshlrev_b32 v172, 16, v154
    v_and_b32 v173, s3, v154
    v_lshlrev_b32 v174, 16, v155
    v_and_b32 v175, s3, v155
    v_lshlrev_b32 v176, 16, v156
    v_and_b32 v177, s3, v156
    v_lshlrev_b32 v178, 16, v157
    v_and_b32 v179, s3, v157
    s_branch P2_y_j
P2_y_d:
    v_lshlrev_b32 v179, 16, v148
    v_and_b32 v178, s3, v148
    v_lshlrev_b32 v177, 16, v149
    v_and_b32 v176, s3, v149
    v_lshlrev_b32 v175, 16, v150
    v_and_b32 v174, s3, v150
    v_lshlrev_b32 v173, 16, v151
    v_and_b32 v172, s3, v151
    v_lshlrev_b32 v171, 16, v152
    v_and_b32 v170, s3, v152
    v_lshlrev_b32 v169, 16, v153
    v_and_b32 v168, s3, v153
    v_lshlrev_b32 v167, 16, v154
    v_and_b32 v166, s3, v154
    v_lshlrev_b32 v165, 16, v155
    v_and_b32 v164, s3, v155
    v_lshlrev_b32 v163, 16, v156
    v_and_b32 v162, s3, v156
    v_lshlrev_b32 v161, 16, v157
    v_and_b32_e64 v160, s3, v157
P2_y_j:
    v_pk_add_f32 v[160:161], v[160:161], v[158:159] op_sel_hi:[1,0]
    v_pk_add_f32 v[162:163], v[162:163], v[158:159] op_sel_hi:[1,0]
    v_pk_add_f32 v[164:165], v[164:165], v[158:159] op_sel_hi:[1,0]
    v_pk_add_f32 v[166:167], v[166:167], v[158:159] op_sel_hi:[1,0]
    v_pk_add_f32 v[168:169], v[168:169], v[158:159] op_sel_hi:[1,0]
    v_pk_add_f32 v[170:171], v[170:171], v[158:159] op_sel_hi:[1,0]
    v_pk_add_f32 v[172:173], v[172:173], v[158:159] op_sel_hi:[1,0]
    v_pk_add_f32 v[174:175], v[174:175], v[158:159] op_sel_hi:[1,0]
    v_pk_add_f32 v[176:177], v[176:177], v[158:159] op_sel_hi:[1,0]
    v_pk_add_f32 v[178:179], v[178:179], v[158:159] op_sel_hi:[1,0]
    s_getreg_b32 s3, hwreg(HW_REG_XCC_ID, 0, 4)
    s_add_u32 s3, s3, 1
    v_cmp_ne_u32 vcc, s3, v159
    s_nop 0
    s_or_b64 vcc, vcc, vcc
    s_cselect_b32 s51, 0, 1
    s_cmp_lg_u32 s20, 3
    s_cbranch_scc1 P2_a3_np
    s_mov_b64 exec, 0xff
    s_waitcnt vmcnt(0)
    v_cmp_ne_u32 vcc, 32, v254
    s_mov_b64 exec, -1
    s_cbranch_vccz P2_a3_np
    s_bfe_u32 s44, s2, 0x30003
    s_lshl_b32 s44, s44, 8
    s_add_u32 s44, s44, 32896
    s_and_b32 s45, s2, 15
    s_lshl_b32 s45, s45, 11
    s_add_u32 s45, s45, 32896
    v_lshlrev_b32 v252, 11, v1
    v_lshlrev_b32 v253, 8, v1
    v_mov_b32 v254, 1
    s_cmp_lg_u32 s20, 3
    s_cbranch_scc1 P2_a3_np
    s_mov_b64 exec, 0xff
    s_mov_b32 s50, 0x20000
P2_a3:
    v_mov_b32 v254, 0
    buffer_atomic_add v254, v253, s[28:31], s45 offen sc0 sc1
    s_sub_u32 s50, s50, 1
    s_cbranch_scc1 P2_a3_x
    s_waitcnt vmcnt(0)
    v_cmp_ne_u32 vcc, 32, v254
    s_cbranch_vccnz P2_a3
P2_a3_x:
    s_mov_b64 exec, -1
    s_waitcnt vmcnt(0)
P2_a3_np:
    s_bfe_u32 s44, s2, 0x30003
    s_lshl_b32 s44, s44, 8
    s_add_u32 s44, s44, 32768
    s_and_b32 s45, s2, 15
    s_lshl_b32 s45, s45, 11
    s_add_u32 s45, s45, 32768
    v_lshlrev_b32 v252, 11, v1
    v_lshlrev_b32 v253, 8, v1
    v_mov_b32 v254, 1
    s_barrier
    s_cmp_lg_u32 s20, 3
    s_cbranch_scc1 P2_a2_na
    s_mov_b64 exec, 0xffff
    buffer_atomic_add v254, v252, s[28:31], s44 offen sc1
    s_mov_b64 exec, -1
P2_a2_na:
    buffer_load_dwordx4 v251, s[40:43], s61 offen offset:1024 sc1 lds
    s_add_u32 s61, s59, 98304
    buffer_load_dwordx4 v251, s[40:43], s61 offen offset:2048 sc1 lds
    s_add_u32 m0, s58, 9216
    s_add_u32 s61, s56, 147456
    buffer_load_dwordx4 v251, s[40:43], s61 offen offset:0 sc1 lds
    buffer_load_dwordx4 v251, s[40:43], s61 offen offset:1024 sc1 lds
    s_add_u32 s61, s59, 147456
    buffer_load_dwordx4 v251, s[40:43], s61 offen offset:2048 sc1 lds
    s_add_u32 m0, s58, 12288
    s_add_u32 s61, s56, 196608
    buffer_load_dwordx4 v251, s[40:43], s61 offen offset:0 sc1 lds
    buffer_load_dwordx4 v251, s[40:43], s61 offen offset:1024 sc1 lds
    s_add_u32 s61, s59, 196608
    buffer_load_dwordx4 v251, s[40:43], s61 offen offset:2048 sc1 lds
    s_add_u32 s63, s62, 0
    buffer_load_dwordx4 a[0:3], v251, s[40:43], s63 offen offset:0 sc1
    buffer_load_dwordx4 a[4:7], v251, s[40:43], s63 offen offset:1024 sc1
    buffer_load_dwordx4 a[8:11], v251, s[40:43], s63 offen offset:2048 sc1
    buffer_load_dwordx4 a[12:15], v251, s[40:43], s63 offen offset:3072 sc1
    s_add_u32 s63, s63, 4096
    buffer_load_dwordx4 a[16:19], v251, s[40:43], s63 offen offset:0 sc1
    s_add_u32 s63, s62, 40960
    buffer_load_dwordx4 a[20:23], v251, s[40:43], s63 offen offset:0 sc1
    buffer_load_dwordx4 a[24:27], v251, s[40:43], s63 offen offset:1024 sc1
    buffer_load_dwordx4 a[28:31], v251, s[40:43], s63 offen offset:2048 sc1
    buffer_load_dwordx4 a[32:35], v251, s[40:43], s63 offen offset:3072 sc1
    s_add_u32 s63, s63, 4096
    buffer_load_dwordx4 a[36:39], v251, s[40:43], s63 offen offset:0 sc1
    s_add_u32 s63, s62, 81920
    buffer_load_dwordx4 a[40:43], v251, s[40:43], s63 offen offset:0 sc1
    buffer_load_dwordx4 a[44:47], v251, s[40:43], s63 offen offset:1024 sc1
    s_cmp_lg_u32 s20, 3
    s_cbranch_scc1 P2_a2_np
    s_mov_b64 exec, 0xff
    s_mov_b32 s50, 0x20000
P2_a2:
    v_mov_b32 v254, 0
    buffer_atomic_add v254, v253, s[28:31], s45 offen sc0 sc1
    s_sub_u32 s50, s50, 1
    s_cbranch_scc1 P2_a2_x
    s_waitcnt vmcnt(0)
    v_cmp_ne_u32 vcc, 32, v254
    s_cbranch_vccnz P2_a2
P2_a2_x:
    s_mov_b64 exec, -1
    s_waitcnt vmcnt(0)
P2_a2_np:
P2_join:
    s_barrier
    s_add_u32 m0, s39, 0
    s_nop 0
    buffer_load_dwordx4 v5, s[12:15], s23 offen sc1 lds
    s_add_u32 m0, s39, 1024
    s_add_u32 s23, s23, 4096
    buffer_load_dwordx4 v5, s[12:15], s23 offen sc1 lds
    s_add_u32 m0, s39, 2048
    s_add_u32 s23, s23, 4096
    buffer_load_dwordx4 v5, s[12:15], s23 offen sc1 lds
    s_add_u32 m0, s39, 3072
    s_add_u32 s23, s23, 4096
    buffer_load_dwordx4 v5, s[12:15], s23 offen sc1 lds
    s_add_u32 m0, s39, 4096
    s_add_u32 s23, s23, 4096
    buffer_load_dwordx4 v5, s[12:15], s23 offen sc1 lds
    s_cmp_lg_u32 s51, 0
    s_cselect_b32 s3, 0, 37748736
    s_add_u32 s8, s6, s3
    s_addc_u32 s9, s7, 0
    s_mov_b32 s10, 0x600000
    s_add_u32 s24, s6, 13631488
    s_addc_u32 s25, s7, 0
    s_mov_b32 s26, 14680064
    s_mov_b32 s27, 0x20000
    s_lshl_b32 s3, s37, 1
    s_add_u32 s3, s3, s53
    s_lshl_b32 s23, s52, 2
    s_add_u32 s23, s23, s3
    s_mul_i32 s23, s23, 5120
    s_add_u32 s23, s23, 3145728
    s_lshl_b32 s3, s36, 9
    s_add_u32 s38, s23, s3
    s_add_u32 s38, s38, 4096
    s_lshl_b32 s3, s36, 11
    s_add_u32 s23, s23, s3
    s_and_b32 s39, s52, 15
    s_lshr_b32 s3, s52, 4
    s_lshl4_add_u32 s39, s39, s3
    s_lshl4_add_u32 s39, s39, s53
    s_lshl2_add_u32 s39, s39, s20
    s_lshl_b32 s39, s39, 7
    s_lshr_b32 s60, s22, 2
    s_lshl_b32 s3, s21, 2
    s_add_u32 s60, s60, s3
    s_lshl_b32 s60, s60, 7
    s_and_b32 s3, s22, 3
    s_lshl_b32 s3, s3, 2
    s_add_u32 s60, s60, s3
    s_add_u32 s60, s60, s20
    v_lshlrev_b32 v11, 3, v1
    v_lshrrev_b32 v12, 5, v1
    v_lshlrev_b32 v12, 2, v12
    v_lshl_add_u32 v12, v2, 3, v12
    v_mov_b32 v13, 0
    v_mov_b32 v14, 0
    v_mov_b32 v5, 0x3f803f80
    buffer_load_dwordx4 a[48:51], v251, s[40:43], s63 offen offset:2048 sc1
    buffer_load_dwordx4 a[52:55], v251, s[40:43], s63 offen offset:3072 sc1
    s_add_u32 s63, s63, 4096
    buffer_load_dwordx4 a[56:59], v251, s[40:43], s63 offen offset:0 sc1
    s_add_u32 s63, s62, 122880
    buffer_load_dwordx4 a[60:63], v251, s[40:43], s63 offen offset:0 sc1
    buffer_load_dwordx4 a[64:67], v251, s[40:43], s63 offen offset:1024 sc1
    buffer_load_dwordx4 a[68:71], v251, s[40:43], s63 offen offset:2048 sc1
    s_waitcnt vmcnt(6)
    s_barrier
    s_nop 0
    ds_read_b64_tr_b16 v[180:181], v6 offset:0
    ds_read_b64_tr_b16 v[182:183], v6 offset:256
    ds_read_b64_tr_b16 v[184:185], v6 offset:2048
    ds_read_b64_tr_b16 v[186:187], v6 offset:2304
    ds_read_b64_tr_b16 v[188:189], v6 offset:4096
    ds_read_b64_tr_b16 v[190:191], v6 offset:4352
    ds_read_b64_tr_b16 v[192:193], v6 offset:6144
    ds_read_b64_tr_b16 v[194:195], v6 offset:6400
    buffer_load_dwordx4 a[72:75], v251, s[40:43], s63 offen offset:3072 sc1
    ds_read_b64_tr_b16 v[196:197], v6 offset:8192
    ds_read_b64_tr_b16 v[198:199], v6 offset:8448
    s_waitcnt lgkmcnt(8)
    v_mfma_f32_16x16x32_bf16 v[200:203], v[32:35], v[180:183], 0
    v_mfma_f32_16x16x32_bf16 v[204:207], v[52:55], v[180:183], 0
    s_add_u32 s63, s63, 4096
    buffer_load_dwordx4 a[76:79], v251, s[40:43], s63 offen offset:0 sc1
    v_mfma_f32_16x16x32_bf16 v[208:211], v[72:75], v[180:183], 0
    v_mfma_f32_16x16x32_bf16 v[212:215], v[92:95], v[180:183], 0
    s_add_u32 s63, s62, 163840
    buffer_load_dwordx4 a[80:83], v251, s[40:43], s63 offen offset:0 sc1
    v_mfma_f32_16x16x32_bf16 v[216:219], v[112:115], v[180:183], 0
    s_waitcnt lgkmcnt(6)
    v_mfma_f32_16x16x32_bf16 v[200:203], v[36:39], v[184:187], v[200:203]
    buffer_load_dwordx4 a[84:87], v251, s[40:43], s63 offen offset:1024 sc1
    v_mfma_f32_16x16x32_bf16 v[204:207], v[56:59], v[184:187], v[204:207]
    v_mfma_f32_16x16x32_bf16 v[208:211], v[76:79], v[184:187], v[208:211]
    buffer_load_dwordx4 a[88:91], v251, s[40:43], s63 offen offset:2048 sc1
    v_mfma_f32_16x16x32_bf16 v[212:215], v[96:99], v[184:187], v[212:215]
    v_mfma_f32_16x16x32_bf16 v[216:219], v[116:119], v[184:187], v[216:219]
    s_waitcnt lgkmcnt(4)
    buffer_load_dwordx4 a[92:95], v251, s[40:43], s63 offen offset:3072 sc1
    v_mfma_f32_16x16x32_bf16 v[200:203], v[40:43], v[188:191], v[200:203]
    v_mfma_f32_16x16x32_bf16 v[204:207], v[60:63], v[188:191], v[204:207]
    s_add_u32 s63, s63, 4096
    buffer_load_dwordx4 a[96:99], v251, s[40:43], s63 offen offset:0 sc1
    v_mfma_f32_16x16x32_bf16 v[208:211], v[80:83], v[188:191], v[208:211]
    v_mfma_f32_16x16x32_bf16 v[212:215], v[100:103], v[188:191], v[212:215]
    s_add_u32 s63, s62, 204800
    buffer_load_dwordx4 a[100:103], v251, s[40:43], s63 offen offset:0 sc1
    v_mfma_f32_16x16x32_bf16 v[216:219], v[120:123], v[188:191], v[216:219]
    s_waitcnt lgkmcnt(2)
    v_mfma_f32_16x16x32_bf16 v[200:203], v[44:47], v[192:195], v[200:203]
    buffer_load_dwordx4 a[104:107], v251, s[40:43], s63 offen offset:1024 sc1
    v_mfma_f32_16x16x32_bf16 v[204:207], v[64:67], v[192:195], v[204:207]
    v_mfma_f32_16x16x32_bf16 v[208:211], v[84:87], v[192:195], v[208:211]
    buffer_load_dwordx4 a[108:111], v251, s[40:43], s63 offen offset:2048 sc1
    v_mfma_f32_16x16x32_bf16 v[212:215], v[104:107], v[192:195], v[212:215]
    v_mfma_f32_16x16x32_bf16 v[216:219], v[124:127], v[192:195], v[216:219]
    s_waitcnt lgkmcnt(0)
    buffer_load_dwordx4 a[112:115], v251, s[40:43], s63 offen offset:3072 sc1
    s_barrier
    v_mfma_f32_16x16x32_bf16 v[200:203], v[48:51], v[196:199], v[200:203]
    v_mfma_f32_16x16x32_bf16 v[204:207], v[68:71], v[196:199], v[204:207]
    s_add_u32 s63, s63, 4096
    buffer_load_dwordx4 a[116:119], v251, s[40:43], s63 offen offset:0 sc1
    v_mfma_f32_16x16x32_bf16 v[208:211], v[88:91], v[196:199], v[208:211]
    v_mfma_f32_16x16x32_bf16 v[212:215], v[108:111], v[196:199], v[212:215]
    v_mfma_f32_16x16x32_bf16 v[216:219], v[128:131], v[196:199], v[216:219]
    s_nop 1
    s_nop 0
    v_fmac_f32 v200, v200, v15 row_ror:8 row_mask:0xf bank_mask:0xf
    v_fmac_f32 v201, v201, v15 row_ror:8 row_mask:0xf bank_mask:0xf
    v_fmac_f32 v202, v202, v15 row_ror:8 row_mask:0xf bank_mask:0xf
    v_fmac_f32 v203, v203, v15 row_ror:8 row_mask:0xf bank_mask:0xf
    ds_write_b128 v7, v[200:203] offset:0
    v_fmac_f32 v204, v204, v15 row_ror:8 row_mask:0xf bank_mask:0xf
    v_fmac_f32 v205, v205, v15 row_ror:8 row_mask:0xf bank_mask:0xf
    v_fmac_f32 v206, v206, v15 row_ror:8 row_mask:0xf bank_mask:0xf
    v_fmac_f32 v207, v207, v15 row_ror:8 row_mask:0xf bank_mask:0xf
    ds_write_b128 v7, v[204:207] offset:1024
    v_fmac_f32 v208, v208, v15 row_ror:8 row_mask:0xf bank_mask:0xf
    v_fmac_f32 v209, v209, v15 row_ror:8 row_mask:0xf bank_mask:0xf
    v_fmac_f32 v210, v210, v15 row_ror:8 row_mask:0xf bank_mask:0xf
    v_fmac_f32 v211, v211, v15 row_ror:8 row_mask:0xf bank_mask:0xf
    ds_write_b128 v7, v[208:211] offset:2048
    v_fmac_f32 v212, v212, v15 row_ror:8 row_mask:0xf bank_mask:0xf
    v_fmac_f32 v213, v213, v15 row_ror:8 row_mask:0xf bank_mask:0xf
    v_fmac_f32 v214, v214, v15 row_ror:8 row_mask:0xf bank_mask:0xf
    v_fmac_f32 v215, v215, v15 row_ror:8 row_mask:0xf bank_mask:0xf
    ds_write_b128 v7, v[212:215] offset:3072
    v_fmac_f32 v216, v216, v15 row_ror:8 row_mask:0xf bank_mask:0xf
    v_fmac_f32 v217, v217, v15 row_ror:8 row_mask:0xf bank_mask:0xf
    v_fmac_f32 v218, v218, v15 row_ror:8 row_mask:0xf bank_mask:0xf
    v_fmac_f32 v219, v219, v15 row_ror:8 row_mask:0xf bank_mask:0xf
    ds_write_b128 v7, v[216:219] offset:4096
    v_pk_fma_f32 v[160:161], v[220:221], v[200:201], v[160:161] op_sel_hi:[0,1,1]
    v_pk_fma_f32 v[162:163], v[220:221], v[202:203], v[162:163] op_sel_hi:[0,1,1]
    v_pk_fma_f32 v[164:165], v[220:221], v[204:205], v[164:165] op_sel_hi:[0,1,1]
    v_pk_fma_f32 v[166:167], v[220:221], v[206:207], v[166:167] op_sel_hi:[0,1,1]
    v_pk_fma_f32 v[168:169], v[220:221], v[208:209], v[168:169] op_sel_hi:[0,1,1]
    v_pk_fma_f32 v[170:171], v[220:221], v[210:211], v[170:171] op_sel_hi:[0,1,1]
    v_pk_fma_f32 v[172:173], v[220:221], v[212:213], v[172:173] op_sel_hi:[0,1,1]
    v_pk_fma_f32 v[174:175], v[220:221], v[214:215], v[174:175] op_sel_hi:[0,1,1]
    v_pk_fma_f32 v[176:177], v[220:221], v[216:217], v[176:177] op_sel_hi:[0,1,1]
    v_pk_fma_f32 v[178:179], v[220:221], v[218:219], v[178:179] op_sel_hi:[0,1,1]
    s_waitcnt lgkmcnt(0)
    s_barrier
    ds_read_b128 v[32:35], v8 offset:0
    ds_read_b128 v[36:39], v9 offset:0
    ds_read_b128 v[40:43], v10 offset:0
    ds_read_b128 v[44:47], v8 offset:1024
    ds_read_b128 v[48:51], v9 offset:1024
    ds_read_b128 v[52:55], v10 offset:1024
    ds_read_b128 v[56:59], v8 offset:2048
    ds_read_b128 v[60:63], v9 offset:2048
    ds_read_b128 v[64:67], v10 offset:2048
    ds_read_b128 v[68:71], v8 offset:3072
    ds_read_b128 v[72:75], v9 offset:3072
    ds_read_b128 v[76:79], v10 offset:3072
    ds_read_b128 v[80:83], v8 offset:4096
    ds_read_b128 v[84:87], v9 offset:4096
    ds_read_b128 v[88:91], v10 offset:4096
    s_waitcnt lgkmcnt(12)
    s_nop 0
    v_pk_fma_f32 v[160:161], v[222:223], v[32:33], v[160:161] op_sel_hi:[0,1,1]
    v_pk_fma_f32 v[162:163], v[222:223], v[34:35], v[162:163] op_sel_hi:[0,1,1]
    v_pk_fma_f32 v[160:161], v[224:225], v[36:37], v[160:161] op_sel_hi:[0,1,1]
    v_pk_fma_f32 v[162:163], v[224:225], v[38:39], v[162:163] op_sel_hi:[0,1,1]
    v_pk_fma_f32 v[160:161], v[226:227], v[40:41], v[160:161] op_sel_hi:[0,1,1]
    v_pk_fma_f32 v[162:163], v[226:227], v[42:43], v[162:163] op_sel_hi:[0,1,1]
    v_cvt_pk_bf16_f32 v148, v160, v161
    v_cvt_pk_bf16_f32 v149, v162, v163
    s_waitcnt lgkmcnt(9)
    s_nop 0
    v_pk_fma_f32 v[164:165], v[222:223], v[44:45], v[164:165] op_sel_hi:[0,1,1]
    v_pk_fma_f32 v[166:167], v[222:223], v[46:47], v[166:167] op_sel_hi:[0,1,1]
    v_pk_fma_f32 v[164:165], v[224:225], v[48:49], v[164:165] op_sel_hi:[0,1,1]
    v_pk_fma_f32 v[166:167], v[224:225], v[50:51], v[166:167] op_sel_hi:[0,1,1]
    v_pk_fma_f32 v[164:165], v[226:227], v[52:53], v[164:165] op_sel_hi:[0,1,1]
    v_pk_fma_f32 v[166:167], v[226:227], v[54:55], v[166:167] op_sel_hi:[0,1,1]
    v_cvt_pk_bf16_f32 v150, v164, v165
    v_cvt_pk_bf16_f32 v151, v166, v167
    buffer_store_dwordx4 v[148:151], v4, s[8:11], s23 offen offset:0
    s_waitcnt lgkmcnt(6)
    s_nop 0
    v_pk_fma_f32 v[168:169], v[222:223], v[56:57], v[168:169] op_sel_hi:[0,1,1]
    v_pk_fma_f32 v[170:171], v[222:223], v[58:59], v[170:171] op_sel_hi:[0,1,1]
    v_pk_fma_f32 v[168:169], v[224:225], v[60:61], v[168:169] op_sel_hi:[0,1,1]
    v_pk_fma_f32 v[170:171], v[224:225], v[62:63], v[170:171] op_sel_hi:[0,1,1]
    v_pk_fma_f32 v[168:169], v[226:227], v[64:65], v[168:169] op_sel_hi:[0,1,1]
    v_pk_fma_f32 v[170:171], v[226:227], v[66:67], v[170:171] op_sel_hi:[0,1,1]
    v_cvt_pk_bf16_f32 v152, v168, v169
    v_cvt_pk_bf16_f32 v153, v170, v171
    s_waitcnt lgkmcnt(3)
    s_nop 0
    v_pk_fma_f32 v[172:173], v[222:223], v[68:69], v[172:173] op_sel_hi:[0,1,1]
    v_pk_fma_f32 v[174:175], v[222:223], v[70:71], v[174:175] op_sel_hi:[0,1,1]
    v_pk_fma_f32 v[172:173], v[224:225], v[72:73], v[172:173] op_sel_hi:[0,1,1]
    v_pk_fma_f32 v[174:175], v[224:225], v[74:75], v[174:175] op_sel_hi:[0,1,1]
    v_pk_fma_f32 v[172:173], v[226:227], v[76:77], v[172:173] op_sel_hi:[0,1,1]
    v_pk_fma_f32 v[174:175], v[226:227], v[78:79], v[174:175] op_sel_hi:[0,1,1]
    v_cvt_pk_bf16_f32 v154, v172, v173
    v_cvt_pk_bf16_f32 v155, v174, v175
    buffer_store_dwordx4 v[152:155], v4, s[8:11], s23 offen offset:1024
    s_waitcnt lgkmcnt(0)
    s_nop 0
    v_pk_fma_f32 v[176:177], v[222:223], v[80:81], v[176:177] op_sel_hi:[0,1,1]
    v_pk_fma_f32 v[178:179], v[222:223], v[82:83], v[178:179] op_sel_hi:[0,1,1]
    v_pk_fma_f32 v[176:177], v[224:225], v[84:85], v[176:177] op_sel_hi:[0,1,1]
    v_pk_fma_f32 v[178:179], v[224:225], v[86:87], v[178:179] op_sel_hi:[0,1,1]
    v_pk_fma_f32 v[176:177], v[226:227], v[88:89], v[176:177] op_sel_hi:[0,1,1]
    v_pk_fma_f32 v[178:179], v[226:227], v[90:91], v[178:179] op_sel_hi:[0,1,1]
    v_cvt_pk_bf16_f32 v156, v176, v177
    v_cvt_pk_bf16_f32 v157, v178, v179
    buffer_store_dwordx2 v[156:157], v11, s[8:11], s38 offen
    v_dot2_f32_bf16 v13, v148, v5, v13
    v_dot2_f32_bf16 v14, v148, v148, v14
    v_dot2_f32_bf16 v13, v149, v5, v13
    v_dot2_f32_bf16 v14, v149, v149, v14
    v_dot2_f32_bf16 v13, v150, v5, v13
    v_dot2_f32_bf16 v14, v150, v150, v14
    v_dot2_f32_bf16 v13, v151, v5, v13
    v_dot2_f32_bf16 v14, v151, v151, v14
    v_dot2_f32_bf16 v13, v152, v5, v13
    v_dot2_f32_bf16 v14, v152, v152, v14
    v_dot2_f32_bf16 v13, v153, v5, v13
    v_dot2_f32_bf16 v14, v153, v153, v14
    v_dot2_f32_bf16 v13, v154, v5, v13
    v_dot2_f32_bf16 v14, v154, v154, v14
    v_dot2_f32_bf16 v13, v155, v5, v13
    v_dot2_f32_bf16 v14, v155, v155, v14
    v_dot2_f32_bf16 v13, v156, v5, v13
    v_dot2_f32_bf16 v14, v156, v156, v14
    v_dot2_f32_bf16 v13, v157, v5, v13
    v_dot2_f32_bf16 v14, v157, v157, v14
    s_nop 2
    v_permlane32_swap_b32 v13, v14
    v_add_f32 v13, v13, v14
    v_mov_b32 v14, v13
    s_nop 1
    v_permlane16_swap_b32 v13, v14
    v_add_f32 v13, v13, v14
    s_mov_b32 exec_lo, 0xffff
    s_mov_b32 exec_hi, 0xffff
    buffer_store_dword v13, v12, s[8:11], s39 offen
    s_mov_b64 exec, -1
    s_lshl_b32 s46, s21, 2
    s_add_u32 s46, s46, s20
    s_lshl_b32 s53, s46, 7
    s_bfe_u32 s3, s22, 0x10002
    s_lshl1_add_u32 s23, s46, s3
    s_xor_b32 s52, s23, 1
    s_mul_i32 s36, s52, 20480
    s_mul_i32 s37, s23, 20480
    s_and_b32 s38, s52, 15
    s_lshr_b32 s3, s52, 4
    s_lshl4_add_u32 s38, s38, s3
    s_lshl_b32 s38, s38, 13
    s_xor_b32 s39, s38, 0x20000
    s_add_u32 s36, s36, 3145728
    s_add_u32 s37, s37, 3145728
    v_add_u32 v11, 4096, v11
    v_lshlrev_b32 v12, 3, v2
    v_lshl_add_u32 v12, v3, 7, v12
    v_lshrrev_b32 v13, 2, v2
    v_and_b32 v14, 3, v1
    v_lshlrev_b32 v14, 3, v14
    v_lshl_add_u32 v15, v3, 2, v13
    v_lshl_add_u32 v16, v15, 7, v14
    v_bfe_u32 v13, v1, 3, 2
    v_lshl_add_u32 v16, v13, 5, v16
    v_xor_b32 v17, 32, v16
    v_xor_b32 v18, 64, v16
    v_xor_b32 v19, 0x60, v16
    v_add_u32 v20, 81920, v4
    s_waitcnt vmcnt(0)
    v_mov_b32 v5, 1
    v_mov_b32 v6, 0
    s_mov_b64 exec, 1
    s_cmp_lg_u32 s51, 0
    s_cbranch_scc1 P3_ar_f
    buffer_wbl2 sc1
    s_waitcnt vmcnt(0)
    buffer_store_byte v5, v6, s[28:31], s60 offen sc1
    s_branch P3_ar_j
P3_ar_f:
    buffer_store_byte v5, v6, s[28:31], s60 offen
P3_ar_j:
    s_mov_b64 exec, -1
    ds_read_b64_tr_b16 v[88:89], v16 offset:0
    ds_read_b64_tr_b16 v[90:91], v16 offset:4096
    ds_read_b64_tr_b16 v[92:93], v17 offset:0
    ds_read_b64_tr_b16 v[94:95], v17 offset:4096
    ds_read_b64_tr_b16 v[96:97], v18 offset:0
    ds_read_b64_tr_b16 v[98:99], v18 offset:4096
    ds_read_b64_tr_b16 v[100:101], v19 offset:0
    ds_read_b64_tr_b16 v[102:103], v19 offset:4096
    ds_read_b128 v[104:107], v20 offset:0
    ds_read_b128 v[108:111], v20 offset:1024
    ds_read_b128 v[112:115], v20 offset:2048
    v_lshlrev_b32 v6, 2, v1
    s_mov_b32 s50, 0x20000
    s_mov_b32 s44, 0x01010101
    s_mov_b64 exec, 15
P4_poll:
    buffer_load_dword v5, v6, s[28:31], s53 offen sc1
    s_sub_u32 s50, s50, 1
    s_cbranch_scc1 P4_poll_x
    s_waitcnt vmcnt(0)
    v_cmp_ne_u32 vcc, s44, v5
    s_cbranch_vccnz P4_poll
P4_poll_x:
    s_mov_b64 exec, -1
    s_waitcnt vmcnt(0)
    buffer_load_dwordx4 v[24:27], v4, s[8:11], s36 offen offset:0 sc1
    buffer_load_dwordx4 v[28:31], v4, s[8:11], s37 offen offset:0 sc1
    buffer_load_dwordx4 v[32:35], v4, s[8:11], s36 offen offset:1024 sc1
    buffer_load_dwordx4 v[36:39], v4, s[8:11], s37 offen offset:1024 sc1
    s_waitcnt vmcnt(2)
    s_waitcnt lgkmcnt(9)
    v_mfma_f32_16x16x32_bf16 v[120:123], v[88:91], v[24:27], 0
    ds_read_b64_tr_b16 v[116:117], v16 offset:8192
    buffer_load_dwordx4 v[40:43], v4, s[8:11], s36 offen offset:2048 sc1
    v_mfma_f32_16x16x32_bf16 v[124:127], v[88:91], v[28:31], 0
    s_waitcnt lgkmcnt(8)
    ds_read_b64_tr_b16 v[118:119], v16 offset:12288
    v_mfma_f32_16x16x32_bf16 v[128:131], v[92:95], v[24:27], 0
    ds_read_b64_tr_b16 v[88:89], v17 offset:8192
    buffer_load_dwordx4 v[44:47], v4, s[8:11], s37 offen offset:2048 sc1
    v_mfma_f32_16x16x32_bf16 v[132:135], v[92:95], v[28:31], 0
    s_waitcnt lgkmcnt(8)
    ds_read_b64_tr_b16 v[90:91], v17 offset:12288
    v_mfma_f32_16x16x32_bf16 v[136:139], v[96:99], v[24:27], 0
    ds_read_b64_tr_b16 v[92:93], v18 offset:8192
    buffer_load_dwordx4 v[48:51], v4, s[8:11], s36 offen offset:3072 sc1
    v_mfma_f32_16x16x32_bf16 v[140:143], v[96:99], v[28:31], 0
    s_waitcnt lgkmcnt(8)
    ds_read_b64_tr_b16 v[94:95], v18 offset:12288
    v_mfma_f32_16x16x32_bf16 v[144:147], v[100:103], v[24:27], 0
    ds_read_b64_tr_b16 v[96:97], v19 offset:8192
    buffer_load_dwordx4 v[52:55], v4, s[8:11], s37 offen offset:3072 sc1
    v_mfma_f32_16x16x32_bf16 v[148:151], v[100:103], v[28:31], 0
    s_waitcnt lgkmcnt(9)
    ds_read_b64_tr_b16 v[98:99], v19 offset:12288
    v_mfma_f32_16x16x32_bf16 v[152:155], v[104:107], v[24:27], 0
    ds_read_b128 v[100:103], v20 offset:3072
    buffer_load_dwordx2 v[56:57], v11, s[8:11], s36 offen sc1
    v_mfma_f32_16x16x32_bf16 v[156:159], v[104:107], v[28:31], 0
    s_waitcnt lgkmcnt(10)
    v_mfma_f32_16x16x32_bf16 v[160:163], v[108:111], v[24:27], 0
    ds_read_b128 v[104:107], v20 offset:4096
    buffer_load_dwordx2 v[58:59], v11, s[8:11], s36 offen offset:512 sc1
    v_mfma_f32_16x16x32_bf16 v[164:167], v[108:111], v[28:31], 0
    s_waitcnt lgkmcnt(10)
    v_mfma_f32_16x16x32_bf16 v[168:171], v[112:115], v[24:27], 0
    ds_read_b128 v[108:111], v20 offset:5120
    buffer_load_dwordx2 v[60:61], v11, s[8:11], s37 offen sc1
    v_mfma_f32_16x16x32_bf16 v[172:175], v[112:115], v[28:31], 0
    s_waitcnt vmcnt(7)
    s_waitcnt lgkmcnt(9)
    v_mfma_f32_16x16x32_bf16 v[120:123], v[116:119], v[32:35], v[120:123]
    ds_read_b64_tr_b16 v[112:113], v16 offset:2048
    buffer_load_dwordx2 v[62:63], v11, s[8:11], s37 offen offset:512 sc1
    v_mfma_f32_16x16x32_bf16 v[124:127], v[116:119], v[36:39], v[124:127]
    s_waitcnt lgkmcnt(8)
    ds_read_b64_tr_b16 v[114:115], v16 offset:6144
    v_mfma_f32_16x16x32_bf16 v[128:131], v[88:91], v[32:35], v[128:131]
    s_add_u32 s36, s36, 5120
    ds_read_b64_tr_b16 v[116:117], v17 offset:2048
    buffer_load_dwordx4 v[64:67], v4, s[8:11], s36 offen offset:0 sc1
    v_mfma_f32_16x16x32_bf16 v[132:135], v[88:91], v[36:39], v[132:135]
    s_waitcnt lgkmcnt(8)
    ds_read_b64_tr_b16 v[118:119], v17 offset:6144
    v_mfma_f32_16x16x32_bf16 v[136:139], v[92:95], v[32:35], v[136:139]
    s_add_u32 s37, s37, 5120
    ds_read_b64_tr_b16 v[88:89], v18 offset:2048
    buffer_load_dwordx4 v[68:71], v4, s[8:11], s37 offen offset:0 sc1
    v_mfma_f32_16x16x32_bf16 v[140:143], v[92:95], v[36:39], v[140:143]
    s_waitcnt lgkmcnt(8)
    ds_read_b64_tr_b16 v[90:91], v18 offset:6144
    v_mfma_f32_16x16x32_bf16 v[144:147], v[96:99], v[32:35], v[144:147]
    ds_read_b64_tr_b16 v[92:93], v19 offset:2048
    buffer_load_dwordx4 v[72:75], v4, s[8:11], s36 offen offset:1024 sc1
    v_mfma_f32_16x16x32_bf16 v[148:151], v[96:99], v[36:39], v[148:151]
    s_waitcnt lgkmcnt(9)
    ds_read_b64_tr_b16 v[94:95], v19 offset:6144
    v_mfma_f32_16x16x32_bf16 v[152:155], v[100:103], v[32:35], v[152:155]
    ds_read_b128 v[96:99], v20 offset:6144
    buffer_load_dwordx4 v[76:79], v4, s[8:11], s37 offen offset:1024 sc1
    v_mfma_f32_16x16x32_bf16 v[156:159], v[100:103], v[36:39], v[156:159]
    s_waitcnt lgkmcnt(10)
    v_mfma_f32_16x16x32_bf16 v[160:163], v[104:107], v[32:35], v[160:163]
    ds_read_b128 v[100:103], v20 offset:7168
    buffer_load_dwordx4 v[80:83], v4, s[8:11], s36 offen offset:2048 sc1
    v_mfma_f32_16x16x32_bf16 v[164:167], v[104:107], v[36:39], v[164:167]
    s_waitcnt lgkmcnt(10)
    v_mfma_f32_16x16x32_bf16 v[168:171], v[108:111], v[32:35], v[168:171]
    ds_read_b128 v[104:107], v20 offset:8192
    buffer_load_dwordx4 v[84:87], v4, s[8:11], s37 offen offset:2048 sc1
    v_mfma_f32_16x16x32_bf16 v[172:175], v[108:111], v[36:39], v[172:175]
    s_waitcnt vmcnt(12)
    s_waitcnt lgkmcnt(9)
    v_mfma_f32_16x16x32_bf16 v[120:123], v[112:115], v[40:43], v[120:123]
    ds_read_b64_tr_b16 v[108:109], v16 offset:10240
    buffer_load_dwordx4 v[24:27], v4, s[8:11], s36 offen offset:3072 sc1
    v_mfma_f32_16x16x32_bf16 v[124:127], v[112:115], v[44:47], v[124:127]
    s_waitcnt lgkmcnt(8)
    ds_read_b64_tr_b16 v[110:111], v16 offset:14336
    v_mfma_f32_16x16x32_bf16 v[128:131], v[116:119], v[40:43], v[128:131]
    ds_read_b64_tr_b16 v[112:113], v17 offset:10240
    buffer_load_dwordx4 v[28:31], v4, s[8:11], s37 offen offset:3072 sc1
    v_mfma_f32_16x16x32_bf16 v[132:135], v[116:119], v[44:47], v[132:135]
    s_waitcnt lgkmcnt(8)
    ds_read_b64_tr_b16 v[114:115], v17 offset:14336
    v_mfma_f32_16x16x32_bf16 v[136:139], v[88:91], v[40:43], v[136:139]
    ds_read_b64_tr_b16 v[116:117], v18 offset:10240
    v_mfma_f32_16x16x32_bf16 v[140:143], v[88:91], v[44:47], v[140:143]
    s_waitcnt lgkmcnt(8)
    ds_read_b64_tr_b16 v[118:119], v18 offset:14336
    v_mfma_f32_16x16x32_bf16 v[144:147], v[92:95], v[40:43], v[144:147]
    s_add_u32 s63, s62, 245760
    ds_read_b64_tr_b16 v[88:89], v19 offset:10240
    buffer_load_dwordx4 a[120:123], v251, s[40:43], s63 offen offset:0 sc1
    v_mfma_f32_16x16x32_bf16 v[148:151], v[92:95], v[44:47], v[148:151]
    s_waitcnt lgkmcnt(9)
    ds_read_b64_tr_b16 v[90:91], v19 offset:14336
    v_mfma_f32_16x16x32_bf16 v[152:155], v[96:99], v[40:43], v[152:155]
    ds_read_b128 v[92:95], v20 offset:9216
    v_mfma_f32_16x16x32_bf16 v[156:159], v[96:99], v[44:47], v[156:159]
    s_waitcnt lgkmcnt(10)
    v_mfma_f32_16x16x32_bf16 v[160:163], v[100:103], v[40:43], v[160:163]
    ds_read_b128 v[96:99], v20 offset:10240
    buffer_load_dwordx4 a[124:127], v251, s[40:43], s63 offen offset:1024 sc1
    v_mfma_f32_16x16x32_bf16 v[164:167], v[100:103], v[44:47], v[164:167]
    s_waitcnt lgkmcnt(10)
    v_mfma_f32_16x16x32_bf16 v[168:171], v[104:107], v[40:43], v[168:171]
    ds_read_b128 v[100:103], v20 offset:11264
    v_mfma_f32_16x16x32_bf16 v[172:175], v[104:107], v[44:47], v[172:175]
    s_waitcnt vmcnt(14)
    s_waitcnt lgkmcnt(9)
    v_mfma_f32_16x16x32_bf16 v[120:123], v[108:111], v[48:51], v[120:123]
    ds_read_b64_tr_b16 v[104:105], v16 offset:16384
    buffer_load_dwordx2 v[32:33], v11, s[8:11], s36 offen sc1
    v_mfma_f32_16x16x32_bf16 v[124:127], v[108:111], v[52:55], v[124:127]
    s_waitcnt lgkmcnt(8)
    ds_read_b64_tr_b16 v[106:107], v16 offset:18432
    v_mfma_f32_16x16x32_bf16 v[128:131], v[112:115], v[48:51], v[128:131]
    ds_read_b64_tr_b16 v[108:109], v17 offset:16384
    buffer_load_dwordx2 v[34:35], v11, s[8:11], s36 offen offset:512 sc1
    v_mfma_f32_16x16x32_bf16 v[132:135], v[112:115], v[52:55], v[132:135]
    s_waitcnt lgkmcnt(8)
    ds_read_b64_tr_b16 v[110:111], v17 offset:18432
    v_mfma_f32_16x16x32_bf16 v[136:139], v[116:119], v[48:51], v[136:139]
    ds_read_b64_tr_b16 v[112:113], v18 offset:16384
    buffer_load_dwordx2 v[36:37], v11, s[8:11], s37 offen sc1
    v_mfma_f32_16x16x32_bf16 v[140:143], v[116:119], v[52:55], v[140:143]
    s_waitcnt lgkmcnt(8)
    ds_read_b64_tr_b16 v[114:115], v18 offset:18432
    v_mfma_f32_16x16x32_bf16 v[144:147], v[88:91], v[48:51], v[144:147]
    ds_read_b64_tr_b16 v[116:117], v19 offset:16384
    buffer_load_dwordx2 v[38:39], v11, s[8:11], s37 offen offset:512 sc1
    v_mfma_f32_16x16x32_bf16 v[148:151], v[88:91], v[52:55], v[148:151]
    s_waitcnt lgkmcnt(9)
    ds_read_b64_tr_b16 v[118:119], v19 offset:18432
    v_mfma_f32_16x16x32_bf16 v[152:155], v[92:95], v[48:51], v[152:155]
    ds_read_b128 v[88:91], v20 offset:12288
    v_mfma_f32_16x16x32_bf16 v[156:159], v[92:95], v[52:55], v[156:159]
    s_waitcnt lgkmcnt(10)
    v_mfma_f32_16x16x32_bf16 v[160:163], v[96:99], v[48:51], v[160:163]
    ds_read_b128 v[92:95], v20 offset:13312
    buffer_load_dwordx4 a[128:131], v251, s[40:43], s63 offen offset:2048 sc1
    v_mfma_f32_16x16x32_bf16 v[164:167], v[96:99], v[52:55], v[164:167]
    s_waitcnt lgkmcnt(10)
    v_mfma_f32_16x16x32_bf16 v[168:171], v[100:103], v[48:51], v[168:171]
    ds_read_b128 v[96:99], v20 offset:14336
    v_mfma_f32_16x16x32_bf16 v[172:175], v[100:103], v[52:55], v[172:175]
    s_waitcnt vmcnt(15)
    s_waitcnt lgkmcnt(9)
    v_mfma_f32_16x16x32_bf16 v[120:123], v[104:107], v[56:59], v[120:123]
    s_add_u32 s36, s36, 5120
    ds_read_b64_tr_b16 v[100:101], v16 offset:20480
    buffer_load_dwordx4 v[40:43], v4, s[8:11], s36 offen offset:0 sc1
    v_mfma_f32_16x16x32_bf16 v[124:127], v[104:107], v[60:63], v[124:127]
    s_waitcnt lgkmcnt(8)
    ds_read_b64_tr_b16 v[102:103], v16 offset:24576
    v_mfma_f32_16x16x32_bf16 v[128:131], v[108:111], v[56:59], v[128:131]
    s_add_u32 s37, s37, 5120
    ds_read_b64_tr_b16 v[104:105], v17 offset:20480
    buffer_load_dwordx4 v[44:47], v4, s[8:11], s37 offen offset:0 sc1
    v_mfma_f32_16x16x32_bf16 v[132:135], v[108:111], v[60:63], v[132:135]
    s_waitcnt lgkmcnt(8)
    ds_read_b64_tr_b16 v[106:107], v17 offset:24576
    v_mfma_f32_16x16x32_bf16 v[136:139], v[112:115], v[56:59], v[136:139]
    ds_read_b64_tr_b16 v[108:109], v18 offset:20480
    v_mfma_f32_16x16x32_bf16 v[140:143], v[112:115], v[60:63], v[140:143]
    s_waitcnt lgkmcnt(8)
    ds_read_b64_tr_b16 v[110:111], v18 offset:24576
    v_mfma_f32_16x16x32_bf16 v[144:147], v[116:119], v[56:59], v[144:147]
    ds_read_b64_tr_b16 v[112:113], v19 offset:20480
    buffer_load_dwordx4 a[132:135], v251, s[40:43], s63 offen offset:3072 sc1
    v_mfma_f32_16x16x32_bf16 v[148:151], v[116:119], v[60:63], v[148:151]
    s_waitcnt lgkmcnt(9)
    ds_read_b64_tr_b16 v[114:115], v19 offset:24576
    v_mfma_f32_16x16x32_bf16 v[152:155], v[88:91], v[56:59], v[152:155]
    ds_read_b128 v[116:119], v20 offset:15360
    v_mfma_f32_16x16x32_bf16 v[156:159], v[88:91], v[60:63], v[156:159]
    s_waitcnt lgkmcnt(10)
    v_mfma_f32_16x16x32_bf16 v[160:163], v[92:95], v[56:59], v[160:163]
    s_add_u32 s63, s63, 4096
    ds_read_b128 v[88:91], v20 offset:16384
    buffer_load_dwordx4 a[136:139], v251, s[40:43], s63 offen offset:0 sc1
    v_mfma_f32_16x16x32_bf16 v[164:167], v[92:95], v[60:63], v[164:167]
    s_waitcnt lgkmcnt(10)
    v_mfma_f32_16x16x32_bf16 v[168:171], v[96:99], v[56:59], v[168:171]
    ds_read_b128 v[92:95], v20 offset:17408
    v_mfma_f32_16x16x32_bf16 v[172:175], v[96:99], v[60:63], v[172:175]
    s_waitcnt vmcnt(17)
    s_waitcnt lgkmcnt(9)
    v_mfma_f32_16x16x32_bf16 v[120:123], v[100:103], v[64:67], v[120:123]
    ds_read_b64_tr_b16 v[96:97], v16 offset:28672
    buffer_load_dwordx4 v[48:51], v4, s[8:11], s36 offen offset:1024 sc1
    v_mfma_f32_16x16x32_bf16 v[124:127], v[100:103], v[68:71], v[124:127]
    s_waitcnt lgkmcnt(8)
    ds_read_b64_tr_b16 v[98:99], v16 offset:32768
    v_mfma_f32_16x16x32_bf16 v[128:131], v[104:107], v[64:67], v[128:131]
    ds_read_b64_tr_b16 v[100:101], v17 offset:28672
    buffer_load_dwordx4 v[52:55], v4, s[8:11], s37 offen offset:1024 sc1
    v_mfma_f32_16x16x32_bf16 v[132:135], v[104:107], v[68:71], v[132:135]
    s_waitcnt lgkmcnt(8)
    ds_read_b64_tr_b16 v[102:103], v17 offset:32768
    v_mfma_f32_16x16x32_bf16 v[136:139], v[108:111], v[64:67], v[136:139]
    ds_read_b64_tr_b16 v[104:105], v18 offset:28672
    v_mfma_f32_16x16x32_bf16 v[140:143], v[108:111], v[68:71], v[140:143]
    s_waitcnt lgkmcnt(8)
    ds_read_b64_tr_b16 v[106:107], v18 offset:32768
    v_mfma_f32_16x16x32_bf16 v[144:147], v[112:115], v[64:67], v[144:147]
    s_add_u32 s63, s62, 286720
    ds_read_b64_tr_b16 v[108:109], v19 offset:28672
    buffer_load_dwordx4 a[140:143], v251, s[40:43], s63 offen offset:0 sc1
    v_mfma_f32_16x16x32_bf16 v[148:151], v[112:115], v[68:71], v[148:151]
    s_waitcnt lgkmcnt(9)
    ds_read_b64_tr_b16 v[110:111], v19 offset:32768
    v_mfma_f32_16x16x32_bf16 v[152:155], v[116:119], v[64:67], v[152:155]
    ds_read_b128 v[112:115], v20 offset:18432
    v_mfma_f32_16x16x32_bf16 v[156:159], v[116:119], v[68:71], v[156:159]
    s_waitcnt lgkmcnt(10)
    v_mfma_f32_16x16x32_bf16 v[160:163], v[88:91], v[64:67], v[160:163]
    ds_read_b128 v[116:119], v20 offset:19456
    buffer_load_dwordx4 a[144:147], v251, s[40:43], s63 offen offset:1024 sc1
    v_mfma_f32_16x16x32_bf16 v[164:167], v[88:91], v[68:71], v[164:167]
    s_waitcnt lgkmcnt(10)
    v_mfma_f32_16x16x32_bf16 v[168:171], v[92:95], v[64:67], v[168:171]
    ds_read_b128 v[88:91], v20 offset:20480
    v_mfma_f32_16x16x32_bf16 v[172:175], v[92:95], v[68:71], v[172:175]
    s_waitcnt vmcnt(19)
    s_waitcnt lgkmcnt(9)
    v_mfma_f32_16x16x32_bf16 v[120:123], v[96:99], v[72:75], v[120:123]
    ds_read_b64_tr_b16 v[92:93], v16 offset:22528
    buffer_load_dwordx4 v[56:59], v4, s[8:11], s36 offen offset:2048 sc1
    v_mfma_f32_16x16x32_bf16 v[124:127], v[96:99], v[76:79], v[124:127]
    s_waitcnt lgkmcnt(8)
    ds_read_b64_tr_b16 v[94:95], v16 offset:26624
    v_mfma_f32_16x16x32_bf16 v[128:131], v[100:103], v[72:75], v[128:131]
    ds_read_b64_tr_b16 v[96:97], v17 offset:22528
    buffer_load_dwordx4 v[60:63], v4, s[8:11], s37 offen offset:2048 sc1
    v_mfma_f32_16x16x32_bf16 v[132:135], v[100:103], v[76:79], v[132:135]
    s_waitcnt lgkmcnt(8)
    ds_read_b64_tr_b16 v[98:99], v17 offset:26624
    v_mfma_f32_16x16x32_bf16 v[136:139], v[104:107], v[72:75], v[136:139]
    ds_read_b64_tr_b16 v[100:101], v18 offset:22528
    buffer_load_dwordx2 v[176:177], v12, s[8:11], s38 offen offset:0 sc1
    v_mfma_f32_16x16x32_bf16 v[140:143], v[104:107], v[76:79], v[140:143]
    s_waitcnt lgkmcnt(8)
    ds_read_b64_tr_b16 v[102:103], v18 offset:26624
    v_mfma_f32_16x16x32_bf16 v[144:147], v[108:111], v[72:75], v[144:147]
    ds_read_b64_tr_b16 v[104:105], v19 offset:22528
    buffer_load_dwordx2 v[178:179], v12, s[8:11], s38 offen offset:512 sc1
    v_mfma_f32_16x16x32_bf16 v[148:151], v[108:111], v[76:79], v[148:151]
    s_waitcnt lgkmcnt(9)
    ds_read_b64_tr_b16 v[106:107], v19 offset:26624
    v_mfma_f32_16x16x32_bf16 v[152:155], v[112:115], v[72:75], v[152:155]
    ds_read_b128 v[108:111], v20 offset:21504
    buffer_load_dwordx2 v[180:181], v12, s[8:11], s39 offen offset:0 sc1
    v_mfma_f32_16x16x32_bf16 v[156:159], v[112:115], v[76:79], v[156:159]
    s_waitcnt lgkmcnt(10)
    v_mfma_f32_16x16x32_bf16 v[160:163], v[116:119], v[72:75], v[160:163]
    ds_read_b128 v[112:115], v20 offset:22528
    buffer_load_dwordx2 v[182:183], v12, s[8:11], s39 offen offset:512 sc1
    v_mfma_f32_16x16x32_bf16 v[164:167], v[116:119], v[76:79], v[164:167]
    s_waitcnt lgkmcnt(10)
    v_mfma_f32_16x16x32_bf16 v[168:171], v[88:91], v[72:75], v[168:171]
    ds_read_b128 v[116:119], v20 offset:23552
    v_mfma_f32_16x16x32_bf16 v[172:175], v[88:91], v[76:79], v[172:175]
    s_waitcnt vmcnt(23)
    s_waitcnt lgkmcnt(9)
    v_mfma_f32_16x16x32_bf16 v[120:123], v[92:95], v[80:83], v[120:123]
    s_mul_i32 s46, s52, 57344
    ds_read_b64_tr_b16 v[88:89], v16 offset:30720
    buffer_load_dwordx4 v[64:67], v4, s[8:11], s36 offen offset:3072 sc1
    v_mfma_f32_16x16x32_bf16 v[124:127], v[92:95], v[84:87], v[124:127]
    s_waitcnt lgkmcnt(8)
    ds_read_b64_tr_b16 v[90:91], v16 offset:34816
    v_mfma_f32_16x16x32_bf16 v[128:131], v[96:99], v[80:83], v[128:131]
    s_mul_i32 s47, s23, 57344
    ds_read_b64_tr_b16 v[92:93], v17 offset:30720
    buffer_load_dwordx4 v[68:71], v4, s[8:11], s37 offen offset:3072 sc1
    v_mfma_f32_16x16x32_bf16 v[132:135], v[96:99], v[84:87], v[132:135]
    s_waitcnt lgkmcnt(8)
    ds_read_b64_tr_b16 v[94:95], v17 offset:34816
    v_mfma_f32_16x16x32_bf16 v[136:139], v[100:103], v[80:83], v[136:139]
    s_add_u32 s46, s46, 7340032
    ds_read_b64_tr_b16 v[96:97], v18 offset:30720
    v_mfma_f32_16x16x32_bf16 v[140:143], v[100:103], v[84:87], v[140:143]
    s_waitcnt lgkmcnt(8)
    ds_read_b64_tr_b16 v[98:99], v18 offset:34816
    v_mfma_f32_16x16x32_bf16 v[144:147], v[104:107], v[80:83], v[144:147]
    s_add_u32 s47, s47, 7340032
    ds_read_b64_tr_b16 v[100:101], v19 offset:30720
    buffer_load_dwordx4 a[148:151], v251, s[40:43], s63 offen offset:2048 sc1
    v_mfma_f32_16x16x32_bf16 v[148:151], v[104:107], v[84:87], v[148:151]
    s_waitcnt lgkmcnt(9)
    ds_read_b64_tr_b16 v[102:103], v19 offset:34816
    v_mfma_f32_16x16x32_bf16 v[152:155], v[108:111], v[80:83], v[152:155]
    s_lshl_b32 s3, s22, 10
    ds_read_b128 v[104:107], v20 offset:24576
    v_mfma_f32_16x16x32_bf16 v[156:159], v[108:111], v[84:87], v[156:159]
    s_waitcnt lgkmcnt(10)
    v_mfma_f32_16x16x32_bf16 v[160:163], v[112:115], v[80:83], v[160:163]
    s_add_u32 s48, s46, s3
    ds_read_b128 v[108:111], v20 offset:25600
    buffer_load_dwordx4 a[152:155], v251, s[40:43], s63 offen offset:3072 sc1
    v_mfma_f32_16x16x32_bf16 v[164:167], v[112:115], v[84:87], v[164:167]
    s_waitcnt lgkmcnt(10)
    v_mfma_f32_16x16x32_bf16 v[168:171], v[116:119], v[80:83], v[168:171]
    s_add_u32 s49, s47, s3
    ds_read_b128 v[112:115], v20 offset:26624
    v_mfma_f32_16x16x32_bf16 v[172:175], v[116:119], v[84:87], v[172:175]
    s_waitcnt vmcnt(25)
    s_waitcnt lgkmcnt(9)
    v_mfma_f32_16x16x32_bf16 v[120:123], v[88:91], v[24:27], v[120:123]
    s_and_b32 s50, s22, 1
    ds_read_b64_tr_b16 v[116:117], v16 offset:36864
    buffer_load_dwordx2 v[72:73], v11, s[8:11], s36 offen sc1
    v_mfma_f32_16x16x32_bf16 v[124:127], v[88:91], v[28:31], v[124:127]
    s_waitcnt lgkmcnt(8)
    ds_read_b64_tr_b16 v[118:119], v16 offset:38912
    v_mfma_f32_16x16x32_bf16 v[128:131], v[92:95], v[24:27], v[128:131]
    ds_read_b64_tr_b16 v[88:89], v17 offset:36864
    buffer_load_dwordx2 v[74:75], v11, s[8:11], s36 offen offset:512 sc1
    s_xor_b32 s50, s50, s52
    v_mfma_f32_16x16x32_bf16 v[132:135], v[92:95], v[28:31], v[132:135]
    s_waitcnt lgkmcnt(8)
    ds_read_b64_tr_b16 v[90:91], v17 offset:38912
    v_mfma_f32_16x16x32_bf16 v[136:139], v[96:99], v[24:27], v[136:139]
    s_mul_i32 s50, s50, 20480
    ds_read_b64_tr_b16 v[92:93], v18 offset:36864
    buffer_load_dwordx2 v[76:77], v11, s[8:11], s37 offen sc1
    v_mfma_f32_16x16x32_bf16 v[140:143], v[96:99], v[28:31], v[140:143]
    s_waitcnt lgkmcnt(8)
    ds_read_b64_tr_b16 v[94:95], v18 offset:38912
    v_mfma_f32_16x16x32_bf16 v[144:147], v[100:103], v[24:27], v[144:147]
    s_add_u32 s46, s48, s3
    ds_read_b64_tr_b16 v[96:97], v19 offset:36864
    buffer_load_dwordx2 v[78:79], v11, s[8:11], s37 offen offset:512 sc1
    v_mfma_f32_16x16x32_bf16 v[148:151], v[100:103], v[28:31], v[148:151]
    s_waitcnt lgkmcnt(9)
    ds_read_b64_tr_b16 v[98:99], v19 offset:38912
    v_mfma_f32_16x16x32_bf16 v[152:155], v[104:107], v[24:27], v[152:155]
    s_add_u32 s47, s49, s3
    ds_read_b128 v[100:103], v20 offset:27648
    v_mfma_f32_16x16x32_bf16 v[156:159], v[104:107], v[28:31], v[156:159]
    s_waitcnt lgkmcnt(10)
    v_mfma_f32_16x16x32_bf16 v[160:163], v[108:111], v[24:27], v[160:163]
    s_add_u32 s63, s63, 4096
    ds_read_b128 v[104:107], v20 offset:28672
    buffer_load_dwordx4 a[156:159], v251, s[40:43], s63 offen offset:0 sc1
    v_mfma_f32_16x16x32_bf16 v[164:167], v[108:111], v[28:31], v[164:167]
    s_waitcnt lgkmcnt(10)
    v_mfma_f32_16x16x32_bf16 v[168:171], v[112:115], v[24:27], v[168:171]
    s_lshr_b32 s3, s22, 1
    ds_read_b128 v[108:111], v20 offset:29696
    v_mfma_f32_16x16x32_bf16 v[172:175], v[112:115], v[28:31], v[172:175]
    s_waitcnt vmcnt(24)
    s_waitcnt lgkmcnt(9)
    v_mfma_f32_16x16x32_bf16 v[120:123], v[116:119], v[32:35], v[120:123]
    s_add_u32 s36, s36, 5120
    ds_read_b64_tr_b16 v[112:113], v16 offset:40960
    buffer_load_dwordx4 v[80:83], v4, s[8:11], s36 offen offset:0 sc1
    v_mfma_f32_16x16x32_bf16 v[124:127], v[116:119], v[36:39], v[124:127]
    s_waitcnt lgkmcnt(8)
    ds_read_b64_tr_b16 v[114:115], v16 offset:45056
    v_mfma_f32_16x16x32_bf16 v[128:131], v[88:91], v[32:35], v[128:131]
    s_add_u32 s37, s37, 5120
    ds_read_b64_tr_b16 v[116:117], v17 offset:40960
    buffer_load_dwordx4 v[84:87], v4, s[8:11], s37 offen offset:0 sc1
    v_mfma_f32_16x16x32_bf16 v[132:135], v[88:91], v[36:39], v[132:135]
    s_waitcnt lgkmcnt(8)
    ds_read_b64_tr_b16 v[118:119], v17 offset:45056
    v_mfma_f32_16x16x32_bf16 v[136:139], v[92:95], v[32:35], v[136:139]
    s_lshl_b32 s3, s3, 10
    ds_read_b64_tr_b16 v[88:89], v18 offset:40960
    v_mfma_f32_16x16x32_bf16 v[140:143], v[92:95], v[36:39], v[140:143]
    s_waitcnt lgkmcnt(8)
    ds_read_b64_tr_b16 v[90:91], v18 offset:45056
    v_mfma_f32_16x16x32_bf16 v[144:147], v[96:99], v[32:35], v[144:147]
    s_add_u32 s63, s96, 0
    ds_read_b64_tr_b16 v[92:93], v19 offset:40960
    buffer_load_dwordx4 a[160:163], v251, s[40:43], s63 offen offset:0 sc1
    v_mfma_f32_16x16x32_bf16 v[148:151], v[96:99], v[36:39], v[148:151]
    s_waitcnt lgkmcnt(9)
    ds_read_b64_tr_b16 v[94:95], v19 offset:45056
    v_mfma_f32_16x16x32_bf16 v[152:155], v[100:103], v[32:35], v[152:155]
    s_add_u32 s50, s50, s3
    ds_read_b128 v[96:99], v20 offset:30720
    v_mfma_f32_16x16x32_bf16 v[156:159], v[100:103], v[36:39], v[156:159]
    s_waitcnt lgkmcnt(10)
    v_mfma_f32_16x16x32_bf16 v[160:163], v[104:107], v[32:35], v[160:163]
    ds_read_b128 v[100:103], v20 offset:31744
    buffer_load_dwordx4 a[164:167], v251, s[40:43], s63 offen offset:1024 sc1
    s_xor_b32 s99, s51, 1
    v_mfma_f32_16x16x32_bf16 v[164:167], v[104:107], v[36:39], v[164:167]
    s_waitcnt lgkmcnt(10)
    v_mfma_f32_16x16x32_bf16 v[168:171], v[108:111], v[32:35], v[168:171]
    s_mul_i32 s99, s99, 3145728
    ds_read_b128 v[104:107], v20 offset:32768
    v_mfma_f32_16x16x32_bf16 v[172:175], v[108:111], v[36:39], v[172:175]
    s_waitcnt vmcnt(25)
    s_waitcnt lgkmcnt(9)
    v_mfma_f32_16x16x32_bf16 v[120:123], v[112:115], v[40:43], v[120:123]
    s_add_u32 s50, s50, s99
    ds_read_b64_tr_b16 v[108:109], v16 offset:49152
    buffer_load_dwordx4 v[24:27], v4, s[8:11], s36 offen offset:1024 sc1
    v_mfma_f32_16x16x32_bf16 v[124:127], v[112:115], v[44:47], v[124:127]
    s_waitcnt lgkmcnt(8)
    ds_read_b64_tr_b16 v[110:111], v16 offset:53248
    v_mfma_f32_16x16x32_bf16 v[128:131], v[116:119], v[40:43], v[128:131]
    s_lshr_b32 s3, s22, 3
    ds_read_b64_tr_b16 v[112:113], v17 offset:49152
    buffer_load_dwordx4 v[28:31], v4, s[8:11], s37 offen offset:1024 sc1
    v_mfma_f32_16x16x32_bf16 v[132:135], v[116:119], v[44:47], v[132:135]
    s_waitcnt lgkmcnt(8)
    ds_read_b64_tr_b16 v[114:115], v17 offset:53248
    v_mfma_f32_16x16x32_bf16 v[136:139], v[88:91], v[40:43], v[136:139]
    s_and_b32 s48, s22, 3
    ds_read_b64_tr_b16 v[116:117], v18 offset:49152
    v_mfma_f32_16x16x32_bf16 v[140:143], v[88:91], v[44:47], v[140:143]
    s_waitcnt lgkmcnt(8)
    ds_read_b64_tr_b16 v[118:119], v18 offset:53248
    v_mfma_f32_16x16x32_bf16 v[144:147], v[92:95], v[40:43], v[144:147]
    ds_read_b64_tr_b16 v[88:89], v19 offset:49152
    buffer_load_dwordx4 a[168:171], v251, s[40:43], s63 offen offset:2048 sc1
    s_lshl2_add_u32 s48, s3, s48
    v_mfma_f32_16x16x32_bf16 v[148:151], v[92:95], v[44:47], v[148:151]
    s_waitcnt lgkmcnt(9)
    ds_read_b64_tr_b16 v[90:91], v19 offset:53248
    v_mfma_f32_16x16x32_bf16 v[152:155], v[96:99], v[40:43], v[152:155]
    s_mul_i32 s3, s52, 20
    ds_read_b128 v[92:95], v20 offset:33792
    v_mfma_f32_16x16x32_bf16 v[156:159], v[96:99], v[44:47], v[156:159]
    s_waitcnt lgkmcnt(10)
    v_mfma_f32_16x16x32_bf16 v[160:163], v[100:103], v[40:43], v[160:163]
    s_add_u32 s48, s48, s3
    ds_read_b128 v[96:99], v20 offset:34816
    buffer_load_dwordx4 a[172:175], v251, s[40:43], s63 offen offset:3072 sc1
    v_mfma_f32_16x16x32_bf16 v[164:167], v[100:103], v[44:47], v[164:167]
    s_waitcnt lgkmcnt(10)
    v_mfma_f32_16x16x32_bf16 v[168:171], v[104:107], v[40:43], v[168:171]
    s_add_u32 s48, s48, 8
    ds_read_b128 v[100:103], v20 offset:35840
    v_mfma_f32_16x16x32_bf16 v[172:175], v[104:107], v[44:47], v[172:175]
    s_waitcnt vmcnt(25)
    s_waitcnt lgkmcnt(9)
    v_mfma_f32_16x16x32_bf16 v[120:123], v[108:111], v[48:51], v[120:123]
    s_lshl_b32 s48, s48, 10
    ds_read_b64_tr_b16 v[104:105], v16 offset:43008
    buffer_load_dwordx4 v[32:35], v4, s[8:11], s36 offen offset:2048 sc1
    v_mfma_f32_16x16x32_bf16 v[124:127], v[108:111], v[52:55], v[124:127]
    s_waitcnt lgkmcnt(8)
    ds_read_b64_tr_b16 v[106:107], v16 offset:47104
    v_mfma_f32_16x16x32_bf16 v[128:131], v[112:115], v[48:51], v[128:131]
    s_add_u32 s48, s48, s99
    ds_read_b64_tr_b16 v[108:109], v17 offset:43008
    buffer_load_dwordx4 v[36:39], v4, s[8:11], s37 offen offset:2048 sc1
    v_mfma_f32_16x16x32_bf16 v[132:135], v[112:115], v[52:55], v[132:135]
    s_waitcnt lgkmcnt(8)
    ds_read_b64_tr_b16 v[110:111], v17 offset:47104
    v_mfma_f32_16x16x32_bf16 v[136:139], v[116:119], v[48:51], v[136:139]
    s_and_b32 s49, s23, 15
    ds_read_b64_tr_b16 v[112:113], v18 offset:43008
    v_mfma_f32_16x16x32_bf16 v[140:143], v[116:119], v[52:55], v[140:143]
    s_waitcnt lgkmcnt(8)
    ds_read_b64_tr_b16 v[114:115], v18 offset:47104
    v_mfma_f32_16x16x32_bf16 v[144:147], v[88:91], v[48:51], v[144:147]
    s_add_u32 s63, s63, 4096
    ds_read_b64_tr_b16 v[116:117], v19 offset:43008
    buffer_load_dwordx4 a[176:179], v251, s[40:43], s63 offen offset:0 sc1
    v_mfma_f32_16x16x32_bf16 v[148:151], v[88:91], v[52:55], v[148:151]
    s_waitcnt lgkmcnt(9)
    ds_read_b64_tr_b16 v[118:119], v19 offset:47104
    v_mfma_f32_16x16x32_bf16 v[152:155], v[92:95], v[48:51], v[152:155]
    s_lshr_b32 s3, s23, 4
    ds_read_b128 v[88:91], v20 offset:36864
    v_mfma_f32_16x16x32_bf16 v[156:159], v[92:95], v[52:55], v[156:159]
    s_waitcnt lgkmcnt(10)
    v_mfma_f32_16x16x32_bf16 v[160:163], v[96:99], v[48:51], v[160:163]
    s_add_u32 s63, s96, 40960
    ds_read_b128 v[92:95], v20 offset:37888
    buffer_load_dwordx4 a[180:183], v251, s[40:43], s63 offen offset:0 sc1
    v_mfma_f32_16x16x32_bf16 v[164:167], v[96:99], v[52:55], v[164:167]
    s_waitcnt lgkmcnt(10)
    v_mfma_f32_16x16x32_bf16 v[168:171], v[100:103], v[48:51], v[168:171]
    ds_read_b128 v[96:99], v20 offset:38912
    s_lshl4_add_u32 s49, s49, s3
    v_mfma_f32_16x16x32_bf16 v[172:175], v[100:103], v[52:55], v[172:175]
    s_waitcnt vmcnt(25)
    s_waitcnt lgkmcnt(9)
    v_mfma_f32_16x16x32_bf16 v[120:123], v[104:107], v[56:59], v[120:123]
    s_add_u32 s49, s49, 8
    ds_read_b64_tr_b16 v[100:101], v16 offset:51200
    buffer_load_dwordx4 v[40:43], v4, s[8:11], s36 offen offset:3072 sc1
    s_waitcnt vmcnt(22)
    v_mfma_f32_16x16x32_bf16 v[124:127], v[104:107], v[60:63], v[124:127]
    s_waitcnt lgkmcnt(8)
    ds_read_b64_tr_b16 v[102:103], v16 offset:55296
    v_add_f32 v176, v176, v178
    v_mfma_f32_16x16x32_bf16 v[128:131], v[108:111], v[56:59], v[128:131]
    s_lshr_b32 s3, s22, 3
    ds_read_b64_tr_b16 v[104:105], v17 offset:51200
    buffer_load_dwordx4 v[44:47], v4, s[8:11], s37 offen offset:3072 sc1
    v_mfma_f32_16x16x32_bf16 v[132:135], v[108:111], v[60:63], v[132:135]
    s_waitcnt lgkmcnt(8)
    ds_read_b64_tr_b16 v[106:107], v17 offset:55296
    v_add_f32 v177, v177, v179
    v_mfma_f32_16x16x32_bf16 v[136:139], v[112:115], v[56:59], v[136:139]
    ds_read_b64_tr_b16 v[108:109], v18 offset:51200
    s_lshl1_add_u32 s49, s49, s3
    v_mov_b32 v178, v176
    v_mfma_f32_16x16x32_bf16 v[140:143], v[112:115], v[60:63], v[140:143]
    s_waitcnt lgkmcnt(8)
    ds_read_b64_tr_b16 v[110:111], v18 offset:55296
    v_mov_b32 v179, v177
    v_mfma_f32_16x16x32_bf16 v[144:147], v[116:119], v[56:59], v[144:147]
    s_and_b32 s3, s22, 3
    ds_read_b64_tr_b16 v[112:113], v19 offset:51200
    buffer_load_dwordx4 a[184:187], v251, s[40:43], s63 offen offset:1024 sc1
    v_mfma_f32_16x16x32_bf16 v[148:151], v[116:119], v[60:63], v[148:151]
    s_waitcnt lgkmcnt(9)
    ds_read_b64_tr_b16 v[114:115], v19 offset:55296
    v_mfma_f32_16x16x32_bf16 v[152:155], v[88:91], v[56:59], v[152:155]
    ds_read_b128 v[116:119], v20 offset:39936
    s_lshl2_add_u32 s49, s49, s3
    v_mfma_f32_16x16x32_bf16 v[156:159], v[88:91], v[60:63], v[156:159]
    s_waitcnt lgkmcnt(10)
    v_permlane32_swap_b32 v176, v178
    v_mfma_f32_16x16x32_bf16 v[160:163], v[92:95], v[56:59], v[160:163]
    s_lshl_b32 s49, s49, 10
    ds_read_b128 v[88:91], v20 offset:40960
    buffer_load_dwordx4 a[188:191], v251, s[40:43], s63 offen offset:2048 sc1
    v_mfma_f32_16x16x32_bf16 v[164:167], v[92:95], v[60:63], v[164:167]
    s_waitcnt lgkmcnt(10)
    v_permlane32_swap_b32 v177, v179
    v_mfma_f32_16x16x32_bf16 v[168:171], v[96:99], v[56:59], v[168:171]
    s_lshr_b32 s3, s22, 3
    ds_read_b128 v[92:95], v20 offset:41984
    v_add_f32 v176, v176, v178
    v_mfma_f32_16x16x32_bf16 v[172:175], v[96:99], v[60:63], v[172:175]
    s_waitcnt vmcnt(23)
    v_add_f32 v177, v177, v179
    v_mov_b32 v178, v176
    s_waitcnt lgkmcnt(9)
    v_mfma_f32_16x16x32_bf16 v[120:123], v[100:103], v[64:67], v[120:123]
    s_lshl_b32 s39, s21, 1
    ds_read_b64_tr_b16 v[96:97], v16 offset:57344
    buffer_load_dwordx2 v[48:49], v11, s[8:11], s36 offen sc1
    v_mfma_f32_16x16x32_bf16 v[124:127], v[100:103], v[68:71], v[124:127]
    s_waitcnt lgkmcnt(8)
    ds_read_b64_tr_b16 v[98:99], v16 offset:59392
    v_mov_b32 v179, v177
    v_mfma_f32_16x16x32_bf16 v[128:131], v[104:107], v[64:67], v[128:131]
    s_add_u32 s39, s39, s3
    ds_read_b64_tr_b16 v[100:101], v17 offset:57344
    buffer_load_dwordx2 v[50:51], v11, s[8:11], s36 offen offset:512 sc1
    v_mfma_f32_16x16x32_bf16 v[132:135], v[104:107], v[68:71], v[132:135]
    s_waitcnt lgkmcnt(8)
    ds_read_b64_tr_b16 v[102:103], v17 offset:59392
    v_mfma_f32_16x16x32_bf16 v[136:139], v[108:111], v[64:67], v[136:139]
    s_lshl_b32 s39, s39, 2
    ds_read_b64_tr_b16 v[104:105], v18 offset:57344
    buffer_load_dwordx2 v[52:53], v11, s[8:11], s37 offen sc1
    v_mfma_f32_16x16x32_bf16 v[140:143], v[108:111], v[68:71], v[140:143]
    s_waitcnt lgkmcnt(8)
    ds_read_b64_tr_b16 v[106:107], v18 offset:59392
    v_mfma_f32_16x16x32_bf16 v[144:147], v[112:115], v[64:67], v[144:147]
    s_add_u32 s39, s39, s20
    ds_read_b64_tr_b16 v[108:109], v19 offset:57344
    buffer_load_dwordx2 v[54:55], v11, s[8:11], s37 offen offset:512 sc1
    v_mfma_f32_16x16x32_bf16 v[148:151], v[112:115], v[68:71], v[148:151]
    s_waitcnt lgkmcnt(9)
    ds_read_b64_tr_b16 v[110:111], v19 offset:59392
    v_mfma_f32_16x16x32_bf16 v[152:155], v[116:119], v[64:67], v[152:155]
    s_lshr_b32 s44, s22, 1
    ds_read_b128 v[112:115], v20 offset:43008
    v_mfma_f32_16x16x32_bf16 v[156:159], v[116:119], v[68:71], v[156:159]
    s_waitcnt lgkmcnt(10)
    v_permlane16_swap_b32 v176, v178
    v_mfma_f32_16x16x32_bf16 v[160:163], v[88:91], v[64:67], v[160:163]
    s_and_b32 s44, s44, 1
    ds_read_b128 v[116:119], v20 offset:44032
    buffer_load_dwordx4 a[192:195], v251, s[40:43], s63 offen offset:3072 sc1
    v_mfma_f32_16x16x32_bf16 v[164:167], v[88:91], v[68:71], v[164:167]
    s_waitcnt lgkmcnt(10)
    v_permlane16_swap_b32 v177, v179
    v_mfma_f32_16x16x32_bf16 v[168:171], v[92:95], v[64:67], v[168:171]
    s_lshr_b32 s45, s22, 2
    ds_read_b128 v[88:91], v20 offset:45056
    v_add_f32 v176, v176, v178
    v_mfma_f32_16x16x32_bf16 v[172:175], v[92:95], v[68:71], v[172:175]
    s_waitcnt vmcnt(22)
    v_add_f32 v177, v177, v179
    v_mul_f32 v176, 0x3acccccd, v176
    s_waitcnt lgkmcnt(9)
    v_mfma_f32_16x16x32_bf16 v[120:123], v[96:99], v[72:75], v[120:123]
    s_add_u32 s45, s45, s44
    v_add_u32 v16, 61440, v16
    ds_read_b64_tr_b16 v[92:93], v16 offset:0
    v_mfma_f32_16x16x32_bf16 v[124:127], v[96:99], v[76:79], v[124:127]
    s_waitcnt lgkmcnt(8)
    ds_read_b64_tr_b16 v[94:95], v16 offset:4096
    v_mov_b32 v178, 0x3727c5ac
    v_mfma_f32_16x16x32_bf16 v[128:131], v[100:103], v[72:75], v[128:131]
    s_and_b32 s45, s45, 1
    v_add_u32 v17, 61440, v17
    ds_read_b64_tr_b16 v[96:97], v17 offset:0
    v_mfma_f32_16x16x32_bf16 v[132:135], v[100:103], v[76:79], v[132:135]
    s_waitcnt lgkmcnt(8)
    ds_read_b64_tr_b16 v[98:99], v17 offset:4096
    v_fmac_f32 v178, 0x3acccccd, v177
    v_mfma_f32_16x16x32_bf16 v[136:139], v[104:107], v[72:75], v[136:139]
    s_add_u32 s3, s22, s44
    v_add_u32 v18, 61440, v18
    ds_read_b64_tr_b16 v[100:101], v18 offset:0
    v_mfma_f32_16x16x32_bf16 v[140:143], v[104:107], v[76:79], v[140:143]
    s_waitcnt lgkmcnt(8)
    ds_read_b64_tr_b16 v[102:103], v18 offset:4096
    v_fma_f32 v178, -v176, v176, v178
    v_mfma_f32_16x16x32_bf16 v[144:147], v[108:111], v[72:75], v[144:147]
    s_and_b32 s3, s3, 1
    v_add_u32 v19, 61440, v19
    ds_read_b64_tr_b16 v[104:105], v19 offset:0
    v_mfma_f32_16x16x32_bf16 v[148:151], v[108:111], v[76:79], v[148:151]
    s_waitcnt lgkmcnt(9)
    ds_read_b64_tr_b16 v[106:107], v19 offset:4096
    v_max_f32 v178, 0x3727c5ac, v178
    v_mfma_f32_16x16x32_bf16 v[152:155], v[112:115], v[72:75], v[152:155]
    s_add_u32 s63, s63, 4096
    ds_read_b128 v[108:111], v20 offset:46080
    buffer_load_dwordx4 a[196:199], v251, s[40:43], s63 offen offset:0 sc1
    v_mfma_f32_16x16x32_bf16 v[156:159], v[112:115], v[76:79], v[156:159]
    s_waitcnt lgkmcnt(10)
    v_rsq_f32 v186, v178
    v_mfma_f32_16x16x32_bf16 v[160:163], v[116:119], v[72:75], v[160:163]
    s_lshl_b32 s54, s39, 1
    ds_read_b128 v[112:115], v20 offset:47104
    v_mul_f32 v184, v178, v186
    v_mfma_f32_16x16x32_bf16 v[164:167], v[116:119], v[76:79], v[164:167]
    s_waitcnt lgkmcnt(10)
    v_mul_f32 v186, 0xbfb8aa3b, v186
    v_add_f32 v180, v180, v182
    v_mfma_f32_16x16x32_bf16 v[168:171], v[88:91], v[72:75], v[168:171]
    s_add_u32 s63, s96, 81920
    ds_read_b128 v[116:119], v20 offset:48128
    buffer_load_dwordx4 a[200:203], v251, s[40:43], s63 offen offset:0 sc1
    v_mfma_f32_16x16x32_bf16 v[172:175], v[88:91], v[76:79], v[172:175]
    s_waitcnt vmcnt(21)
    v_add_f32 v181, v181, v183
    v_mov_b32 v182, v180
    s_waitcnt lgkmcnt(9)
    v_mfma_f32_16x16x32_bf16 v[120:123], v[92:95], v[80:83], v[120:123]
    s_add_u32 s54, s54, s44
    ds_read_b64_tr_b16 v[88:89], v16 offset:8192
    v_mov_b32 v183, v181
    v_mfma_f32_16x16x32_bf16 v[124:127], v[92:95], v[84:87], v[124:127]
    s_waitcnt lgkmcnt(8)
    ds_read_b64_tr_b16 v[90:91], v16 offset:12288
    v_mfma_f32_16x16x32_bf16 v[128:131], v[96:99], v[80:83], v[128:131]
    s_lshl_b32 s54, s54, 1
    ds_read_b64_tr_b16 v[92:93], v17 offset:8192
    buffer_load_dwordx4 a[204:207], v251, s[40:43], s63 offen offset:1024 sc1
    v_mfma_f32_16x16x32_bf16 v[132:135], v[96:99], v[84:87], v[132:135]
    s_waitcnt lgkmcnt(8)
    ds_read_b64_tr_b16 v[94:95], v17 offset:12288
    v_mfma_f32_16x16x32_bf16 v[136:139], v[100:103], v[80:83], v[136:139]
    s_add_u32 s54, s54, s3
    ds_read_b64_tr_b16 v[96:97], v18 offset:8192
    v_mfma_f32_16x16x32_bf16 v[140:143], v[100:103], v[84:87], v[140:143]
    s_waitcnt lgkmcnt(8)
    ds_read_b64_tr_b16 v[98:99], v18 offset:12288
    v_mfma_f32_16x16x32_bf16 v[144:147], v[104:107], v[80:83], v[144:147]
    s_mul_i32 s54, s54, 5120
    ds_read_b64_tr_b16 v[100:101], v19 offset:8192
    buffer_load_dwordx4 a[208:211], v251, s[40:43], s63 offen offset:2048 sc1
    v_mfma_f32_16x16x32_bf16 v[148:151], v[104:107], v[84:87], v[148:151]
    s_waitcnt lgkmcnt(9)
    ds_read_b64_tr_b16 v[102:103], v19 offset:12288
    v_mfma_f32_16x16x32_bf16 v[152:155], v[108:111], v[80:83], v[152:155]
    s_add_u32 s54, s54, 3145728
    ds_read_b128 v[104:107], v20 offset:49152
    v_mfma_f32_16x16x32_bf16 v[156:159], v[108:111], v[84:87], v[156:159]
    s_waitcnt lgkmcnt(10)
    v_permlane32_swap_b32 v180, v182
    v_mfma_f32_16x16x32_bf16 v[160:163], v[112:115], v[80:83], v[160:163]
    s_lshl_b32 s3, s45, 9
    ds_read_b128 v[108:111], v20 offset:50176
    buffer_load_dwordx4 a[212:215], v251, s[40:43], s63 offen offset:3072 sc1
    v_mfma_f32_16x16x32_bf16 v[164:167], v[112:115], v[84:87], v[164:167]
    s_waitcnt lgkmcnt(10)
    v_permlane32_swap_b32 v181, v183
    v_mfma_f32_16x16x32_bf16 v[168:171], v[116:119], v[80:83], v[168:171]
    s_add_u32 s55, s54, s3
    ds_read_b128 v[112:115], v20 offset:51200
    v_add_f32 v180, v180, v182
    v_mfma_f32_16x16x32_bf16 v[172:175], v[116:119], v[84:87], v[172:175]
    s_waitcnt vmcnt(20)
    v_add_f32 v181, v181, v183
    v_mov_b32 v182, v180
    s_waitcnt lgkmcnt(9)
    v_mfma_f32_16x16x32_bf16 v[120:123], v[88:91], v[24:27], v[120:123]
    s_add_u32 s63, s63, 4096
    ds_read_b64_tr_b16 v[116:117], v16 offset:2048
    buffer_load_dwordx4 a[216:219], v251, s[40:43], s63 offen offset:0 sc1
    v_mfma_f32_16x16x32_bf16 v[124:127], v[88:91], v[28:31], v[124:127]
    s_waitcnt lgkmcnt(8)
    ds_read_b64_tr_b16 v[118:119], v16 offset:6144
    v_mov_b32 v183, v181
    v_mfma_f32_16x16x32_bf16 v[128:131], v[92:95], v[24:27], v[128:131]
    s_add_u32 s55, s55, 4096
    ds_read_b64_tr_b16 v[88:89], v17 offset:2048
    v_mfma_f32_16x16x32_bf16 v[132:135], v[92:95], v[28:31], v[132:135]
    s_waitcnt lgkmcnt(8)
    ds_read_b64_tr_b16 v[90:91], v17 offset:6144
    v_mfma_f32_16x16x32_bf16 v[136:139], v[96:99], v[24:27], v[136:139]
    s_add_u32 s63, s96, 122880
    ds_read_b64_tr_b16 v[92:93], v18 offset:2048
    buffer_load_dwordx4 a[220:223], v251, s[40:43], s63 offen offset:0 sc1
    v_mfma_f32_16x16x32_bf16 v[140:143], v[96:99], v[28:31], v[140:143]
    s_waitcnt lgkmcnt(8)
    ds_read_b64_tr_b16 v[94:95], v18 offset:6144
    v_mfma_f32_16x16x32_bf16 v[144:147], v[100:103], v[24:27], v[144:147]
    s_lshl_b32 s3, s45, 11
    ds_read_b64_tr_b16 v[96:97], v19 offset:2048
    v_mfma_f32_16x16x32_bf16 v[148:151], v[100:103], v[28:31], v[148:151]
    s_waitcnt lgkmcnt(9)
    ds_read_b64_tr_b16 v[98:99], v19 offset:6144
    v_mfma_f32_16x16x32_bf16 v[152:155], v[104:107], v[24:27], v[152:155]
    s_add_u32 s54, s54, s3
    ds_read_b128 v[100:103], v20 offset:52224
    buffer_load_dwordx4 a[224:227], v251, s[40:43], s63 offen offset:1024 sc1
    v_mfma_f32_16x16x32_bf16 v[156:159], v[104:107], v[28:31], v[156:159]
    s_waitcnt lgkmcnt(10)
    v_permlane16_swap_b32 v180, v182
    v_mfma_f32_16x16x32_bf16 v[160:163], v[108:111], v[24:27], v[160:163]
    s_lshl_b32 s98, s39, 6
    ds_read_b128 v[104:107], v20 offset:53248
    v_mfma_f32_16x16x32_bf16 v[164:167], v[108:111], v[28:31], v[164:167]
    s_waitcnt lgkmcnt(10)
    v_permlane16_swap_b32 v181, v183
    v_mfma_f32_16x16x32_bf16 v[168:171], v[112:115], v[24:27], v[168:171]
    s_add_u32 s98, s98, 12582912
    ds_read_b128 v[108:111], v20 offset:54272
    buffer_load_dwordx4 a[228:231], v251, s[40:43], s63 offen offset:2048 sc1
    v_mfma_f32_16x16x32_bf16 v[172:175], v[112:115], v[28:31], v[172:175]
    s_waitcnt vmcnt(20)
    v_add_f32 v180, v180, v182
    v_add_f32 v181, v181, v183
    s_waitcnt lgkmcnt(9)
    v_mfma_f32_16x16x32_bf16 v[120:123], v[116:119], v[32:35], v[120:123]
    s_lshl_b32 s60, s21, 1
    ds_read_b64_tr_b16 v[112:113], v16 offset:10240
    v_mul_f32 v180, 0x3acccccd, v180
    v_mfma_f32_16x16x32_bf16 v[124:127], v[116:119], v[36:39], v[124:127]
    s_waitcnt lgkmcnt(8)
    ds_read_b64_tr_b16 v[114:115], v16 offset:14336
    v_mov_b32 v182, 0x3727c5ac
    v_mfma_f32_16x16x32_bf16 v[128:131], v[88:91], v[32:35], v[128:131]
    s_lshr_b32 s3, s20, 1
    ds_read_b64_tr_b16 v[116:117], v17 offset:10240
    buffer_load_dwordx4 a[232:235], v251, s[40:43], s63 offen offset:3072 sc1
    v_mfma_f32_16x16x32_bf16 v[132:135], v[88:91], v[36:39], v[132:135]
    s_waitcnt lgkmcnt(8)
    ds_read_b64_tr_b16 v[118:119], v17 offset:14336
    v_fmac_f32 v182, 0x3acccccd, v181
    v_mfma_f32_16x16x32_bf16 v[136:139], v[92:95], v[32:35], v[136:139]
    s_add_u32 s60, s60, s3
    ds_read_b64_tr_b16 v[88:89], v18 offset:10240
    v_fma_f32 v182, -v180, v180, v182
    v_mfma_f32_16x16x32_bf16 v[140:143], v[92:95], v[36:39], v[140:143]
    s_waitcnt lgkmcnt(8)
    ds_read_b64_tr_b16 v[90:91], v18 offset:14336
    v_max_f32 v182, 0x3727c5ac, v182
    v_mfma_f32_16x16x32_bf16 v[144:147], v[96:99], v[32:35], v[144:147]
    s_add_u32 s63, s63, 4096
    ds_read_b64_tr_b16 v[92:93], v19 offset:10240
    buffer_load_dwordx4 a[236:239], v251, s[40:43], s63 offen offset:0 sc1
    v_mfma_f32_16x16x32_bf16 v[148:151], v[96:99], v[36:39], v[148:151]
    s_waitcnt lgkmcnt(9)
    ds_read_b64_tr_b16 v[94:95], v19 offset:14336
    v_mfma_f32_16x16x32_bf16 v[152:155], v[100:103], v[32:35], v[152:155]
    s_lshl_b32 s60, s60, 2
    ds_read_b128 v[96:99], v20 offset:55296
    v_mfma_f32_16x16x32_bf16 v[156:159], v[100:103], v[36:39], v[156:159]
    s_waitcnt lgkmcnt(10)
    v_rsq_f32 v190, v182
    v_mfma_f32_16x16x32_bf16 v[160:163], v[104:107], v[32:35], v[160:163]
    s_add_u32 s63, s97, 0
    ds_read_b128 v[100:103], v20 offset:56320
    buffer_load_dwordx4 a[240:243], v251, s[40:43], s63 offen offset:0 sc1
    v_mfma_f32_16x16x32_bf16 v[164:167], v[104:107], v[36:39], v[164:167]
    s_waitcnt lgkmcnt(10)
    v_mul_f32 v188, v182, v190
    v_mul_f32 v190, 0xbfb8aa3b, v190
    v_mfma_f32_16x16x32_bf16 v[168:171], v[108:111], v[32:35], v[168:171]
    s_lshr_b32 s3, s22, 2
    ds_read_b128 v[104:107], v20 offset:57344
    v_mfma_f32_16x16x32_bf16 v[172:175], v[108:111], v[36:39], v[172:175]
    s_waitcnt vmcnt(19)
    s_waitcnt lgkmcnt(9)
    v_mfma_f32_16x16x32_bf16 v[120:123], v[112:115], v[40:43], v[120:123]
    s_add_u32 s60, s60, s3
    ds_read_b64_tr_b16 v[108:109], v16 offset:16384
    buffer_load_dwordx4 a[244:247], v251, s[40:43], s63 offen offset:1024 sc1
    v_mfma_f32_16x16x32_bf16 v[124:127], v[112:115], v[44:47], v[124:127]
    s_waitcnt lgkmcnt(8)
    ds_read_b64_tr_b16 v[110:111], v16 offset:18432
    v_mfma_f32_16x16x32_bf16 v[128:131], v[116:119], v[40:43], v[128:131]
    s_lshl_b32 s60, s60, 6
    ds_read_b64_tr_b16 v[112:113], v17 offset:16384
    v_mfma_f32_16x16x32_bf16 v[132:135], v[116:119], v[44:47], v[132:135]
    s_waitcnt lgkmcnt(8)
    ds_read_b64_tr_b16 v[114:115], v17 offset:18432
    v_mfma_f32_16x16x32_bf16 v[136:139], v[88:91], v[40:43], v[136:139]
    s_and_b32 s3, s22, 3
    ds_read_b64_tr_b16 v[116:117], v18 offset:16384
    buffer_load_dwordx4 a[248:251], v251, s[40:43], s63 offen offset:2048 sc1
    v_mfma_f32_16x16x32_bf16 v[140:143], v[88:91], v[44:47], v[140:143]
    s_waitcnt lgkmcnt(8)
    ds_read_b64_tr_b16 v[118:119], v18 offset:18432
    v_mfma_f32_16x16x32_bf16 v[144:147], v[92:95], v[40:43], v[144:147]
    s_add_u32 s60, s60, s3
    ds_read_b64_tr_b16 v[88:89], v19 offset:16384
    v_mfma_f32_16x16x32_bf16 v[148:151], v[92:95], v[44:47], v[148:151]
    s_waitcnt lgkmcnt(9)
    ds_read_b64_tr_b16 v[90:91], v19 offset:18432
    v_mfma_f32_16x16x32_bf16 v[152:155], v[96:99], v[40:43], v[152:155]
    s_lshl_b32 s60, s60, 1
    ds_read_b128 v[92:95], v20 offset:58368
    buffer_load_dwordx4 a[252:255], v251, s[40:43], s63 offen offset:3072 sc1
    v_mfma_f32_16x16x32_bf16 v[156:159], v[96:99], v[44:47], v[156:159]
    s_waitcnt lgkmcnt(10)
    v_mfma_f32_16x16x32_bf16 v[160:163], v[100:103], v[40:43], v[160:163]
    s_and_b32 s3, s20, 1
    ds_read_b128 v[96:99], v20 offset:59392
    v_mfma_f32_16x16x32_bf16 v[164:167], v[100:103], v[44:47], v[164:167]
    s_waitcnt lgkmcnt(10)
    v_mfma_f32_16x16x32_bf16 v[168:171], v[104:107], v[40:43], v[168:171]
    s_add_u32 s63, s63, 4096
    ds_read_b128 v[100:103], v20 offset:60416
    buffer_load_dwordx4 v[232:235], v4, s[40:43], s63 offen offset:0 sc1
    v_mfma_f32_16x16x32_bf16 v[172:175], v[104:107], v[44:47], v[172:175]
    s_waitcnt vmcnt(17)
    s_waitcnt lgkmcnt(9)
    v_mfma_f32_16x16x32_bf16 v[120:123], v[108:111], v[48:51], v[120:123]
    s_add_u32 s60, s60, s3
    v_mfma_f32_16x16x32_bf16 v[124:127], v[108:111], v[52:55], v[124:127]
    s_waitcnt lgkmcnt(7)
    v_mfma_f32_16x16x32_bf16 v[128:131], v[112:115], v[48:51], v[128:131]
    s_add_u32 s63, s97, 40960
    buffer_load_dwordx4 v[236:239], v4, s[40:43], s63 offen offset:0 sc1
    v_mfma_f32_16x16x32_bf16 v[132:135], v[112:115], v[52:55], v[132:135]
    s_waitcnt lgkmcnt(5)
    v_mfma_f32_16x16x32_bf16 v[136:139], v[116:119], v[48:51], v[136:139]
    s_add_u32 s60, s60, 8192
    v_mfma_f32_16x16x32_bf16 v[140:143], v[116:119], v[52:55], v[140:143]
    s_waitcnt lgkmcnt(3)
    v_mfma_f32_16x16x32_bf16 v[144:147], v[88:91], v[48:51], v[144:147]
    s_lshl_b32 s53, s39, 7
    buffer_load_dwordx4 v[240:243], v4, s[40:43], s63 offen offset:1024 sc1
    v_mfma_f32_16x16x32_bf16 v[148:151], v[88:91], v[52:55], v[148:151]
    s_waitcnt lgkmcnt(2)
    v_mfma_f32_16x16x32_bf16 v[152:155], v[92:95], v[48:51], v[152:155]
    s_add_u32 s53, s53, 8192
    v_mfma_f32_16x16x32_bf16 v[156:159], v[92:95], v[52:55], v[156:159]
    s_waitcnt lgkmcnt(1)
    v_mfma_f32_16x16x32_bf16 v[160:163], v[96:99], v[48:51], v[160:163]
    s_mul_i32 s3, s44, 48
    buffer_load_dwordx4 v[244:247], v4, s[40:43], s63 offen offset:2048 sc1
    v_xor_b32 v7, s3, v1
    v_mfma_f32_16x16x32_bf16 v[164:167], v[96:99], v[52:55], v[164:167]
    s_waitcnt lgkmcnt(0)
    v_lshlrev_b32 v9, 4, v7
    v_lshlrev_b32 v7, 3, v7
    v_mfma_f32_16x16x32_bf16 v[168:171], v[100:103], v[48:51], v[168:171]
    v_lshlrev_b32 v8, 2, v2
    v_mfma_f32_16x16x32_bf16 v[172:175], v[100:103], v[52:55], v[172:175]
    s_barrier
    buffer_load_dwordx4 v[192:195], v9, s[8:11], s54 offen sc1
    buffer_load_dwordx4 v[196:199], v9, s[8:11], s54 offen offset:1024 sc1
    buffer_load_dwordx2 v[200:201], v7, s[8:11], s55 offen sc1
    buffer_load_dword v202, v8, s[12:15], s98 offen sc1
    v_pk_mul_f32 v[24:25], v[124:125], v[190:191] op_sel_hi:[1,0]
    v_pk_mul_f32 v[26:27], v[126:127], v[190:191] op_sel_hi:[1,0]
    v_pk_mul_f32 v[28:29], v[132:133], v[190:191] op_sel_hi:[1,0]
    v_pk_mul_f32 v[30:31], v[134:135], v[190:191] op_sel_hi:[1,0]
    v_exp_f32 v24, v24
    v_exp_f32 v25, v25
    v_exp_f32 v26, v26
    v_exp_f32 v27, v27
    buffer_load_dwordx4 v[248:251], v4, s[40:43], s63 offen offset:3072 sc1
    v_exp_f32 v28, v28
    v_exp_f32 v29, v29
    v_exp_f32 v30, v30
    v_exp_f32_e64 v31, v31
    v_pk_fma_f32 v[24:25], v[24:25], v[188:189], v[188:189] op_sel_hi:[1,0,0]
    v_pk_fma_f32 v[26:27], v[26:27], v[188:189], v[188:189] op_sel_hi:[1,0,0]
    v_pk_fma_f32 v[28:29], v[28:29], v[188:189], v[188:189] op_sel_hi:[1,0,0]
    v_pk_fma_f32 v[30:31], v[30:31], v[188:189], v[188:189] op_sel_hi:[1,0,0]
    s_add_u32 s63, s63, 4096
    buffer_load_dwordx4 v[252:255], v4, s[40:43], s63 offen offset:0 sc1
    v_rcp_f32 v24, v24
    v_rcp_f32 v25, v25
    v_rcp_f32 v26, v26
    v_rcp_f32 v27, v27
    v_rcp_f32 v28, v28
    v_rcp_f32 v29, v29
    v_rcp_f32 v30, v30
    v_rcp_f32 v31, v31
    v_pk_mul_f32 v[124:125], v[124:125], v[24:25]
    v_pk_mul_f32 v[126:127], v[126:127], v[26:27]
    v_pk_mul_f32 v[132:133], v[132:133], v[28:29]
    v_pk_mul_f32 v[134:135], v[134:135], v[30:31]
    v_cvt_pk_bf16_f32 v60, v124, v125
    v_cvt_pk_bf16_f32 v61, v126, v127
    v_cvt_pk_bf16_f32 v62, v132, v133
    v_cvt_pk_bf16_f32 v63, v134, v135
    buffer_store_dwordx4 v[60:63], v4, s[24:27], s47 offen offset:0 sc1
    v_pk_mul_f32 v[40:41], v[140:141], v[190:191] op_sel_hi:[1,0]
    v_pk_mul_f32 v[42:43], v[142:143], v[190:191] op_sel_hi:[1,0]
    v_pk_mul_f32 v[44:45], v[148:149], v[190:191] op_sel_hi:[1,0]
    v_pk_mul_f32 v[46:47], v[150:151], v[190:191] op_sel_hi:[1,0]
    v_exp_f32 v40, v40
    v_exp_f32 v41, v41
    v_exp_f32 v42, v42
    v_exp_f32 v43, v43
    v_exp_f32 v44, v44
    v_exp_f32 v45, v45
    v_exp_f32 v46, v46
    v_exp_f32 v47, v47
    v_pk_fma_f32 v[40:41], v[40:41], v[188:189], v[188:189] op_sel_hi:[1,0,0]
    v_pk_fma_f32 v[42:43], v[42:43], v[188:189], v[188:189] op_sel_hi:[1,0,0]
    v_pk_fma_f32 v[44:45], v[44:45], v[188:189], v[188:189] op_sel_hi:[1,0,0]
    v_pk_fma_f32 v[46:47], v[46:47], v[188:189], v[188:189] op_sel_hi:[1,0,0]
    v_rcp_f32 v40, v40
    v_rcp_f32 v41, v41
    v_rcp_f32 v42, v42
    v_rcp_f32 v43, v43
    v_rcp_f32 v44, v44
    v_rcp_f32 v45, v45
    v_rcp_f32 v46, v46
    v_rcp_f32 v47, v47
    v_pk_mul_f32 v[140:141], v[140:141], v[40:41]
    v_pk_mul_f32 v[142:143], v[142:143], v[42:43]
    v_pk_mul_f32 v[148:149], v[148:149], v[44:45]
    v_pk_mul_f32 v[150:151], v[150:151], v[46:47]
    v_cvt_pk_bf16_f32 v64, v140, v141
    v_cvt_pk_bf16_f32 v65, v142, v143
    v_cvt_pk_bf16_f32 v66, v148, v149
    v_cvt_pk_bf16_f32 v67, v150, v151
    buffer_store_dwordx4 v[64:67], v4, s[24:27], s47 offen offset:1024 sc1
    v_pk_mul_f32 v[24:25], v[120:121], v[186:187] op_sel_hi:[1,0]
    v_pk_mul_f32 v[26:27], v[122:123], v[186:187] op_sel_hi:[1,0]
    v_pk_mul_f32 v[28:29], v[128:129], v[186:187] op_sel_hi:[1,0]
    v_pk_mul_f32 v[30:31], v[130:131], v[186:187] op_sel_hi:[1,0]
    v_exp_f32 v24, v24
    v_exp_f32 v25, v25
    v_exp_f32 v26, v26
    v_exp_f32 v27, v27
    v_exp_f32 v28, v28
    v_exp_f32 v29, v29
    v_exp_f32 v30, v30
    v_exp_f32 v31, v31
    v_pk_fma_f32 v[24:25], v[24:25], v[184:185], v[184:185] op_sel_hi:[1,0,0]
    v_pk_fma_f32 v[26:27], v[26:27], v[184:185], v[184:185] op_sel_hi:[1,0,0]
    v_pk_fma_f32 v[28:29], v[28:29], v[184:185], v[184:185] op_sel_hi:[1,0,0]
    v_pk_fma_f32 v[30:31], v[30:31], v[184:185], v[184:185] op_sel_hi:[1,0,0]
    v_rcp_f32 v24, v24
    v_rcp_f32 v25, v25
    v_rcp_f32 v26, v26
    v_rcp_f32 v27, v27
    v_rcp_f32 v28, v28
    v_rcp_f32 v29, v29
    v_rcp_f32 v30, v30
    v_rcp_f32 v31, v31
    v_pk_mul_f32 v[120:121], v[120:121], v[24:25]
    v_pk_mul_f32 v[122:123], v[122:123], v[26:27]
    v_pk_mul_f32 v[128:129], v[128:129], v[28:29]
    v_pk_mul_f32 v[130:131], v[130:131], v[30:31]
    v_cvt_pk_bf16_f32 v68, v120, v121
    v_cvt_pk_bf16_f32 v69, v122, v123
    v_cvt_pk_bf16_f32 v70, v128, v129
    v_cvt_pk_bf16_f32 v71, v130, v131
    buffer_store_dwordx4 v[68:71], v4, s[24:27], s46 offen offset:0 sc1
    v_pk_mul_f32 v[40:41], v[136:137], v[186:187] op_sel_hi:[1,0]
    v_pk_mul_f32 v[42:43], v[138:139], v[186:187] op_sel_hi:[1,0]
    v_pk_mul_f32 v[44:45], v[144:145], v[186:187] op_sel_hi:[1,0]
    v_pk_mul_f32 v[46:47], v[146:147], v[186:187] op_sel_hi:[1,0]
    v_exp_f32 v40, v40
    v_exp_f32 v41, v41
    v_exp_f32 v42, v42
    v_exp_f32 v43, v43
    v_exp_f32 v44, v44
    v_exp_f32 v45, v45
    v_exp_f32 v46, v46
    v_exp_f32 v47, v47
    v_pk_fma_f32 v[40:41], v[40:41], v[184:185], v[184:185] op_sel_hi:[1,0,0]
    v_pk_fma_f32 v[42:43], v[42:43], v[184:185], v[184:185] op_sel_hi:[1,0,0]
    v_pk_fma_f32 v[44:45], v[44:45], v[184:185], v[184:185] op_sel_hi:[1,0,0]
    v_pk_fma_f32 v[46:47], v[46:47], v[184:185], v[184:185] op_sel_hi:[1,0,0]
    v_rcp_f32 v40, v40
    v_rcp_f32 v41, v41
    v_rcp_f32 v42, v42
    v_rcp_f32 v43, v43
    v_rcp_f32 v44, v44
    v_rcp_f32 v45, v45
    v_rcp_f32 v46, v46
    v_rcp_f32 v47, v47
    v_pk_mul_f32 v[136:137], v[136:137], v[40:41]
    v_pk_mul_f32 v[138:139], v[138:139], v[42:43]
    v_pk_mul_f32 v[144:145], v[144:145], v[44:45]
    v_pk_mul_f32 v[146:147], v[146:147], v[46:47]
    v_cvt_pk_bf16_f32 v72, v136, v137
    v_cvt_pk_bf16_f32 v73, v138, v139
    v_cvt_pk_bf16_f32 v74, v144, v145
    v_cvt_pk_bf16_f32 v75, v146, v147
    buffer_store_dwordx4 v[72:75], v4, s[24:27], s46 offen offset:1024 sc1
    v_pk_mul_f32 v[24:25], v[156:157], v[190:191] op_sel_hi:[1,0]
    v_pk_mul_f32 v[26:27], v[158:159], v[190:191] op_sel_hi:[1,0]
    v_pk_mul_f32 v[28:29], v[164:165], v[190:191] op_sel_hi:[1,0]
    v_pk_mul_f32 v[30:31], v[166:167], v[190:191] op_sel_hi:[1,0]
    v_exp_f32 v24, v24
    v_exp_f32 v25, v25
    v_exp_f32 v26, v26
    v_exp_f32 v27, v27
    v_exp_f32 v28, v28
    v_exp_f32 v29, v29
    v_exp_f32 v30, v30
    v_exp_f32 v31, v31
    v_pk_fma_f32 v[24:25], v[24:25], v[188:189], v[188:189] op_sel_hi:[1,0,0]
    v_pk_fma_f32 v[26:27], v[26:27], v[188:189], v[188:189] op_sel_hi:[1,0,0]
    v_pk_fma_f32 v[28:29], v[28:29], v[188:189], v[188:189] op_sel_hi:[1,0,0]
    v_pk_fma_f32 v[30:31], v[30:31], v[188:189], v[188:189] op_sel_hi:[1,0,0]
    v_rcp_f32 v24, v24
    v_rcp_f32 v25, v25
    v_rcp_f32 v26, v26
    v_rcp_f32 v27, v27
    v_rcp_f32 v28, v28
    v_rcp_f32 v29, v29
    v_rcp_f32 v30, v30
    v_rcp_f32 v31, v31
    v_pk_mul_f32 v[156:157], v[156:157], v[24:25]
    v_pk_mul_f32 v[158:159], v[158:159], v[26:27]
    v_pk_mul_f32 v[164:165], v[164:165], v[28:29]
    v_pk_mul_f32 v[166:167], v[166:167], v[30:31]
    v_cvt_pk_bf16_f32 v60, v156, v157
    v_cvt_pk_bf16_f32 v61, v158, v159
    v_cvt_pk_bf16_f32 v62, v164, v165
    v_cvt_pk_bf16_f32 v63, v166, v167
    buffer_store_dwordx4 v[60:63], v4, s[8:11], s49 offen
    v_pk_mul_f32 v[40:41], v[152:153], v[186:187] op_sel_hi:[1,0]
    v_pk_mul_f32 v[42:43], v[154:155], v[186:187] op_sel_hi:[1,0]
    v_pk_mul_f32 v[44:45], v[160:161], v[186:187] op_sel_hi:[1,0]
    v_pk_mul_f32 v[46:47], v[162:163], v[186:187] op_sel_hi:[1,0]
    v_exp_f32 v40, v40
    v_exp_f32 v41, v41
    v_exp_f32 v42, v42
    v_exp_f32 v43, v43
    v_exp_f32 v44, v44
    v_exp_f32 v45, v45
    v_exp_f32 v46, v46
    v_exp_f32 v47, v47
    v_pk_fma_f32 v[40:41], v[40:41], v[184:185], v[184:185] op_sel_hi:[1,0,0]
    v_pk_fma_f32 v[42:43], v[42:43], v[184:185], v[184:185] op_sel_hi:[1,0,0]
    v_pk_fma_f32 v[44:45], v[44:45], v[184:185], v[184:185] op_sel_hi:[1,0,0]
    v_pk_fma_f32 v[46:47], v[46:47], v[184:185], v[184:185] op_sel_hi:[1,0,0]
    v_rcp_f32 v40, v40
    v_rcp_f32 v41, v41
    v_rcp_f32 v42, v42
    v_rcp_f32 v43, v43
    v_rcp_f32 v44, v44
    v_rcp_f32 v45, v45
    v_rcp_f32 v46, v46
    v_rcp_f32 v47, v47
    v_pk_mul_f32 v[152:153], v[152:153], v[40:41]
    v_pk_mul_f32 v[154:155], v[154:155], v[42:43]
    v_pk_mul_f32 v[160:161], v[160:161], v[44:45]
    v_pk_mul_f32 v[162:163], v[162:163], v[46:47]
    v_cvt_pk_bf16_f32 v64, v152, v153
    v_cvt_pk_bf16_f32 v65, v154, v155
    v_cvt_pk_bf16_f32 v66, v160, v161
    v_cvt_pk_bf16_f32 v67, v162, v163
    buffer_store_dwordx4 v[64:67], v4, s[24:27], s48 offen
    v_pk_mul_f32 v[24:25], v[168:169], v[186:187] op_sel_hi:[1,0]
    v_pk_mul_f32 v[26:27], v[170:171], v[186:187] op_sel_hi:[1,0]
    v_pk_mul_f32 v[28:29], v[172:173], v[190:191] op_sel_hi:[1,0]
    v_pk_mul_f32 v[30:31], v[174:175], v[190:191] op_sel_hi:[1,0]
    v_exp_f32 v24, v24
    v_exp_f32 v25, v25
    v_exp_f32 v26, v26
    v_exp_f32 v27, v27
    v_exp_f32 v28, v28
    v_exp_f32 v29, v29
    v_exp_f32 v30, v30
    v_exp_f32 v31, v31
    v_pk_fma_f32 v[24:25], v[24:25], v[184:185], v[184:185] op_sel_hi:[1,0,0]
    v_pk_fma_f32 v[26:27], v[26:27], v[184:185], v[184:185] op_sel_hi:[1,0,0]
    v_pk_fma_f32 v[28:29], v[28:29], v[188:189], v[188:189] op_sel_hi:[1,0,0]
    v_pk_fma_f32 v[30:31], v[30:31], v[188:189], v[188:189] op_sel_hi:[1,0,0]
    v_rcp_f32 v24, v24
    v_rcp_f32 v25, v25
    v_rcp_f32 v26, v26
    v_rcp_f32 v27, v27
    v_rcp_f32 v28, v28
    v_rcp_f32 v29, v29
    v_rcp_f32 v30, v30
    v_rcp_f32 v31, v31
    v_pk_mul_f32 v[168:169], v[168:169], v[24:25]
    v_pk_mul_f32 v[170:171], v[170:171], v[26:27]
    v_pk_mul_f32 v[172:173], v[172:173], v[28:29]
    v_pk_mul_f32 v[174:175], v[174:175], v[30:31]
    v_cvt_pk_bf16_f32 v68, v168, v169
    v_cvt_pk_bf16_f32 v69, v170, v171
    v_cvt_pk_bf16_f32 v70, v172, v173
    v_cvt_pk_bf16_f32 v71, v174, v175
    buffer_store_dwordx4 v[68:71], v4, s[24:27], s50 offen
    s_sub_u32 s52, s39, s20
    s_lshl_b32 s23, s20, 11
    s_add_u32 s99, s99, s23
    s_lshl_b32 s23, s20, 13
    s_add_u32 s23, s23, 7340032
    s_xor_b32 s3, s20, 0
    s_add_u32 s3, s3, s52
    s_mul_i32 s56, s3, 57344
    s_add_u32 s56, s56, s23
    s_mul_i32 s61, s3, 20480
    s_add_u32 s61, s61, s99
    s_xor_b32 s3, s20, 1
    s_add_u32 s3, s3, s52
    s_mul_i32 s57, s3, 57344
    s_add_u32 s57, s57, s23
    s_mul_i32 s62, s3, 20480
    s_add_u32 s62, s62, s99
    s_xor_b32 s3, s20, 2
    s_add_u32 s3, s3, s52
    s_mul_i32 s58, s3, 57344
    s_add_u32 s58, s58, s23
    s_mul_i32 s63, s3, 20480
    s_add_u32 s63, s63, s99
    s_xor_b32 s3, s20, 3
    s_add_u32 s3, s3, s52
    s_mul_i32 s59, s3, 57344
    s_add_u32 s59, s59, s23
    s_mul_i32 s96, s3, 20480
    s_add_u32 s96, s96, s99
    s_mov_b32 s12, s16
    s_mov_b32 s13, s17
    s_mov_b32 s14, 2621440
    s_mov_b32 s15, 0x20000
    s_mul_i32 s54, s20, 6144
    s_sub_u32 s54, s54, 49152
    s_lshl_b32 s55, s20, 12
    s_sub_u32 s55, 28672, s55
    s_lshr_b32 s46, s39, 5
    s_lshl_b32 s46, s46, 8
    s_and_b32 s3, s39, 31
    s_add_u32 s46, s46, s3
    s_mul_i32 s36, s46, 1280
    s_and_b32 s3, s22, 7
    s_mul_i32 s3, s3, 160
    s_add_u32 s36, s36, s3
    s_mov_b32 s3, 0xffff0000
    s_mov_b32 s44, 0x01010101
    v_and_b32 v7, 1, v1
    v_lshlrev_b32 v7, 2, v7
    s_waitcnt vmcnt(9)
    s_bitcmp1_b32 s22, 1
    s_cbranch_scc1 P5_d
    v_lshlrev_b32 v152, 16, v192
    v_and_b32 v156, s3, v192
    v_lshlrev_b32 v160, 16, v193
    v_and_b32 v164, s3, v193
    v_lshlrev_b32 v168, 16, v194
    v_and_b32 v157, s3, v194
    v_lshlrev_b32 v161, 16, v195
    v_and_b32 v165, s3, v195
    v_lshlrev_b32 v169, 16, v196
    v_and_b32 v153, s3, v196
    v_lshlrev_b32 v154, 16, v197
    v_and_b32 v158, s3, v197
    v_lshlrev_b32 v162, 16, v198
    v_and_b32 v166, s3, v198
    v_lshlrev_b32 v170, 16, v199
    v_and_b32 v159, s3, v199
    v_lshlrev_b32 v163, 16, v200
    v_and_b32 v167, s3, v200
    v_lshlrev_b32 v171, 16, v201
    v_and_b32 v155, s3, v201
    s_branch P5_j
P5_d:
    v_lshlrev_b32 v155, 16, v192
    v_and_b32 v171, s3, v192
    v_lshlrev_b32 v167, 16, v193
    v_and_b32 v163, s3, v193
    v_lshlrev_b32 v159, 16, v194
    v_and_b32 v170, s3, v194
    v_lshlrev_b32 v166, 16, v195
    v_and_b32 v162, s3, v195
    v_lshlrev_b32 v158, 16, v196
    v_and_b32 v154, s3, v196
    v_lshlrev_b32 v153, 16, v197
    v_and_b32 v169, s3, v197
    v_lshlrev_b32 v165, 16, v198
    v_and_b32 v161, s3, v198
    v_lshlrev_b32 v157, 16, v199
    v_and_b32 v168, s3, v199
    v_lshlrev_b32 v164, 16, v200
    v_and_b32 v160, s3, v200
    v_lshlrev_b32 v156, 16, v201
    v_and_b32_e64 v152, s3, v201
P5_j:
    v_pk_add_f32 v[152:153], v[152:153], v[202:203] op_sel_hi:[1,0] neg_lo:[0,1] neg_hi:[0,1]
    v_pk_add_f32 v[154:155], v[154:155], v[202:203] op_sel_hi:[1,0] neg_lo:[0,1] neg_hi:[0,1]
    v_pk_add_f32 v[156:157], v[156:157], v[202:203] op_sel_hi:[1,0] neg_lo:[0,1] neg_hi:[0,1]
    v_pk_add_f32 v[158:159], v[158:159], v[202:203] op_sel_hi:[1,0] neg_lo:[0,1] neg_hi:[0,1]
    v_pk_add_f32 v[160:161], v[160:161], v[202:203] op_sel_hi:[1,0] neg_lo:[0,1] neg_hi:[0,1]
    v_pk_add_f32 v[162:163], v[162:163], v[202:203] op_sel_hi:[1,0] neg_lo:[0,1] neg_hi:[0,1]
    v_pk_add_f32 v[164:165], v[164:165], v[202:203] op_sel_hi:[1,0] neg_lo:[0,1] neg_hi:[0,1]
    v_pk_add_f32 v[166:167], v[166:167], v[202:203] op_sel_hi:[1,0] neg_lo:[0,1] neg_hi:[0,1]
    v_pk_add_f32 v[168:169], v[168:169], v[202:203] op_sel_hi:[1,0] neg_lo:[0,1] neg_hi:[0,1]
    v_pk_add_f32 v[170:171], v[170:171], v[202:203] op_sel_hi:[1,0] neg_lo:[0,1] neg_hi:[0,1]
    s_waitcnt vmcnt(0)
    v_mov_b32 v5, 1
    v_mov_b32 v6, 0
    s_mov_b64 exec, 1
    s_cmp_lg_u32 s51, 0
    s_cbranch_scc1 P4_ar_f
    buffer_wbl2 sc1
    s_waitcnt vmcnt(0)
    buffer_store_byte v5, v6, s[28:31], s60 offen sc1
    s_branch P4_ar_j
P4_ar_f:
    buffer_store_byte v5, v6, s[28:31], s60 offen
P4_ar_j:
    s_mov_b64 exec, -1
    buffer_load_dword v8, v7, s[28:31], s53 offen sc1
    s_add_u32 s60, s60, 8
    s_xor_b32 s3, s20, 1
    s_mul_i32 s3, s3, 15360
    v_add_u32 v9, s3, v4
    s_xor_b32 s3, s20, 2
    s_mul_i32 s3, s3, 15360
    v_add_u32 v10, s3, v4
    s_xor_b32 s3, s20, 3
    s_mul_i32 s3, s3, 15360
    v_add_u32 v11, s3, v4
    s_and_b32 s3, s20, 1
    s_lshl_b32 s3, s3, 11
    s_sub_u32 s54, 8192, s3
    s_waitcnt vmcnt(0)
    v_cmp_ne_u32 vcc, s44, v8
    s_cbranch_vccz P5_p1_x
    s_mov_b32 s50, 0x20000
P5_p1:
    buffer_load_dword v8, v7, s[28:31], s53 offen offset:0 sc1
    s_sub_u32 s50, s50, 1
    s_waitcnt vmcnt(0)
    s_cbranch_scc1 P5_p1_x
    v_cmp_ne_u32 vcc, s44, v8
    s_cbranch_vccnz P5_p1
P5_p1_x:
    buffer_load_dwordx4 v[24:27], v4, s[24:27], s61 offen offset:0 sc1
    buffer_load_dwordx4 v[28:31], v4, s[24:27], s62 offen offset:0 sc1
    buffer_load_dwordx4 v[32:35], v4, s[24:27], s63 offen offset:0 sc1
    buffer_load_dwordx4 v[36:39], v4, s[24:27], s96 offen offset:0 sc1
    s_waitcnt vmcnt(0)
    v_swap_b32 v24, v30
    v_swap_b32 v25, v31
    v_swap_b32 v32, v38
    v_swap_b32 v33, v39
    v_mfma_f32_16x16x32_bf16 v[152:155], a[240:243], v[24:27], v[152:155]
    buffer_load_dwordx4 v[40:43], v4, s[24:27], s61 offen offset:1024 sc1
    v_mfma_f32_16x16x32_bf16 v[172:175], a[240:243], v[28:31], 0
    v_mfma_f32_16x16x32_bf16 v[192:195], a[240:243], v[32:35], 0
    buffer_load_dwordx4 v[44:47], v4, s[24:27], s62 offen offset:1024 sc1
    v_mfma_f32_16x16x32_bf16 v[212:215], a[240:243], v[36:39], 0
    v_mfma_f32_16x16x32_bf16 v[156:159], a[244:247], v[24:27], v[156:159]
    buffer_load_dwordx4 v[48:51], v4, s[24:27], s63 offen offset:1024 sc1
    v_mfma_f32_16x16x32_bf16 v[176:179], a[244:247], v[28:31], 0
    v_mfma_f32_16x16x32_bf16 v[196:199], a[244:247], v[32:35], 0
    buffer_load_dwordx4 v[52:55], v4, s[24:27], s96 offen offset:1024 sc1
    v_mfma_f32_16x16x32_bf16 v[216:219], a[244:247], v[36:39], 0
    v_mfma_f32_16x16x32_bf16 v[160:163], a[248:251], v[24:27], v[160:163]
    s_add_u32 s62, s62, s54
    buffer_load_dwordx4 v[56:59], v4, s[24:27], s62 offen offset:0 sc1
    v_mfma_f32_16x16x32_bf16 v[180:183], a[248:251], v[28:31], 0
    v_mfma_f32_16x16x32_bf16 v[200:203], a[248:251], v[32:35], 0
    s_add_u32 s96, s96, s54
    buffer_load_dwordx4 v[60:63], v4, s[24:27], s96 offen offset:0 sc1
    v_mfma_f32_16x16x32_bf16 v[220:223], a[248:251], v[36:39], 0
    v_mfma_f32_16x16x32_bf16 v[164:167], a[252:255], v[24:27], v[164:167]
    buffer_load_dwordx4 v[64:67], v4, s[24:27], s62 offen offset:1024 sc1
    v_mfma_f32_16x16x32_bf16 v[184:187], a[252:255], v[28:31], 0
    v_mfma_f32_16x16x32_bf16 v[204:207], a[252:255], v[32:35], 0
    buffer_load_dwordx4 v[68:71], v4, s[24:27], s96 offen offset:1024 sc1
    v_mfma_f32_16x16x32_bf16 v[224:227], a[252:255], v[36:39], 0
    v_mfma_f32_16x16x32_bf16 v[168:171], v[232:235], v[24:27], v[168:171]
    v_mfma_f32_16x16x32_bf16 v[188:191], v[232:235], v[28:31], 0
    v_mfma_f32_16x16x32_bf16 v[208:211], v[232:235], v[32:35], 0
    v_mfma_f32_16x16x32_bf16 v[228:231], v[232:235], v[36:39], 0
    s_waitcnt vmcnt(4)
    v_swap_b32 v40, v46
    v_swap_b32 v41, v47
    v_swap_b32 v48, v54
    v_swap_b32 v49, v55
    v_mfma_f32_16x16x32_bf16 v[152:155], v[236:239], v[40:43], v[152:155]
    buffer_load_dwordx4 v[72:75], v4, s[24:27], s62 offen offset:2048 sc1
    v_mfma_f32_16x16x32_bf16 v[172:175], v[236:239], v[44:47], v[172:175]
    s_xor_b32 s45, s39, 0
    v_mfma_f32_16x16x32_bf16 v[192:195], v[236:239], v[48:51], v[192:195]
    s_and_b32 s37, s45, 15
    buffer_load_dwordx4 v[76:79], v4, s[24:27], s96 offen offset:2048 sc1
    v_mfma_f32_16x16x32_bf16 v[212:215], v[236:239], v[52:55], v[212:215]
    s_lshr_b32 s45, s45, 4
    v_mfma_f32_16x16x32_bf16 v[156:159], v[240:243], v[40:43], v[156:159]
    buffer_load_dwordx4 v[80:83], v4, s[24:27], s62 offen offset:3072 sc1
    s_lshl4_add_u32 s37, s37, s45
    v_mfma_f32_16x16x32_bf16 v[176:179], v[240:243], v[44:47], v[176:179]
    s_add_u32 s37, s37, 8
    v_mfma_f32_16x16x32_bf16 v[196:199], v[240:243], v[48:51], v[196:199]
    s_lshr_b32 s45, s20, 1
    buffer_load_dwordx4 v[84:87], v4, s[24:27], s96 offen offset:3072 sc1
    v_mfma_f32_16x16x32_bf16 v[216:219], v[240:243], v[52:55], v[216:219]
    s_lshl1_add_u32 s37, s37, s45
    v_mfma_f32_16x16x32_bf16 v[160:163], v[244:247], v[40:43], v[160:163]
    s_lshl_b32 s37, s37, 12
    v_mfma_f32_16x16x32_bf16 v[180:183], v[244:247], v[44:47], v[180:183]
    s_xor_b32 s45, s39, 2
    v_mfma_f32_16x16x32_bf16 v[200:203], v[244:247], v[48:51], v[200:203]
    s_and_b32 s38, s45, 15
    v_mfma_f32_16x16x32_bf16 v[220:223], v[244:247], v[52:55], v[220:223]
    s_lshr_b32 s45, s45, 4
    v_mfma_f32_16x16x32_bf16 v[164:167], v[248:251], v[40:43], v[164:167]
    s_lshl4_add_u32 s38, s38, s45
    v_mfma_f32_16x16x32_bf16 v[184:187], v[248:251], v[44:47], v[184:187]
    s_add_u32 s38, s38, 8
    v_mfma_f32_16x16x32_bf16 v[204:207], v[248:251], v[48:51], v[204:207]
    s_lshr_b32 s45, s20, 1
    v_mfma_f32_16x16x32_bf16 v[224:227], v[248:251], v[52:55], v[224:227]
    s_lshl1_add_u32 s38, s38, s45
    v_mfma_f32_16x16x32_bf16 v[168:171], v[252:255], v[40:43], v[168:171]
    s_lshl_b32 s38, s38, 12
    v_mfma_f32_16x16x32_bf16 v[188:191], v[252:255], v[44:47], v[188:191]
    v_mfma_f32_16x16x32_bf16 v[208:211], v[252:255], v[48:51], v[208:211]
    v_mfma_f32_16x16x32_bf16 v[228:231], v[252:255], v[52:55], v[228:231]
    s_waitcnt vmcnt(6)
    v_mfma_f32_16x16x32_bf16 v[172:175], a[160:163], v[56:59], v[172:175]
    buffer_load_dwordx4 v[88:91], v4, s[24:27], s57 offen offset:0 sc1
    v_mfma_f32_16x16x32_bf16 v[212:215], a[160:163], v[60:63], v[212:215]
    v_mfma_f32_16x16x32_bf16 v[176:179], a[164:167], v[56:59], v[176:179]
    buffer_load_dwordx4 v[92:95], v4, s[24:27], s59 offen offset:0 sc1
    v_mfma_f32_16x16x32_bf16 v[216:219], a[164:167], v[60:63], v[216:219]
    v_mfma_f32_16x16x32_bf16 v[180:183], a[168:171], v[56:59], v[180:183]
    buffer_load_dwordx4 v[96:99], v4, s[24:27], s57 offen offset:1024 sc1
    v_mfma_f32_16x16x32_bf16 v[220:223], a[168:171], v[60:63], v[220:223]
    s_mul_i32 s3, s20, 15360
    v_add_u32 v6, s3, v4
    v_mul_u32_u24 v5, 160, v2
    v_mfma_f32_16x16x32_bf16 v[184:187], a[172:175], v[56:59], v[184:187]
    buffer_load_dwordx4 v[100:103], v4, s[24:27], s59 offen offset:1024 sc1
    v_mad_u32_u24 v5, v3, 40, v5
    v_mfma_f32_16x16x32_bf16 v[224:227], a[172:175], v[60:63], v[224:227]
    s_mul_i32 s3, s20, 2560
    s_add_u32 s3, s3, 65536
    v_add_u32 v5, s3, v5
    v_add_u32 v22, s3, v4
    v_mfma_f32_16x16x32_bf16 v[188:191], a[176:179], v[56:59], v[188:191]
    v_add_u32 v12, 0, v1
    v_mul_u32_u24 v13, 6554, v12
    v_mfma_f32_16x16x32_bf16 v[228:231], a[176:179], v[60:63], v[228:231]
    s_waitcnt vmcnt(8)
    v_lshrrev_b32 v13, 16, v13
    v_mul_u32_u24 v14, 10, v13
    v_mfma_f32_16x16x32_bf16 v[172:175], a[180:183], v[64:67], v[172:175]
    buffer_load_dwordx4 v[104:107], v4, s[24:27], s57 offen offset:2048 sc1
    v_sub_u32 v12, v12, v14
    v_mfma_f32_16x16x32_bf16 v[212:215], a[180:183], v[68:71], v[212:215]
    v_and_b32 v14, 7, v13
    v_mul_u32_u24 v14, 40960, v14
    v_mfma_f32_16x16x32_bf16 v[176:179], a[184:187], v[64:67], v[176:179]
    buffer_load_dwordx4 v[108:111], v4, s[24:27], s59 offen offset:2048 sc1
    v_lshl_add_u32 v14, v12, 4, v14
    v_mfma_f32_16x16x32_bf16 v[216:219], a[184:187], v[68:71], v[216:219]
    v_lshrrev_b32 v13, 3, v13
    v_mul_u32_u24 v13, 1310720, v13
    v_mfma_f32_16x16x32_bf16 v[180:183], a[188:191], v[64:67], v[180:183]
    v_add_u32 v7, v13, v14
    v_add_u32 v12, 64, v1
    v_mfma_f32_16x16x32_bf16 v[220:223], a[188:191], v[68:71], v[220:223]
    v_mul_u32_u24 v13, 6554, v12
    v_lshrrev_b32 v13, 16, v13
    v_mfma_f32_16x16x32_bf16 v[184:187], a[192:195], v[64:67], v[184:187]
    v_mul_u32_u24 v14, 10, v13
    v_sub_u32 v12, v12, v14
    v_mfma_f32_16x16x32_bf16 v[224:227], a[192:195], v[68:71], v[224:227]
    v_and_b32 v14, 7, v13
    v_mul_u32_u24 v14, 40960, v14
    v_mfma_f32_16x16x32_bf16 v[188:191], a[196:199], v[64:67], v[188:191]
    v_lshl_add_u32 v14, v12, 4, v14
    v_lshrrev_b32 v13, 3, v13
    v_mfma_f32_16x16x32_bf16 v[228:231], a[196:199], v[68:71], v[228:231]
    s_waitcnt vmcnt(8)
    v_mul_u32_u24 v13, 1310720, v13
    v_add_u32 v8, v13, v14
    v_mfma_f32_16x16x32_bf16 v[172:175], a[200:203], v[72:75], v[172:175]
    buffer_load_dwordx4 v[112:115], v4, s[24:27], s57 offen offset:3072 sc1
    v_add_u32 v12, 128, v1
    v_mfma_f32_16x16x32_bf16 v[212:215], a[200:203], v[76:79], v[212:215]
    v_mul_u32_u24 v13, 6554, v12
    v_lshrrev_b32 v13, 16, v13
    v_mfma_f32_16x16x32_bf16 v[176:179], a[204:207], v[72:75], v[176:179]
    buffer_load_dwordx4 v[116:119], v4, s[24:27], s59 offen offset:3072 sc1
    v_mul_u32_u24 v14, 10, v13
    v_mfma_f32_16x16x32_bf16 v[216:219], a[204:207], v[76:79], v[216:219]
    v_sub_u32 v12, v12, v14
    v_and_b32 v14, 7, v13
    v_mfma_f32_16x16x32_bf16 v[180:183], a[208:211], v[72:75], v[180:183]
    v_mul_u32_u24 v14, 40960, v14
    v_lshl_add_u32 v14, v12, 4, v14
    v_mfma_f32_16x16x32_bf16 v[220:223], a[208:211], v[76:79], v[220:223]
    v_lshrrev_b32 v13, 3, v13
    v_mul_u32_u24 v13, 1310720, v13
    v_mfma_f32_16x16x32_bf16 v[184:187], a[212:215], v[72:75], v[184:187]
    v_add_u32 v23, v13, v14
    v_mfma_f32_16x16x32_bf16 v[224:227], a[212:215], v[76:79], v[224:227]
    v_mfma_f32_16x16x32_bf16 v[188:191], a[216:219], v[72:75], v[188:191]
    v_mfma_f32_16x16x32_bf16 v[228:231], a[216:219], v[76:79], v[228:231]
    s_waitcnt vmcnt(8)
    v_mfma_f32_16x16x32_bf16 v[172:175], a[220:223], v[80:83], v[172:175]
    s_add_u32 s57, s57, 4096
    buffer_load_dwordx4 v[120:123], v4, s[24:27], s57 offen offset:0 sc1
    v_mfma_f32_16x16x32_bf16 v[212:215], a[220:223], v[84:87], v[212:215]
    v_mfma_f32_16x16x32_bf16 v[176:179], a[224:227], v[80:83], v[176:179]
    s_add_u32 s59, s59, 4096
    buffer_load_dwordx4 v[124:127], v4, s[24:27], s59 offen offset:0 sc1
    v_mfma_f32_16x16x32_bf16 v[216:219], a[224:227], v[84:87], v[216:219]
    v_mfma_f32_16x16x32_bf16 v[180:183], a[228:231], v[80:83], v[180:183]
    v_mfma_f32_16x16x32_bf16 v[220:223], a[228:231], v[84:87], v[220:223]
    v_mfma_f32_16x16x32_bf16 v[184:187], a[232:235], v[80:83], v[184:187]
    v_mfma_f32_16x16x32_bf16 v[224:227], a[232:235], v[84:87], v[224:227]
    v_mfma_f32_16x16x32_bf16 v[188:191], a[236:239], v[80:83], v[188:191]
    v_mfma_f32_16x16x32_bf16 v[228:231], a[236:239], v[84:87], v[228:231]
    s_waitcnt vmcnt(8)
    v_mfma_f32_16x16x32_bf16 v[172:175], a[0:3], v[88:91], v[172:175]
    buffer_load_dwordx4 v[24:27], v4, s[24:27], s57 offen offset:1024 sc1
    v_mfma_f32_16x16x32_bf16 v[212:215], a[0:3], v[92:95], v[212:215]
    v_mfma_f32_16x16x32_bf16 v[176:179], a[4:7], v[88:91], v[176:179]
    buffer_load_dwordx4 v[28:31], v4, s[24:27], s59 offen offset:1024 sc1
    v_mfma_f32_16x16x32_bf16 v[216:219], a[4:7], v[92:95], v[216:219]
    v_mfma_f32_16x16x32_bf16 v[180:183], a[8:11], v[88:91], v[180:183]
    v_mfma_f32_16x16x32_bf16 v[220:223], a[8:11], v[92:95], v[220:223]
    v_mfma_f32_16x16x32_bf16 v[184:187], a[12:15], v[88:91], v[184:187]
    v_mfma_f32_16x16x32_bf16 v[224:227], a[12:15], v[92:95], v[224:227]
    v_mfma_f32_16x16x32_bf16 v[188:191], a[16:19], v[88:91], v[188:191]
    v_mfma_f32_16x16x32_bf16 v[228:231], a[16:19], v[92:95], v[228:231]
    s_waitcnt vmcnt(8)
    v_mfma_f32_16x16x32_bf16 v[172:175], a[20:23], v[96:99], v[172:175]
    buffer_load_dwordx4 v[32:35], v4, s[24:27], s57 offen offset:2048 sc1
    v_mfma_f32_16x16x32_bf16 v[212:215], a[20:23], v[100:103], v[212:215]
    v_mfma_f32_16x16x32_bf16 v[176:179], a[24:27], v[96:99], v[176:179]
    buffer_load_dwordx4 v[36:39], v4, s[24:27], s59 offen offset:2048 sc1
    v_mfma_f32_16x16x32_bf16 v[216:219], a[24:27], v[100:103], v[216:219]
    v_mfma_f32_16x16x32_bf16 v[180:183], a[28:31], v[96:99], v[180:183]
    v_mfma_f32_16x16x32_bf16 v[220:223], a[28:31], v[100:103], v[220:223]
    v_mfma_f32_16x16x32_bf16 v[184:187], a[32:35], v[96:99], v[184:187]
    v_mfma_f32_16x16x32_bf16 v[224:227], a[32:35], v[100:103], v[224:227]
    v_mfma_f32_16x16x32_bf16 v[188:191], a[36:39], v[96:99], v[188:191]
    v_mfma_f32_16x16x32_bf16 v[228:231], a[36:39], v[100:103], v[228:231]
    s_waitcnt vmcnt(8)
    v_mfma_f32_16x16x32_bf16 v[172:175], a[40:43], v[104:107], v[172:175]
    buffer_load_dwordx4 v[40:43], v4, s[24:27], s57 offen offset:3072 sc1
    v_mfma_f32_16x16x32_bf16 v[212:215], a[40:43], v[108:111], v[212:215]
    v_mfma_f32_16x16x32_bf16 v[176:179], a[44:47], v[104:107], v[176:179]
    buffer_load_dwordx4 v[44:47], v4, s[24:27], s59 offen offset:3072 sc1
    v_mfma_f32_16x16x32_bf16 v[216:219], a[44:47], v[108:111], v[216:219]
    v_mfma_f32_16x16x32_bf16 v[180:183], a[48:51], v[104:107], v[180:183]
    v_mfma_f32_16x16x32_bf16 v[220:223], a[48:51], v[108:111], v[220:223]
    v_mfma_f32_16x16x32_bf16 v[184:187], a[52:55], v[104:107], v[184:187]
    v_mfma_f32_16x16x32_bf16 v[224:227], a[52:55], v[108:111], v[224:227]
    v_mfma_f32_16x16x32_bf16 v[188:191], a[56:59], v[104:107], v[188:191]
    v_mfma_f32_16x16x32_bf16 v[228:231], a[56:59], v[108:111], v[228:231]
    s_waitcnt vmcnt(8)
    v_mfma_f32_16x16x32_bf16 v[172:175], a[60:63], v[112:115], v[172:175]
    buffer_load_dwordx4 v[48:51], v4, s[24:27], s58 offen offset:0 sc1
    v_mfma_f32_16x16x32_bf16 v[212:215], a[60:63], v[116:119], v[212:215]
    v_mfma_f32_16x16x32_bf16 v[176:179], a[64:67], v[112:115], v[176:179]
    buffer_load_dwordx4 v[52:55], v4, s[24:27], s58 offen offset:1024 sc1
    v_mfma_f32_16x16x32_bf16 v[216:219], a[64:67], v[116:119], v[216:219]
    v_mfma_f32_16x16x32_bf16 v[180:183], a[68:71], v[112:115], v[180:183]
    buffer_load_dwordx4 v[56:59], v4, s[24:27], s58 offen offset:2048 sc1
    v_mfma_f32_16x16x32_bf16 v[220:223], a[68:71], v[116:119], v[220:223]
    v_mfma_f32_16x16x32_bf16 v[184:187], a[72:75], v[112:115], v[184:187]
    v_mfma_f32_16x16x32_bf16 v[224:227], a[72:75], v[116:119], v[224:227]
    v_mfma_f32_16x16x32_bf16 v[188:191], a[76:79], v[112:115], v[188:191]
    v_mfma_f32_16x16x32_bf16 v[228:231], a[76:79], v[116:119], v[228:231]
    s_waitcnt vmcnt(9)
    v_mfma_f32_16x16x32_bf16 v[172:175], a[80:83], v[120:123], v[172:175]
    buffer_load_dwordx4 v[60:63], v4, s[24:27], s58 offen offset:3072 sc1
    v_mfma_f32_16x16x32_bf16 v[212:215], a[80:83], v[124:127], v[212:215]
    v_mfma_f32_16x16x32_bf16 v[176:179], a[84:87], v[120:123], v[176:179]
    s_add_u32 s58, s58, 4096
    buffer_load_dwordx4 v[64:67], v4, s[24:27], s58 offen offset:0 sc1
    v_mfma_f32_16x16x32_bf16 v[216:219], a[84:87], v[124:127], v[216:219]
    v_mfma_f32_16x16x32_bf16 v[180:183], a[88:91], v[120:123], v[180:183]
    buffer_load_dwordx4 v[68:71], v4, s[24:27], s58 offen offset:1024 sc1
    v_mfma_f32_16x16x32_bf16 v[220:223], a[88:91], v[124:127], v[220:223]
    v_mfma_f32_16x16x32_bf16 v[184:187], a[92:95], v[120:123], v[184:187]
    v_mfma_f32_16x16x32_bf16 v[224:227], a[92:95], v[124:127], v[224:227]
    v_mfma_f32_16x16x32_bf16 v[188:191], a[96:99], v[120:123], v[188:191]
    v_mfma_f32_16x16x32_bf16 v[228:231], a[96:99], v[124:127], v[228:231]
    s_waitcnt vmcnt(10)
    v_mfma_f32_16x16x32_bf16 v[172:175], a[100:103], v[24:27], v[172:175]
    buffer_load_dwordx4 v[72:75], v4, s[24:27], s58 offen offset:2048 sc1
    v_mfma_f32_16x16x32_bf16 v[212:215], a[100:103], v[28:31], v[212:215]
    v_mfma_f32_16x16x32_bf16 v[176:179], a[104:107], v[24:27], v[176:179]
    buffer_load_dwordx4 v[76:79], v4, s[24:27], s58 offen offset:3072 sc1
    v_mfma_f32_16x16x32_bf16 v[216:219], a[104:107], v[28:31], v[216:219]
    v_mfma_f32_16x16x32_bf16 v[180:183], a[108:111], v[24:27], v[180:183]
    buffer_load_dwordx4 v[80:83], v4, s[8:11], s38 offen offset:0 sc1
    v_mfma_f32_16x16x32_bf16 v[220:223], a[108:111], v[28:31], v[220:223]
    v_mfma_f32_16x16x32_bf16 v[184:187], a[112:115], v[24:27], v[184:187]
    v_mfma_f32_16x16x32_bf16 v[224:227], a[112:115], v[28:31], v[224:227]
    v_mfma_f32_16x16x32_bf16 v[188:191], a[116:119], v[24:27], v[188:191]
    v_mfma_f32_16x16x32_bf16 v[228:231], a[116:119], v[28:31], v[228:231]
    s_waitcnt vmcnt(11)
    v_mfma_f32_16x16x32_bf16 v[172:175], a[120:123], v[32:35], v[172:175]
    buffer_load_dwordx4 v[84:87], v4, s[8:11], s38 offen offset:1024 sc1
    v_mfma_f32_16x16x32_bf16 v[212:215], a[120:123], v[36:39], v[212:215]
    v_mfma_f32_16x16x32_bf16 v[176:179], a[124:127], v[32:35], v[176:179]
    buffer_load_dwordx4 v[88:91], v4, s[8:11], s38 offen offset:2048 sc1
    v_mfma_f32_16x16x32_bf16 v[216:219], a[124:127], v[36:39], v[216:219]
    v_mfma_f32_16x16x32_bf16 v[180:183], a[128:131], v[32:35], v[180:183]
    buffer_load_dwordx4 v[92:95], v4, s[8:11], s38 offen offset:3072 sc1
    v_mfma_f32_16x16x32_bf16 v[220:223], a[128:131], v[36:39], v[220:223]
    v_mfma_f32_16x16x32_bf16 v[184:187], a[132:135], v[32:35], v[184:187]
    v_mfma_f32_16x16x32_bf16 v[224:227], a[132:135], v[36:39], v[224:227]
    v_mfma_f32_16x16x32_bf16 v[188:191], a[136:139], v[32:35], v[188:191]
    v_mfma_f32_16x16x32_bf16 v[228:231], a[136:139], v[36:39], v[228:231]
    s_waitcnt vmcnt(12)
    v_mfma_f32_16x16x32_bf16 v[172:175], a[140:143], v[40:43], v[172:175]
    buffer_load_dwordx4 v[96:99], v4, s[24:27], s56 offen offset:0 sc1
    v_mfma_f32_16x16x32_bf16 v[212:215], a[140:143], v[44:47], v[212:215]
    v_mfma_f32_16x16x32_bf16 v[176:179], a[144:147], v[40:43], v[176:179]
    buffer_load_dwordx4 v[100:103], v4, s[24:27], s56 offen offset:1024 sc1
    v_mfma_f32_16x16x32_bf16 v[216:219], a[144:147], v[44:47], v[216:219]
    v_mfma_f32_16x16x32_bf16 v[180:183], a[148:151], v[40:43], v[180:183]
    buffer_load_dwordx4 v[104:107], v4, s[24:27], s56 offen offset:2048 sc1
    v_mfma_f32_16x16x32_bf16 v[220:223], a[148:151], v[44:47], v[220:223]
    v_mfma_f32_16x16x32_bf16 v[184:187], a[152:155], v[40:43], v[184:187]
    v_mfma_f32_16x16x32_bf16 v[224:227], a[152:155], v[44:47], v[224:227]
    v_mfma_f32_16x16x32_bf16 v[188:191], a[156:159], v[40:43], v[188:191]
    v_mfma_f32_16x16x32_bf16 v[228:231], a[156:159], v[44:47], v[228:231]
    s_waitcnt vmcnt(14)
    v_mfma_f32_16x16x32_bf16 v[192:195], a[0:3], v[48:51], v[192:195]
    buffer_load_dwordx4 v[108:111], v4, s[24:27], s56 offen offset:3072 sc1
    v_mfma_f32_16x16x32_bf16 v[196:199], a[4:7], v[48:51], v[196:199]
    v_mfma_f32_16x16x32_bf16 v[200:203], a[8:11], v[48:51], v[200:203]
    s_add_u32 s56, s56, 4096
    buffer_load_dwordx4 v[112:115], v4, s[24:27], s56 offen offset:0 sc1
    ds_write_b128 v9, v[172:175] offset:0
    v_mfma_f32_16x16x32_bf16 v[204:207], a[12:15], v[48:51], v[204:207]
    v_mfma_f32_16x16x32_bf16 v[208:211], a[16:19], v[48:51], v[208:211]
    s_waitcnt vmcnt(15)
    buffer_load_dwordx4 v[116:119], v4, s[24:27], s56 offen offset:1024 sc1
    v_mfma_f32_16x16x32_bf16 v[192:195], a[20:23], v[52:55], v[192:195]
    ds_write_b128 v9, v[176:179] offset:1024
    v_mfma_f32_16x16x32_bf16 v[196:199], a[24:27], v[52:55], v[196:199]
    buffer_load_dwordx4 v[120:123], v4, s[24:27], s56 offen offset:2048 sc1
    v_mfma_f32_16x16x32_bf16 v[200:203], a[28:31], v[52:55], v[200:203]
    v_mfma_f32_16x16x32_bf16 v[204:207], a[32:35], v[52:55], v[204:207]
    ds_write_b128 v9, v[180:183] offset:2048
    v_mfma_f32_16x16x32_bf16 v[208:211], a[36:39], v[52:55], v[208:211]
    s_waitcnt vmcnt(16)
    v_mfma_f32_16x16x32_bf16 v[192:195], a[40:43], v[56:59], v[192:195]
    buffer_load_dwordx4 v[124:127], v4, s[24:27], s56 offen offset:3072 sc1
    v_mfma_f32_16x16x32_bf16 v[196:199], a[44:47], v[56:59], v[196:199]
    ds_write_b128 v9, v[184:187] offset:3072
    v_mfma_f32_16x16x32_bf16 v[200:203], a[48:51], v[56:59], v[200:203]
    v_mfma_f32_16x16x32_bf16 v[204:207], a[52:55], v[56:59], v[204:207]
    v_mfma_f32_16x16x32_bf16 v[208:211], a[56:59], v[56:59], v[208:211]
    s_waitcnt vmcnt(16)
    ds_write_b128 v9, v[188:191] offset:4096
    v_mfma_f32_16x16x32_bf16 v[192:195], a[60:63], v[60:63], v[192:195]
    buffer_load_dwordx4 v[24:27], v4, s[8:11], s37 offen offset:0 sc1
    v_mfma_f32_16x16x32_bf16 v[196:199], a[64:67], v[60:63], v[196:199]
    v_mfma_f32_16x16x32_bf16 v[200:203], a[68:71], v[60:63], v[200:203]
    ds_write_b128 v11, v[212:215] offset:10240
    v_mfma_f32_16x16x32_bf16 v[204:207], a[72:75], v[60:63], v[204:207]
    v_mfma_f32_16x16x32_bf16 v[208:211], a[76:79], v[60:63], v[208:211]
    s_waitcnt vmcnt(16)
    v_mfma_f32_16x16x32_bf16 v[192:195], a[80:83], v[64:67], v[192:195]
    buffer_load_dwordx4 v[28:31], v4, s[8:11], s37 offen offset:1024 sc1
    ds_write_b128 v11, v[216:219] offset:11264
    v_mfma_f32_16x16x32_bf16 v[196:199], a[84:87], v[64:67], v[196:199]
    v_mfma_f32_16x16x32_bf16 v[200:203], a[88:91], v[64:67], v[200:203]
    v_mfma_f32_16x16x32_bf16 v[204:207], a[92:95], v[64:67], v[204:207]
    ds_write_b128 v11, v[220:223] offset:12288
    v_mfma_f32_16x16x32_bf16 v[208:211], a[96:99], v[64:67], v[208:211]
    s_waitcnt vmcnt(16)
    v_mfma_f32_16x16x32_bf16 v[192:195], a[100:103], v[68:71], v[192:195]
    buffer_load_dwordx4 v[32:35], v4, s[8:11], s37 offen offset:2048 sc1
    v_mfma_f32_16x16x32_bf16 v[196:199], a[104:107], v[68:71], v[196:199]
    ds_write_b128 v11, v[224:227] offset:13312
    v_mfma_f32_16x16x32_bf16 v[200:203], a[108:111], v[68:71], v[200:203]
    v_mfma_f32_16x16x32_bf16 v[204:207], a[112:115], v[68:71], v[204:207]
    v_mfma_f32_16x16x32_bf16 v[208:211], a[116:119], v[68:71], v[208:211]
    s_waitcnt vmcnt(16)
    ds_write_b128 v11, v[228:231] offset:14336
    v_mfma_f32_16x16x32_bf16 v[192:195], a[120:123], v[72:75], v[192:195]
    buffer_load_dwordx4 v[36:39], v4, s[8:11], s37 offen offset:3072 sc1
    v_mfma_f32_16x16x32_bf16 v[196:199], a[124:127], v[72:75], v[196:199]
    v_mfma_f32_16x16x32_bf16 v[200:203], a[128:131], v[72:75], v[200:203]
    v_mfma_f32_16x16x32_bf16 v[204:207], a[132:135], v[72:75], v[204:207]
    v_mfma_f32_16x16x32_bf16 v[208:211], a[136:139], v[72:75], v[208:211]
    s_waitcnt vmcnt(16)
    v_mfma_f32_16x16x32_bf16 v[192:195], a[140:143], v[76:79], v[192:195]
    v_mfma_f32_16x16x32_bf16 v[196:199], a[144:147], v[76:79], v[196:199]
    s_waitcnt lgkmcnt(0)
    s_barrier
    v_mfma_f32_16x16x32_bf16 v[200:203], a[148:151], v[76:79], v[200:203]
    ds_read_b128 v[128:131], v6 offset:0
    ds_read_b128 v[132:135], v6 offset:1024
    v_mfma_f32_16x16x32_bf16 v[204:207], a[152:155], v[76:79], v[204:207]
    ds_read_b128 v[136:139], v6 offset:2048
    ds_read_b128 v[140:143], v6 offset:3072
    v_mfma_f32_16x16x32_bf16 v[208:211], a[156:159], v[76:79], v[208:211]
    s_waitcnt vmcnt(15)
    ds_read_b128 v[144:147], v6 offset:4096
    v_mfma_f32_16x16x32_bf16 v[192:195], a[160:163], v[80:83], v[192:195]
    v_mfma_f32_16x16x32_bf16 v[196:199], a[164:167], v[80:83], v[196:199]
    v_mfma_f32_16x16x32_bf16 v[200:203], a[168:171], v[80:83], v[200:203]
    v_mfma_f32_16x16x32_bf16 v[204:207], a[172:175], v[80:83], v[204:207]
    v_mfma_f32_16x16x32_bf16 v[208:211], a[176:179], v[80:83], v[208:211]
    s_waitcnt lgkmcnt(0)
    v_add_f32 v152, v152, v128
    v_add_f32 v153, v153, v129
    s_waitcnt vmcnt(14)
    v_mfma_f32_16x16x32_bf16 v[192:195], a[180:183], v[84:87], v[192:195]
    v_add_f32 v154, v154, v130
    v_add_f32 v155, v155, v131
    v_mfma_f32_16x16x32_bf16 v[196:199], a[184:187], v[84:87], v[196:199]
    v_add_f32 v156, v156, v132
    v_add_f32 v157, v157, v133
    v_mfma_f32_16x16x32_bf16 v[200:203], a[188:191], v[84:87], v[200:203]
    v_add_f32 v158, v158, v134
    v_add_f32 v159, v159, v135
    v_mfma_f32_16x16x32_bf16 v[204:207], a[192:195], v[84:87], v[204:207]
    v_add_f32 v160, v160, v136
    v_add_f32 v161, v161, v137
    v_mfma_f32_16x16x32_bf16 v[208:211], a[196:199], v[84:87], v[208:211]
    s_waitcnt vmcnt(13)
    v_add_f32 v162, v162, v138
    v_add_f32 v163, v163, v139
    v_mfma_f32_16x16x32_bf16 v[192:195], a[200:203], v[88:91], v[192:195]
    v_add_f32 v164, v164, v140
    v_add_f32 v165, v165, v141
    v_mfma_f32_16x16x32_bf16 v[196:199], a[204:207], v[88:91], v[196:199]
    v_add_f32 v166, v166, v142
    v_add_f32 v167, v167, v143
    v_mfma_f32_16x16x32_bf16 v[200:203], a[208:211], v[88:91], v[200:203]
    v_add_f32 v168, v168, v144
    v_add_f32 v169, v169, v145
    v_mfma_f32_16x16x32_bf16 v[204:207], a[212:215], v[88:91], v[204:207]
    v_add_f32 v170, v170, v146
    v_add_f32 v171, v171, v147
    v_mfma_f32_16x16x32_bf16 v[208:211], a[216:219], v[88:91], v[208:211]
    s_waitcnt vmcnt(12)
    v_mfma_f32_16x16x32_bf16 v[192:195], a[220:223], v[92:95], v[192:195]
    v_mfma_f32_16x16x32_bf16 v[196:199], a[224:227], v[92:95], v[196:199]
    v_mfma_f32_16x16x32_bf16 v[200:203], a[228:231], v[92:95], v[200:203]
    v_mfma_f32_16x16x32_bf16 v[204:207], a[232:235], v[92:95], v[204:207]
    v_mfma_f32_16x16x32_bf16 v[208:211], a[236:239], v[92:95], v[208:211]
    s_waitcnt vmcnt(11)
    v_mfma_f32_16x16x32_bf16 v[152:155], a[0:3], v[96:99], v[152:155]
    ds_read_b128 v[128:131], v6 offset:10240
    ds_read_b128 v[132:135], v6 offset:11264
    v_mfma_f32_16x16x32_bf16 v[156:159], a[4:7], v[96:99], v[156:159]
    ds_read_b128 v[136:139], v6 offset:12288
    ds_read_b128 v[140:143], v6 offset:13312
    v_mfma_f32_16x16x32_bf16 v[160:163], a[8:11], v[96:99], v[160:163]
    s_lshr_b32 s3, s2, 3
    s_or_b32 s3, s3, s20
    s_cbranch_scc1 WB_d
    buffer_wbl2 sc1
    s_branch WB_x
WB_d:
    buffer_load_dword v9, v2, s[28:31], 0 offen
WB_x:
    v_mfma_f32_16x16x32_bf16 v[164:167], a[12:15], v[96:99], v[164:167]
    ds_read_b128 v[144:147], v6 offset:14336
    ds_write_b128 v10, v[192:195] offset:5120
    v_mfma_f32_16x16x32_bf16 v[168:171], a[16:19], v[96:99], v[168:171]
    s_waitcnt vmcnt(11)
    v_mfma_f32_16x16x32_bf16 v[152:155], a[20:23], v[100:103], v[152:155]
    ds_write_b128 v10, v[196:199] offset:6144
    v_mfma_f32_16x16x32_bf16 v[156:159], a[24:27], v[100:103], v[156:159]
    v_mfma_f32_16x16x32_bf16 v[160:163], a[28:31], v[100:103], v[160:163]
    v_mfma_f32_16x16x32_bf16 v[164:167], a[32:35], v[100:103], v[164:167]
    ds_write_b128 v10, v[200:203] offset:7168
    v_mfma_f32_16x16x32_bf16 v[168:171], a[36:39], v[100:103], v[168:171]
    s_waitcnt vmcnt(10)
    v_mfma_f32_16x16x32_bf16 v[152:155], a[40:43], v[104:107], v[152:155]
    v_mfma_f32_16x16x32_bf16 v[156:159], a[44:47], v[104:107], v[156:159]
    ds_write_b128 v10, v[204:207] offset:8192
    v_mfma_f32_16x16x32_bf16 v[160:163], a[48:51], v[104:107], v[160:163]
    v_mfma_f32_16x16x32_bf16 v[164:167], a[52:55], v[104:107], v[164:167]
    v_mfma_f32_16x16x32_bf16 v[168:171], a[56:59], v[104:107], v[168:171]
    s_waitcnt vmcnt(9)
    ds_write_b128 v10, v[208:211] offset:9216
    v_mfma_f32_16x16x32_bf16 v[152:155], a[60:63], v[108:111], v[152:155]
    v_mfma_f32_16x16x32_bf16 v[156:159], a[64:67], v[108:111], v[156:159]
    v_mfma_f32_16x16x32_bf16 v[160:163], a[68:71], v[108:111], v[160:163]
    v_mfma_f32_16x16x32_bf16 v[164:167], a[72:75], v[108:111], v[164:167]
    v_mfma_f32_16x16x32_bf16 v[168:171], a[76:79], v[108:111], v[168:171]
    s_waitcnt vmcnt(8)
    v_mfma_f32_16x16x32_bf16 v[152:155], a[80:83], v[112:115], v[152:155]
    v_mfma_f32_16x16x32_bf16 v[156:159], a[84:87], v[112:115], v[156:159]
    v_mfma_f32_16x16x32_bf16 v[160:163], a[88:91], v[112:115], v[160:163]
    v_mfma_f32_16x16x32_bf16 v[164:167], a[92:95], v[112:115], v[164:167]
    v_mfma_f32_16x16x32_bf16 v[168:171], a[96:99], v[112:115], v[168:171]
    s_waitcnt lgkmcnt(0)
    s_barrier
    s_waitcnt vmcnt(7)
    v_mfma_f32_16x16x32_bf16 v[152:155], a[100:103], v[116:119], v[152:155]
    ds_read_b128 v[172:175], v6 offset:5120
    ds_read_b128 v[176:179], v6 offset:6144
    v_mfma_f32_16x16x32_bf16 v[156:159], a[104:107], v[116:119], v[156:159]
    ds_read_b128 v[180:183], v6 offset:7168
    ds_read_b128 v[184:187], v6 offset:8192
    v_mfma_f32_16x16x32_bf16 v[160:163], a[108:111], v[116:119], v[160:163]
    ds_read_b128 v[188:191], v6 offset:9216
    v_mfma_f32_16x16x32_bf16 v[164:167], a[112:115], v[116:119], v[164:167]
    v_mfma_f32_16x16x32_bf16 v[168:171], a[116:119], v[116:119], v[168:171]
    s_waitcnt vmcnt(6)
    v_mfma_f32_16x16x32_bf16 v[152:155], a[120:123], v[120:123], v[152:155]
    v_mfma_f32_16x16x32_bf16 v[156:159], a[124:127], v[120:123], v[156:159]
    v_mfma_f32_16x16x32_bf16 v[160:163], a[128:131], v[120:123], v[160:163]
    s_waitcnt lgkmcnt(0)
    v_add_f32 v128, v128, v172
    v_add_f32 v129, v129, v173
    v_mfma_f32_16x16x32_bf16 v[164:167], a[132:135], v[120:123], v[164:167]
    v_add_f32 v130, v130, v174
    v_add_f32 v131, v131, v175
    v_mfma_f32_16x16x32_bf16 v[168:171], a[136:139], v[120:123], v[168:171]
    s_waitcnt vmcnt(5)
    v_add_f32 v132, v132, v176
    v_add_f32 v133, v133, v177
    v_mfma_f32_16x16x32_bf16 v[152:155], a[140:143], v[124:127], v[152:155]
    v_add_f32 v134, v134, v178
    v_add_f32 v135, v135, v179
    v_mfma_f32_16x16x32_bf16 v[156:159], a[144:147], v[124:127], v[156:159]
    v_add_f32 v136, v136, v180
    v_add_f32 v137, v137, v181
    v_mfma_f32_16x16x32_bf16 v[160:163], a[148:151], v[124:127], v[160:163]
    v_add_f32 v138, v138, v182
    v_add_f32 v139, v139, v183
    v_mfma_f32_16x16x32_bf16 v[164:167], a[152:155], v[124:127], v[164:167]
    v_add_f32 v140, v140, v184
    v_add_f32 v141, v141, v185
    v_mfma_f32_16x16x32_bf16 v[168:171], a[156:159], v[124:127], v[168:171]
    s_waitcnt vmcnt(4)
    v_add_f32 v142, v142, v186
    v_add_f32 v143, v143, v187
    v_mfma_f32_16x16x32_bf16 v[152:155], a[160:163], v[24:27], v[152:155]
    v_add_f32 v144, v144, v188
    v_add_f32 v145, v145, v189
    v_mfma_f32_16x16x32_bf16 v[156:159], a[164:167], v[24:27], v[156:159]
    v_add_f32 v146, v146, v190
    v_add_f32 v147, v147, v191
    v_mfma_f32_16x16x32_bf16 v[160:163], a[168:171], v[24:27], v[160:163]
    v_mfma_f32_16x16x32_bf16 v[164:167], a[172:175], v[24:27], v[164:167]
    v_mfma_f32_16x16x32_bf16 v[168:171], a[176:179], v[24:27], v[168:171]
    s_waitcnt vmcnt(3)
    v_mfma_f32_16x16x32_bf16 v[152:155], a[180:183], v[28:31], v[152:155]
    v_mfma_f32_16x16x32_bf16 v[156:159], a[184:187], v[28:31], v[156:159]
    v_mfma_f32_16x16x32_bf16 v[160:163], a[188:191], v[28:31], v[160:163]
    v_mfma_f32_16x16x32_bf16 v[164:167], a[192:195], v[28:31], v[164:167]
    v_mfma_f32_16x16x32_bf16 v[168:171], a[196:199], v[28:31], v[168:171]
    s_waitcnt vmcnt(2)
    v_mfma_f32_16x16x32_bf16 v[152:155], a[200:203], v[32:35], v[152:155]
    v_mfma_f32_16x16x32_bf16 v[156:159], a[204:207], v[32:35], v[156:159]
    v_mfma_f32_16x16x32_bf16 v[160:163], a[208:211], v[32:35], v[160:163]
    v_mfma_f32_16x16x32_bf16 v[164:167], a[212:215], v[32:35], v[164:167]
    v_mfma_f32_16x16x32_bf16 v[168:171], a[216:219], v[32:35], v[168:171]
    s_waitcnt vmcnt(1)
    v_mfma_f32_16x16x32_bf16 v[152:155], a[220:223], v[36:39], v[152:155]
    v_mfma_f32_16x16x32_bf16 v[156:159], a[224:227], v[36:39], v[156:159]
    v_mfma_f32_16x16x32_bf16 v[160:163], a[228:231], v[36:39], v[160:163]
    v_mfma_f32_16x16x32_bf16 v[164:167], a[232:235], v[36:39], v[164:167]
    v_mfma_f32_16x16x32_bf16 v[168:171], a[236:239], v[36:39], v[168:171]
    s_nop 3
    v_pk_add_f32 v[152:153], v[152:153], v[128:129]
    v_pk_add_f32 v[154:155], v[154:155], v[130:131]
    v_pk_add_f32 v[156:157], v[156:157], v[132:133]
    v_pk_add_f32 v[158:159], v[158:159], v[134:135]
    v_pk_add_f32 v[160:161], v[160:161], v[136:137]
    v_pk_add_f32 v[162:163], v[162:163], v[138:139]
    v_pk_add_f32 v[164:165], v[164:165], v[140:141]
    v_pk_add_f32 v[166:167], v[166:167], v[142:143]
    v_pk_add_f32 v[168:169], v[168:169], v[144:145]
    v_pk_add_f32 v[170:171], v[170:171], v[146:147]
    v_cvt_pk_bf16_f32 v12, v152, v156
    v_cvt_pk_bf16_f32 v13, v160, v164
    ds_write_b64 v5, v[12:13] offset:0
    v_cvt_pk_bf16_f32 v14, v168, v157
    v_cvt_pk_bf16_f32 v15, v161, v165
    ds_write_b64 v5, v[14:15] offset:8
    v_cvt_pk_bf16_f32 v16, v169, v153
    v_cvt_pk_bf16_f32 v17, v154, v158
    ds_write_b64 v5, v[16:17] offset:16
    v_cvt_pk_bf16_f32 v18, v162, v166
    v_cvt_pk_bf16_f32 v19, v170, v159
    ds_write_b64 v5, v[18:19] offset:24
    v_cvt_pk_bf16_f32 v20, v163, v167
    v_cvt_pk_bf16_f32 v21, v171, v155
    ds_write_b64 v5, v[20:21] offset:32
    s_waitcnt lgkmcnt(0)
    ds_read_b128 v[24:27], v22 offset:0
    ds_read_b128 v[28:31], v22 offset:1024
    ds_read_b128 v[32:35], v22 offset:2048
    s_waitcnt lgkmcnt(2)
    buffer_store_dwordx4 v[24:27], v7, s[12:15], s36 offen
    s_waitcnt lgkmcnt(1)
    buffer_store_dwordx4 v[28:31], v8, s[12:15], s36 offen
    s_waitcnt lgkmcnt(0)
    s_mov_b32 exec_hi, 0
    buffer_store_dwordx4 v[32:35], v23, s[12:15], s36 offen
    s_mov_b64 exec, -1
K_end:
    s_endpgm
CODE_END:
.p2align 6
JTAB:
.long 2,0,41088,41088,3145728,1284,16777216,327680,3,0,16,0,16,8192,1314816,16777216
.long 0,0,0,0,0,0,0,0,4,0,0,0,0,0,0,0
.long 0,0,0,0,0,0,0,0,4,0,0,0,0,0,0,0
.long 31074,0,41088,41088,3277184,1284,16777216,327680,3,0,16,0,16,8192,1314816,16777216
.long 164354,0,41088,41088,3146240,1284,16777216,327680,3,0,16,0,16,8192,1314816,16777216
.long 0,0,0,0,0,0,0,0,4,0,0,0,0,0,0,0
.long 0,0,0,0,0,0,0,0,4,0,0,0,0,0,0,0
.long 195426,0,41088,41088,3277696,1284,16777216,327680,3,0,16,0,16,8192,1314816,16777216
.long 328706,0,41088,41088,3146752,1284,16777216,327680,3,0,16,0,16,8192,1314816,16777216
.long 0,0,0,0,0,0,0,0,4,0,0,0,0,0,0,0
.long 0,0,0,0,0,0,0,0,4,0,0,0,0,0,0,0
.long 359778,0,41088,41088,3278208,1284,16777216,327680,3,0,16,0,16,8192,1314816,16777216
.long 493058,0,41088,41088,3147264,1284,16777216,327680,3,0,16,0,16,8192,1314816,16777216
.long 0,0,0,0,0,0,0,0,4,0,0,0,0,0,0,0
.long 0,0,0,0,0,0,0,0,4,0,0,0,0,0,0,0
.long 524130,0,41088,41088,3278720,1284,16777216,327680,3,0,16,0,16,8192,1314816,16777216
.long 657410,0,41088,41088,3147776,1284,16777216,327680,3,0,16,0,16,8192,1314816,16777216
.long 0,0,0,0,0,0,0,0,4,0,0,0,0,0,0,0
.long 0,0,0,0,0,0,0,0,4,0,0,0,0,0,0,0
.long 688482,0,41088,41088,3279232,1284,16777216,327680,3,0,16,0,16,8192,1314816,16777216
.long 821762,0,41088,41088,3148288,1284,16777216,327680,3,0,16,0,16,8192,1314816,16777216
.long 0,0,0,0,0,0,0,0,4,0,0,0,0,0,0,0
.long 0,0,0,0,0,0,0,0,4,0,0,0,0,0,0,0
.long 852834,0,41088,41088,3279744,1284,16777216,327680,3,0,16,0,16,8192,1314816,16777216
.long 986114,0,41088,41088,3148800,1284,16777216,327680,3,0,16,0,16,8192,1314816,16777216
.long 0,0,0,0,0,0,0,0,4,0,0,0,0,0,0,0
.long 0,0,0,0,0,0,0,0,4,0,0,0,0,0,0,0
.long 1017186,0,41088,41088,3280256,1284,16777216,327680,3,0,16,0,16,8192,1314816,16777216
.long 1150466,0,41088,41088,3149312,1284,16777216,327680,3,0,16,0,16,8192,1314816,16777216
.long 0,0,0,0,0,0,0,0,4,0,0,0,0,0,0,0
.long 0,0,0,0,0,0,0,0,4,0,0,0,0,0,0,0
.long 1181538,0,41088,41088,3280768,1284,16777216,327680,3,0,16,0,16,8192,1314816,16777216
.long 130,0,41088,41088,3211264,1284,16777216,327680,3,0,16,0,16,8192,1314816,16777216
.long 0,0,0,0,0,0,0,0,4,0,0,0,0,0,0,0
.long 0,0,0,0,0,0,0,0,4,0,0,0,0,0,0,0
.long 31202,0,41088,41088,3342720,1284,16777216,327680,3,0,16,0,16,8192,1314816,16777216
.long 164482,0,41088,41088,3211776,1284,16777216,327680,3,0,16,0,16,8192,1314816,16777216
.long 0,0,0,0,0,0,0,0,4,0,0,0,0,0,0,0
.long 0,0,0,0,0,0,0,0,4,0,0,0,0,0,0,0
.long 195554,0,41088,41088,3343232,1284,16777216,327680,3,0,16,0,16,8192,1314816,16777216
.long 328834,0,41088,41088,3212288,1284,16777216,327680,3,0,16,0,16,8192,1314816,16777216
.long 0,0,0,0,0,0,0,0,4,0,0,0,0,0,0,0
.long 0,0,0,0,0,0,0,0,4,0,0,0,0,0,0,0
.long 359906,0,41088,41088,3343744,1284,16777216,327680,3,0,16,0,16,8192,1314816,16777216
.long 493186,0,41088,41088,3212800,1284,16777216,327680,3,0,16,0,16,8192,1314816,16777216
.long 0,0,0,0,0,0,0,0,4,0,0,0,0,0,0,0
.long 0,0,0,0,0,0,0,0,4,0,0,0,0,0,0,0
.long 524258,0,41088,41088,3344256,1284,16777216,327680,3,0,16,0,16,8192,1314816,16777216
.long 657538,0,41088,41088,3213312,1284,16777216,327680,3,0,16,0,16,8192,1314816,16777216
.long 0,0,0,0,0,0,0,0,4,0,0,0,0,0,0,0
.long 0,0,0,0,0,0,0,0,4,0,0,0,0,0,0,0
.long 688610,0,41088,41088,3344768,1284,16777216,327680,3,0,16,0,16,8192,1314816,16777216
.long 821890,0,41088,41088,3213824,1284,16777216,327680,3,0,16,0,16,8192,1314816,16777216
.long 0,0,0,0,0,0,0,0,4,0,0,0,0,0,0,0
.long 0,0,0,0,0,0,0,0,4,0,0,0,0,0,0,0
.long 852962,0,41088,41088,3345280,1284,16777216,327680,3,0,16,0,16,8192,1314816,16777216
.long 986242,0,41088,41088,3214336,1284,16777216,327680,3,0,16,0,16,8192,1314816,16777216
.long 0,0,0,0,0,0,0,0,4,0,0,0,0,0,0,0
.long 0,0,0,0,0,0,0,0,4,0,0,0,0,0,0,0
.long 1017314,0,41088,41088,3345792,1284,16777216,327680,3,0,16,0,16,8192,1314816,16777216
.long 1150594,0,41088,41088,3214848,1284,16777216,327680,3,0,16,0,16,8192,1314816,16777216
.long 0,0,0,0,0,0,0,0,4,0,0,0,0,0,0,0
.long 0,0,0,0,0,0,0,0,4,0,0,0,0,0,0,0
.long 1181666,0,41088,41088,3346304,1284,16777216,327680,3,0,16,0,16,8192,1314816,16777216
.long 258,0,41088,41088,3276800,1284,16777216,327680,3,0,16,0,16,8192,1314816,16777216
.long 0,0,0,0,0,0,0,0,4,0,0,0,0,0,0,0
.long 0,0,0,0,0,0,0,0,4,0,0,0,0,0,0,0
.long 31330,0,41088,41088,3408256,1284,16777216,327680,3,0,16,0,16,8192,1314816,16777216
.long 164610,0,41088,41088,3277312,1284,16777216,327680,3,0,16,0,16,8192,1314816,16777216
.long 0,0,0,0,0,0,0,0,4,0,0,0,0,0,0,0
.long 0,0,0,0,0,0,0,0,4,0,0,0,0,0,0,0
.long 195682,0,41088,41088,3408768,1284,16777216,327680,3,0,16,0,16,8192,1314816,16777216
.long 328962,0,41088,41088,3277824,1284,16777216,327680,3,0,16,0,16,8192,1314816,16777216
.long 0,0,0,0,0,0,0,0,4,0,0,0,0,0,0,0
.long 0,0,0,0,0,0,0,0,4,0,0,0,0,0,0,0
.long 360034,0,41088,41088,3409280,1284,16777216,327680,3,0,16,0,16,8192,1314816,16777216
.long 493314,0,41088,41088,3278336,1284,16777216,327680,3,0,16,0,16,8192,1314816,16777216
.long 0,0,0,0,0,0,0,0,4,0,0,0,0,0,0,0
.long 0,0,0,0,0,0,0,0,4,0,0,0,0,0,0,0
.long 524386,0,41088,41088,3409792,1284,16777216,327680,3,0,16,0,16,8192,1314816,16777216
.long 657666,0,41088,41088,3278848,1284,16777216,327680,3,0,16,0,16,8192,1314816,16777216
.long 0,0,0,0,0,0,0,0,4,0,0,0,0,0,0,0
.long 0,0,0,0,0,0,0,0,4,0,0,0,0,0,0,0
.long 688738,0,41088,41088,3410304,1284,16777216,327680,3,0,16,0,16,8192,1314816,16777216
.long 822018,0,41088,41088,3279360,1284,16777216,327680,3,0,16,0,16,8192,1314816,16777216
.long 0,0,0,0,0,0,0,0,4,0,0,0,0,0,0,0
.long 0,0,0,0,0,0,0,0,4,0,0,0,0,0,0,0
.long 853090,0,41088,41088,3410816,1284,16777216,327680,3,0,16,0,16,8192,1314816,16777216
.long 986370,0,41088,41088,3279872,1284,16777216,327680,3,0,16,0,16,8192,1314816,16777216
.long 0,0,0,0,0,0,0,0,4,0,0,0,0,0,0,0
.long 0,0,0,0,0,0,0,0,4,0,0,0,0,0,0,0
.long 1017442,0,41088,41088,3411328,1284,16777216,327680,3,0,16,0,16,8192,1314816,16777216
.long 1150722,0,41088,41088,3280384,1284,16777216,327680,3,0,16,0,16,8192,1314816,16777216
.long 0,0,0,0,0,0,0,0,4,0,0,0,0,0,0,0
.long 0,0,0,0,0,0,0,0,4,0,0,0,0,0,0,0
.long 1181794,0,41088,41088,3411840,1284,16777216,327680,3,0,16,0,16,8192,1314816,16777216
.long 386,0,41088,41088,3342336,1284,16777216,327680,3,0,16,0,16,8192,1314816,16777216
.long 0,0,0,0,0,0,0,0,4,0,0,0,0,0,0,0
.long 0,0,0,0,0,0,0,0,4,0,0,0,0,0,0,0
.long 31460,0,41088,41088,3150208,1284,16777216,327680,3,0,16,0,16,8192,1314816,16777216
.long 164738,0,41088,41088,3342848,1284,16777216,327680,3,0,16,0,16,8192,1314816,16777216
.long 0,0,0,0,0,0,0,0,4,0,0,0,0,0,0,0
.long 0,0,0,0,0,0,0,0,4,0,0,0,0,0,0,0
.long 195812,0,41088,41088,3150720,1284,16777216,327680,3,0,16,0,16,8192,1314816,16777216
.long 329090,0,41088,41088,3343360,1284,16777216,327680,3,0,16,0,16,8192,1314816,16777216
.long 0,0,0,0,0,0,0,0,4,0,0,0,0,0,0,0
.long 0,0,0,0,0,0,0,0,4,0,0,0,0,0,0,0
.long 360164,0,41088,41088,3151232,1284,16777216,327680,3,0,16,0,16,8192,1314816,16777216
.long 493442,0,41088,41088,3343872,1284,16777216,327680,3,0,16,0,16,8192,1314816,16777216
.long 0,0,0,0,0,0,0,0,4,0,0,0,0,0,0,0
.long 0,0,0,0,0,0,0,0,4,0,0,0,0,0,0,0
.long 524516,0,41088,41088,3151744,1284,16777216,327680,3,0,16,0,16,8192,1314816,16777216
.long 657794,0,41088,41088,3344384,1284,16777216,327680,3,0,16,0,16,8192,1314816,16777216
.long 0,0,0,0,0,0,0,0,4,0,0,0,0,0,0,0
.long 0,0,0,0,0,0,0,0,4,0,0,0,0,0,0,0
.long 688868,0,41088,41088,3152256,1284,16777216,327680,3,0,16,0,16,8192,1314816,16777216
.long 822146,0,41088,41088,3344896,1284,16777216,327680,3,0,16,0,16,8192,1314816,16777216
.long 0,0,0,0,0,0,0,0,4,0,0,0,0,0,0,0
.long 0,0,0,0,0,0,0,0,4,0,0,0,0,0,0,0
.long 853220,0,41088,41088,3152768,1284,16777216,327680,3,0,16,0,16,8192,1314816,16777216
.long 986498,0,41088,41088,3345408,1284,16777216,327680,3,0,16,0,16,8192,1314816,16777216
.long 0,0,0,0,0,0,0,0,4,0,0,0,0,0,0,0
.long 0,0,0,0,0,0,0,0,4,0,0,0,0,0,0,0
.long 1017572,0,41088,41088,3153280,1284,16777216,327680,3,0,16,0,16,8192,1314816,16777216
.long 1150850,0,41088,41088,3345920,1284,16777216,327680,3,0,16,0,16,8192,1314816,16777216
.long 0,0,0,0,0,0,0,0,4,0,0,0,0,0,0,0
.long 0,0,0,0,0,0,0,0,4,0,0,0,0,0,0,0
.long 1181924,0,41088,41088,3153792,1284,16777216,327680,3,0,16,0,16,8192,1314816,16777216
.long 514,0,41088,41088,3407872,1284,16777216,327680,3,0,16,0,16,8192,1314816,16777216
.long 0,0,0,0,0,0,0,0,4,0,0,0,0,0,0,0
.long 0,0,0,0,0,0,0,0,4,0,0,0,0,0,0,0
.long 31588,0,41088,41088,3215744,1284,16777216,327680,3,0,16,0,16,8192,1314816,16777216
.long 164866,0,41088,41088,3408384,1284,16777216,327680,3,0,16,0,16,8192,1314816,16777216
.long 0,0,0,0,0,0,0,0,4,0,0,0,0,0,0,0
.long 0,0,0,0,0,0,0,0,4,0,0,0,0,0,0,0
.long 195940,0,41088,41088,3216256,1284,16777216,327680,3,0,16,0,16,8192,1314816,16777216
.long 329218,0,41088,41088,3408896,1284,16777216,327680,3,0,16,0,16,8192,1314816,16777216
.long 0,0,0,0,0,0,0,0,4,0,0,0,0,0,0,0
.long 0,0,0,0,0,0,0,0,4,0,0,0,0,0,0,0
.long 360292,0,41088,41088,3216768,1284,16777216,327680,3,0,16,0,16,8192,1314816,16777216
.long 493570,0,41088,41088,3409408,1284,16777216,327680,3,0,16,0,16,8192,1314816,16777216
.long 0,0,0,0,0,0,0,0,4,0,0,0,0,0,0,0
.long 0,0,0,0,0,0,0,0,4,0,0,0,0,0,0,0
.long 524644,0,41088,41088,3217280,1284,16777216,327680,3,0,16,0,16,8192,1314816,16777216
.long 657922,0,41088,41088,3409920,1284,16777216,327680,3,0,16,0,16,8192,1314816,16777216
.long 0,0,0,0,0,0,0,0,4,0,0,0,0,0,0,0
.long 0,0,0,0,0,0,0,0,4,0,0,0,0,0,0,0
.long 688996,0,41088,41088,3217792,1284,16777216,327680,3,0,16,0,16,8192,1314816,16777216
.long 822274,0,41088,41088,3410432,1284,16777216,327680,3,0,16,0,16,8192,1314816,16777216
.long 0,0,0,0,0,0,0,0,4,0,0,0,0,0,0,0
.long 0,0,0,0,0,0,0,0,4,0,0,0,0,0,0,0
.long 853348,0,41088,41088,3218304,1284,16777216,327680,3,0,16,0,16,8192,1314816,16777216
.long 986626,0,41088,41088,3410944,1284,16777216,327680,3,0,16,0,16,8192,1314816,16777216
.long 0,0,0,0,0,0,0,0,4,0,0,0,0,0,0,0
.long 0,0,0,0,0,0,0,0,4,0,0,0,0,0,0,0
.long 1017700,0,41088,41088,3218816,1284,16777216,327680,3,0,16,0,16,8192,1314816,16777216
.long 1150978,0,41088,41088,3411456,1284,16777216,327680,3,0,16,0,16,8192,1314816,16777216
.long 0,0,0,0,0,0,0,0,4,0,0,0,0,0,0,0
.long 0,0,0,0,0,0,0,0,4,0,0,0,0,0,0,0
.long 1182052,0,41088,41088,3219328,1284,16777216,327680,3,0,16,0,16,8192,1314816,16777216
.long 644,0,41088,41088,3149824,1284,16777216,327680,3,0,16,0,16,8192,1314816,16777216
.long 0,0,0,0,0,0,0,0,4,0,0,0,0,0,0,0
.long 0,0,0,0,0,0,0,0,4,0,0,0,0,0,0,0
.long 31716,0,41088,41088,3281280,1284,16777216,327680,3,0,16,0,16,8192,1314816,16777216
.long 164996,0,41088,41088,3150336,1284,16777216,327680,3,0,16,0,16,8192,1314816,16777216
.long 0,0,0,0,0,0,0,0,4,0,0,0,0,0,0,0
.long 0,0,0,0,0,0,0,0,4,0,0,0,0,0,0,0
.long 196068,0,41088,41088,3281792,1284,16777216,327680,3,0,16,0,16,8192,1314816,16777216
.long 329348,0,41088,41088,3150848,1284,16777216,327680,3,0,16,0,16,8192,1314816,16777216
.long 0,0,0,0,0,0,0,0,4,0,0,0,0,0,0,0
.long 0,0,0,0,0,0,0,0,4,0,0,0,0,0,0,0
.long 360420,0,41088,41088,3282304,1284,16777216,327680,3,0,16,0,16,8192,1314816,16777216
.long 493700,0,41088,41088,3151360,1284,16777216,327680,3,0,16,0,16,8192,1314816,16777216
.long 0,0,0,0,0,0,0,0,4,0,0,0,0,0,0,0
.long 0,0,0,0,0,0,0,0,4,0,0,0,0,0,0,0
.long 524772,0,41088,41088,3282816,1284,16777216,327680,3,0,16,0,16,8192,1314816,16777216
.long 658052,0,41088,41088,3151872,1284,16777216,327680,3,0,16,0,16,8192,1314816,16777216
.long 0,0,0,0,0,0,0,0,4,0,0,0,0,0,0,0
.long 0,0,0,0,0,0,0,0,4,0,0,0,0,0,0,0
.long 689124,0,41088,41088,3283328,1284,16777216,327680,3,0,16,0,16,8192,1314816,16777216
.long 822404,0,41088,41088,3152384,1284,16777216,327680,3,0,16,0,16,8192,1314816,16777216
.long 0,0,0,0,0,0,0,0,4,0,0,0,0,0,0,0
.long 0,0,0,0,0,0,0,0,4,0,0,0,0,0,0,0
.long 853476,0,41088,41088,3283840,1284,16777216,327680,3,0,16,0,16,8192,1314816,16777216
.long 986756,0,41088,41088,3152896,1284,16777216,327680,3,0,16,0,16,8192,1314816,16777216
.long 0,0,0,0,0,0,0,0,4,0,0,0,0,0,0,0
.long 0,0,0,0,0,0,0,0,4,0,0,0,0,0,0,0
.long 1017828,0,41088,41088,3284352,1284,16777216,327680,3,0,16,0,16,8192,1314816,16777216
.long 1151108,0,41088,41088,3153408,1284,16777216,327680,3,0,16,0,16,8192,1314816,16777216
.long 0,0,0,0,0,0,0,0,4,0,0,0,0,0,0,0
.long 0,0,0,0,0,0,0,0,4,0,0,0,0,0,0,0
.long 1182180,0,41088,41088,3284864,1284,16777216,327680,3,0,16,0,16,8192,1314816,16777216
.long 772,0,41088,41088,3215360,1284,16777216,327680,3,0,16,0,16,8192,1314816,16777216
.long 0,0,0,0,0,0,0,0,4,0,0,0,0,0,0,0
.long 0,0,0,0,0,0,0,0,4,0,0,0,0,0,0,0
.long 31844,0,41088,41088,3346816,1284,16777216,327680,3,0,16,0,16,8192,1314816,16777216
.long 165124,0,41088,41088,3215872,1284,16777216,327680,3,0,16,0,16,8192,1314816,16777216
.long 0,0,0,0,0,0,0,0,4,0,0,0,0,0,0,0
.long 0,0,0,0,0,0,0,0,4,0,0,0,0,0,0,0
.long 196196,0,41088,41088,3347328,1284,16777216,327680,3,0,16,0,16,8192,1314816,16777216
.long 329476,0,41088,41088,3216384,1284,16777216,327680,3,0,16,0,16,8192,1314816,16777216
.long 0,0,0,0,0,0,0,0,4,0,0,0,0,0,0,0
.long 0,0,0,0,0,0,0,0,4,0,0,0,0,0,0,0
.long 360548,0,41088,41088,3347840,1284,16777216,327680,3,0,16,0,16,8192,1314816,16777216
.long 493828,0,41088,41088,3216896,1284,16777216,327680,3,0,16,0,16,8192,1314816,16777216
.long 0,0,0,0,0,0,0,0,4,0,0,0,0,0,0,0
.long 0,0,0,0,0,0,0,0,4,0,0,0,0,0,0,0
.long 524900,0,41088,41088,3348352,1284,16777216,327680,3,0,16,0,16,8192,1314816,16777216
.long 658180,0,41088,41088,3217408,1284,16777216,327680,3,0,16,0,16,8192,1314816,16777216
.long 0,0,0,0,0,0,0,0,4,0,0,0,0,0,0,0
.long 0,0,0,0,0,0,0,0,4,0,0,0,0,0,0,0
.long 689252,0,41088,41088,3348864,1284,16777216,327680,3,0,16,0,16,8192,1314816,16777216
.long 822532,0,41088,41088,3217920,1284,16777216,327680,3,0,16,0,16,8192,1314816,16777216
.long 0,0,0,0,0,0,0,0,4,0,0,0,0,0,0,0
.long 0,0,0,0,0,0,0,0,4,0,0,0,0,0,0,0
.long 853604,0,41088,41088,3349376,1284,16777216,327680,3,0,16,0,16,8192,1314816,16777216
.long 986884,0,41088,41088,3218432,1284,16777216,327680,3,0,16,0,16,8192,1314816,16777216
.long 0,0,0,0,0,0,0,0,4,0,0,0,0,0,0,0
.long 0,0,0,0,0,0,0,0,4,0,0,0,0,0,0,0
.long 1017956,0,41088,41088,3349888,1284,16777216,327680,3,0,16,0,16,8192,1314816,16777216
.long 1151236,0,41088,41088,3218944,1284,16777216,327680,3,0,16,0,16,8192,1314816,16777216
.long 0,0,0,0,0,0,0,0,4,0,0,0,0,0,0,0
.long 0,0,0,0,0,0,0,0,4,0,0,0,0,0,0,0
.long 1182308,0,41088,41088,3350400,1284,16777216,327680,3,0,16,0,16,8192,1314816,16777216
.long 900,0,41088,41088,3280896,1284,16777216,327680,3,0,16,0,16,8192,1314816,16777216
.long 0,0,0,0,0,0,0,0,4,0,0,0,0,0,0,0
.long 0,0,0,0,0,0,0,0,4,0,0,0,0,0,0,0
.long 31972,0,41088,41088,3412352,1284,16777216,327680,3,0,16,0,16,8192,1314816,16777216
.long 165252,0,41088,41088,3281408,1284,16777216,327680,3,0,16,0,16,8192,1314816,16777216
.long 0,0,0,0,0,0,0,0,4,0,0,0,0,0,0,0
.long 0,0,0,0,0,0,0,0,4,0,0,0,0,0,0,0
.long 196324,0,41088,41088,3412864,1284,16777216,327680,3,0,16,0,16,8192,1314816,16777216
.long 329604,0,41088,41088,3281920,1284,16777216,327680,3,0,16,0,16,8192,1314816,16777216
.long 0,0,0,0,0,0,0,0,4,0,0,0,0,0,0,0
.long 0,0,0,0,0,0,0,0,4,0,0,0,0,0,0,0
.long 360676,0,41088,41088,3413376,1284,16777216,327680,3,0,16,0,16,8192,1314816,16777216
.long 493956,0,41088,41088,3282432,1284,16777216,327680,3,0,16,0,16,8192,1314816,16777216
.long 0,0,0,0,0,0,0,0,4,0,0,0,0,0,0,0
.long 0,0,0,0,0,0,0,0,4,0,0,0,0,0,0,0
.long 525028,0,41088,41088,3413888,1284,16777216,327680,3,0,16,0,16,8192,1314816,16777216
.long 658308,0,41088,41088,3282944,1284,16777216,327680,3,0,16,0,16,8192,1314816,16777216
.long 0,0,0,0,0,0,0,0,4,0,0,0,0,0,0,0
.long 0,0,0,0,0,0,0,0,4,0,0,0,0,0,0,0
.long 689380,0,41088,41088,3414400,1284,16777216,327680,3,0,16,0,16,8192,1314816,16777216
.long 822660,0,41088,41088,3283456,1284,16777216,327680,3,0,16,0,16,8192,1314816,16777216
.long 0,0,0,0,0,0,0,0,4,0,0,0,0,0,0,0
.long 0,0,0,0,0,0,0,0,4,0,0,0,0,0,0,0
.long 853732,0,41088,41088,3414912,1284,16777216,327680,3,0,16,0,16,8192,1314816,16777216
.long 987012,0,41088,41088,3283968,1284,16777216,327680,3,0,16,0,16,8192,1314816,16777216
.long 0,0,0,0,0,0,0,0,4,0,0,0,0,0,0,0
.long 0,0,0,0,0,0,0,0,4,0,0,0,0,0,0,0
.long 1018084,0,41088,41088,3415424,1284,16777216,327680,3,0,16,0,16,8192,1314816,16777216
.long 1151364,0,41088,41088,3284480,1284,16777216,327680,3,0,16,0,16,8192,1314816,16777216
.long 0,0,0,0,0,0,0,0,4,0,0,0,0,0,0,0
.long 0,0,0,0,0,0,0,0,4,0,0,0,0,0,0,0
.long 1182436,0,41088,41088,3415936,1284,16777216,327680,3,0,16,0,16,8192,1314816,16777216
.long 1028,0,41088,41088,3346432,1284,16777216,327680,3,0,16,0,16,8192,1314816,16777216
.long 0,0,0,0,0,0,0,0,4,0,0,0,0,0,0,0
.long 0,0,0,0,0,0,0,0,4,0,0,0,0,0,0,0
.long 1920,3456,3456,3456,6291456,69120,16777216,1024,4,0,16,0,256,16,2211840,16777216
.long 165380,0,41088,41088,3346944,1284,16777216,327680,3,0,16,0,16,8192,1314816,16777216
.long 0,0,0,0,0,0,0,0,4,0,0,0,0,0,0,0
.long 0,0,0,0,0,0,0,0,4,0,0,0,0,0,0,0
.long 278400,3456,3456,3456,6537216,69120,16777216,1024,4,0,16,0,256,16,2211840,16777216
.long 329732,0,41088,41088,3347456,1284,16777216,327680,3,0,16,0,16,8192,1314816,16777216
.long 0,0,0,0,0,0,0,0,4,0,0,0,0,0,0,0
.long 0,0,0,0,0,0,0,0,4,0,0,0,0,0,0,0
.long 2002944,-3456,-3456,-3456,6782976,69120,16777216,1024,4,3,16,0,256,16,2211840,16777216
.long 494084,0,41088,41088,3347968,1284,16777216,327680,3,0,16,0,16,8192,1314816,16777216
.long 0,0,0,0,0,0,0,0,4,0,0,0,0,0,0,0
.long 0,0,0,0,0,0,0,0,4,0,0,0,0,0,0,0
.long 1726464,-3456,-3456,-3456,7028736,69120,16777216,1024,4,3,16,0,256,16,2211840,16777216
.long 658436,0,41088,41088,3348480,1284,16777216,327680,3,0,16,0,16,8192,1314816,16777216
.long 0,0,0,0,0,0,0,0,4,0,0,0,0,0,0,0
.long 0,0,0,0,0,0,0,0,4,0,0,0,0,0,0,0
.long 29568,3456,3456,3456,6340608,69120,16777216,1024,4,0,16,0,256,16,2211840,16777216
.long 822788,0,41088,41088,3348992,1284,16777216,327680,3,0,16,0,16,8192,1314816,16777216
.long 0,0,0,0,0,0,0,0,4,0,0,0,0,0,0,0
.long 0,0,0,0,0,0,0,0,4,0,0,0,0,0,0,0
.long 306048,3456,3456,3456,6586368,69120,16777216,1024,4,0,16,0,256,16,2211840,16777216
.long 987140,0,41088,41088,3349504,1284,16777216,327680,3,0,16,0,16,8192,1314816,16777216
.long 0,0,0,0,0,0,0,0,4,0,0,0,0,0,0,0
.long 0,0,0,0,0,0,0,0,4,0,0,0,0,0,0,0
.long 1975296,-3456,-3456,-3456,6832128,69120,16777216,1024,4,3,16,0,256,16,2211840,16777216
.long 1151492,0,41088,41088,3350016,1284,16777216,327680,3,0,16,0,16,8192,1314816,16777216
.long 0,0,0,0,0,0,0,0,4,0,0,0,0,0,0,0
.long 0,0,0,0,0,0,0,0,4,0,0,0,0,0,0,0
.long 1698816,-3456,-3456,-3456,7077888,69120,16777216,1024,4,3,16,0,256,16,2211840,16777216
.long 1156,0,41088,41088,3411968,1284,16777216,327680,3,0,16,0,16,8192,1314816,16777216
.long 0,0,0,0,0,0,0,0,4,0,0,0,0,0,0,0
.long 0,0,0,0,0,0,0,0,4,0,0,0,0,0,0,0
.long 1107840,3456,3456,3456,6389760,69120,16777216,1024,4,0,16,0,256,16,2211840,16777216
.long 165508,0,41088,41088,3412480,1284,16777216,327680,3,0,16,0,16,8192,1314816,16777216
.long 0,0,0,0,0,0,0,0,4,0,0,0,0,0,0,0
.long 0,0,0,0,0,0,0,0,4,0,0,0,0,0,0,0
.long 1384320,3456,3456,3456,6635520,69120,16777216,1024,4,0,16,0,256,16,2211840,16777216
.long 329860,0,41088,41088,3412992,1284,16777216,327680,3,0,16,0,16,8192,1314816,16777216
.long 0,0,0,0,0,0,0,0,4,0,0,0,0,0,0,0
.long 0,0,0,0,0,0,0,0,4,0,0,0,0,0,0,0
.long 897024,-3456,-3456,-3456,6881280,69120,16777216,1024,4,3,16,0,256,16,2211840,16777216
.long 494212,0,41088,41088,3413504,1284,16777216,327680,3,0,16,0,16,8192,1314816,16777216
.long 0,0,0,0,0,0,0,0,4,0,0,0,0,0,0,0
.long 0,0,0,0,0,0,0,0,4,0,0,0,0,0,0,0
.long 620544,-3456,-3456,-3456,7127040,69120,16777216,1024,4,3,16,0,256,16,2211840,16777216
.long 658564,0,41088,41088,3414016,1284,16777216,327680,3,0,16,0,16,8192,1314816,16777216
.long 0,0,0,0,0,0,0,0,4,0,0,0,0,0,0,0
.long 0,0,0,0,0,0,0,0,4,0,0,0,0,0,0,0
.long 1135488,3456,3456,3456,6438912,69120,16777216,1024,4,0,16,0,256,16,2211840,16777216
.long 822916,0,41088,41088,3414528,1284,16777216,327680,3,0,16,0,16,8192,1314816,16777216
.long 0,0,0,0,0,0,0,0,4,0,0,0,0,0,0,0
.long 0,0,0,0,0,0,0,0,4,0,0,0,0,0,0,0
.long 1411968,3456,3456,3456,6684672,69120,16777216,1024,4,0,16,0,256,16,2211840,16777216
.long 987268,0,41088,41088,3415040,1284,16777216,327680,3,0,16,0,16,8192,1314816,16777216
.long 0,0,0,0,0,0,0,0,4,0,0,0,0,0,0,0
.long 0,0,0,0,0,0,0,0,4,0,0,0,0,0,0,0
.long 869376,-3456,-3456,-3456,6930432,69120,16777216,1024,4,3,16,0,256,16,2211840,16777216
.long 1151620,0,41088,41088,3415552,1284,16777216,327680,3,0,16,0,16,8192,1314816,16777216
.long 0,0,0,0,0,0,0,0,4,0,0,0,0,0,0,0
.long 0,0,0,0,0,0,0,0,4,0,0,0,0,0,0,0
.long 592896,-3456,-3456,-3456,7176192,69120,16777216,1024,4,3,16,0,256,16,2211840,16777216
.long 10274,0,41088,41088,3145856,1284,16777216,327680,3,0,16,0,16,8192,1314816,16777216
.long 0,0,0,0,0,0,0,0,4,0,0,0,0,0,0,0
.long 0,0,0,0,0,0,0,0,4,0,0,0,0,0,0,0
.long 57216,3456,3456,1095552,6488064,69120,16777216,1024,4,0,16,0,256,16,2211840,16777216
.long 174626,0,41088,41088,3146368,1284,16777216,327680,3,0,16,0,16,8192,1314816,16777216
.long 0,0,0,0,0,0,0,0,4,0,0,0,0,0,0,0
.long 0,0,0,0,0,0,0,0,4,0,0,0,0,0,0,0
.long 333696,3456,3456,1095552,6733824,69120,16777216,1024,4,0,16,0,256,16,2211840,16777216
.long 338978,0,41088,41088,3146880,1284,16777216,327680,3,0,16,0,16,8192,1314816,16777216
.long 0,0,0,0,0,0,0,0,4,0,0,0,0,0,0,0
.long 0,0,0,0,0,0,0,0,4,0,0,0,0,0,0,0
.long 1947648,-3456,-3456,-1095552,6979584,69120,16777216,1024,4,3,16,0,256,16,2211840,16777216
.long 503330,0,41088,41088,3147392,1284,16777216,327680,3,0,16,0,16,8192,1314816,16777216
.long 0,0,0,0,0,0,0,0,4,0,0,0,0,0,0,0
.long 0,0,0,0,0,0,0,0,4,0,0,0,0,0,0,0
.long 1671168,-3456,-3456,-1095552,7225344,69120,16777216,1024,4,3,16,0,256,16,2211840,16777216
.long 667682,0,41088,41088,3147904,1284,16777216,327680,3,0,16,0,16,8192,1314816,16777216
.long 0,0,0,0,0,0,0,0,4,0,0,0,0,0,0,0
.long 0,0,0,0,0,0,0,0,4,0,0,0,0,0,0,0
.long 2176,3456,3456,3456,6299648,69120,16777216,1024,4,0,16,0,256,16,2211840,16777216
.long 832034,0,41088,41088,3148416,1284,16777216,327680,3,0,16,0,16,8192,1314816,16777216
.long 0,0,0,0,0,0,0,0,4,0,0,0,0,0,0,0
.long 0,0,0,0,0,0,0,0,4,0,0,0,0,0,0,0
.long 278656,3456,3456,3456,6545408,69120,16777216,1024,4,0,16,0,256,16,2211840,16777216
.long 996386,0,41088,41088,3148928,1284,16777216,327680,3,0,16,0,16,8192,1314816,16777216
.long 0,0,0,0,0,0,0,0,4,0,0,0,0,0,0,0
.long 0,0,0,0,0,0,0,0,4,0,0,0,0,0,0,0
.long 2003200,-3456,-3456,-3456,6791168,69120,16777216,1024,4,3,16,0,256,16,2211840,16777216
.long 1160738,0,41088,41088,3149440,1284,16777216,327680,3,0,16,0,16,8192,1314816,16777216
.long 0,0,0,0,0,0,0,0,4,0,0,0,0,0,0,0
.long 0,0,0,0,0,0,0,0,4,0,0,0,0,0,0,0
.long 1726720,-3456,-3456,-3456,7036928,69120,16777216,1024,4,3,16,0,256,16,2211840,16777216
.long 10402,0,41088,41088,3211392,1284,16777216,327680,3,0,16,0,16,8192,1314816,16777216
.long 0,0,0,0,0,0,0,0,4,0,0,0,0,0,0,0
.long 0,0,0,0,0,0,0,0,4,0,0,0,0,0,0,0
.long 29824,3456,3456,3456,6348800,69120,16777216,1024,4,0,16,0,256,16,2211840,16777216
.long 174754,0,41088,41088,3211904,1284,16777216,327680,3,0,16,0,16,8192,1314816,16777216
.long 0,0,0,0,0,0,0,0,4,0,0,0,0,0,0,0
.long 0,0,0,0,0,0,0,0,4,0,0,0,0,0,0,0
.long 306304,3456,3456,3456,6594560,69120,16777216,1024,4,0,16,0,256,16,2211840,16777216
.long 339106,0,41088,41088,3212416,1284,16777216,327680,3,0,16,0,16,8192,1314816,16777216
.long 0,0,0,0,0,0,0,0,4,0,0,0,0,0,0,0
.long 0,0,0,0,0,0,0,0,4,0,0,0,0,0,0,0
.long 1975552,-3456,-3456,-3456,6840320,69120,16777216,1024,4,3,16,0,256,16,2211840,16777216
.long 503458,0,41088,41088,3212928,1284,16777216,327680,3,0,16,0,16,8192,1314816,16777216
.long 0,0,0,0,0,0,0,0,4,0,0,0,0,0,0,0
.long 0,0,0,0,0,0,0,0,4,0,0,0,0,0,0,0
.long 1699072,-3456,-3456,-3456,7086080,69120,16777216,1024,4,3,16,0,256,16,2211840,16777216
.long 667810,0,41088,41088,3213440,1284,16777216,327680,3,0,16,0,16,8192,1314816,16777216
.long 0,0,0,0,0,0,0,0,4,0,0,0,0,0,0,0
.long 0,0,0,0,0,0,0,0,4,0,0,0,0,0,0,0
.long 1108096,3456,3456,3456,6397952,69120,16777216,1024,4,0,16,0,256,16,2211840,16777216
.long 832162,0,41088,41088,3213952,1284,16777216,327680,3,0,16,0,16,8192,1314816,16777216
.long 0,0,0,0,0,0,0,0,4,0,0,0,0,0,0,0
.long 0,0,0,0,0,0,0,0,4,0,0,0,0,0,0,0
.long 1384576,3456,3456,3456,6643712,69120,16777216,1024,4,0,16,0,256,16,2211840,16777216
.long 996514,0,41088,41088,3214464,1284,16777216,327680,3,0,16,0,16,8192,1314816,16777216
.long 0,0,0,0,0,0,0,0,4,0,0,0,0,0,0,0
.long 0,0,0,0,0,0,0,0,4,0,0,0,0,0,0,0
.long 897280,-3456,-3456,-3456,6889472,69120,16777216,1024,4,3,16,0,256,16,2211840,16777216
.long 1160866,0,41088,41088,3214976,1284,16777216,327680,3,0,16,0,16,8192,1314816,16777216
.long 0,0,0,0,0,0,0,0,4,0,0,0,0,0,0,0
.long 0,0,0,0,0,0,0,0,4,0,0,0,0,0,0,0
.long 620800,-3456,-3456,-3456,7135232,69120,16777216,1024,4,3,16,0,256,16,2211840,16777216
.long 10530,0,41088,41088,3276928,1284,16777216,327680,3,0,16,0,16,8192,1314816,16777216
.long 0,0,0,0,0,0,0,0,4,0,0,0,0,0,0,0
.long 0,0,0,0,0,0,0,0,4,0,0,0,0,0,0,0
.long 1135744,3456,3456,3456,6447104,69120,16777216,1024,4,0,16,0,256,16,2211840,16777216
.long 174882,0,41088,41088,3277440,1284,16777216,327680,3,0,16,0,16,8192,1314816,16777216
.long 0,0,0,0,0,0,0,0,4,0,0,0,0,0,0,0
.long 0,0,0,0,0,0,0,0,4,0,0,0,0,0,0,0
.long 1412224,3456,3456,3456,6692864,69120,16777216,1024,4,0,16,0,256,16,2211840,16777216
.long 339234,0,41088,41088,3277952,1284,16777216,327680,3,0,16,0,16,8192,1314816,16777216
.long 0,0,0,0,0,0,0,0,4,0,0,0,0,0,0,0
.long 0,0,0,0,0,0,0,0,4,0,0,0,0,0,0,0
.long 869632,-3456,-3456,-3456,6938624,69120,16777216,1024,4,3,16,0,256,16,2211840,16777216
.long 503586,0,41088,41088,3278464,1284,16777216,327680,3,0,16,0,16,8192,1314816,16777216
.long 0,0,0,0,0,0,0,0,4,0,0,0,0,0,0,0
.long 0,0,0,0,0,0,0,0,4,0,0,0,0,0,0,0
.long 593152,-3456,-3456,-3456,7184384,69120,16777216,1024,4,3,16,0,256,16,2211840,16777216
.long 667938,0,41088,41088,3278976,1284,16777216,327680,3,0,16,0,16,8192,1314816,16777216
.long 0,0,0,0,0,0,0,0,4,0,0,0,0,0,0,0
.long 0,0,0,0,0,0,0,0,4,0,0,0,0,0,0,0
.long 57472,3456,3456,1095552,6496256,69120,16777216,1024,4,0,16,0,256,16,2211840,16777216
.long 832290,0,41088,41088,3279488,1284,16777216,327680,3,0,16,0,16,8192,1314816,16777216
.long 0,0,0,0,0,0,0,0,4,0,0,0,0,0,0,0
.long 0,0,0,0,0,0,0,0,4,0,0,0,0,0,0,0
.long 333952,3456,3456,1095552,6742016,69120,16777216,1024,4,0,16,0,256,16,2211840,16777216
.long 996642,0,41088,41088,3280000,1284,16777216,327680,3,0,16,0,16,8192,1314816,16777216
.long 0,0,0,0,0,0,0,0,4,0,0,0,0,0,0,0
.long 0,0,0,0,0,0,0,0,4,0,0,0,0,0,0,0
.long 1947904,-3456,-3456,-1095552,6987776,69120,16777216,1024,4,3,16,0,256,16,2211840,16777216
.long 1160994,0,41088,41088,3280512,1284,16777216,327680,3,0,16,0,16,8192,1314816,16777216
.long 0,0,0,0,0,0,0,0,4,0,0,0,0,0,0,0
.long 0,0,0,0,0,0,0,0,4,0,0,0,0,0,0,0
.long 1671424,-3456,-3456,-1095552,7233536,69120,16777216,1024,4,3,16,0,256,16,2211840,16777216
.long 10658,0,41088,41088,3342464,1284,16777216,327680,3,0,16,0,16,8192,1314816,16777216
.long 0,0,0,0,0,0,0,0,4,0,0,0,0,0,0,0
.long 0,0,0,0,0,0,0,0,4,0,0,0,0,0,0,0
.long 2432,3456,3456,3456,6307840,69120,16777216,1024,4,0,16,0,256,16,2211840,16777216
.long 175010,0,41088,41088,3342976,1284,16777216,327680,3,0,16,0,16,8192,1314816,16777216
.long 0,0,0,0,0,0,0,0,4,0,0,0,0,0,0,0
.long 0,0,0,0,0,0,0,0,4,0,0,0,0,0,0,0
.long 278912,3456,3456,3456,6553600,69120,16777216,1024,4,0,16,0,256,16,2211840,16777216
.long 339362,0,41088,41088,3343488,1284,16777216,327680,3,0,16,0,16,8192,1314816,16777216
.long 0,0,0,0,0,0,0,0,4,0,0,0,0,0,0,0
.long 0,0,0,0,0,0,0,0,4,0,0,0,0,0,0,0
.long 2003456,-3456,-3456,-3456,6799360,69120,16777216,1024,4,3,16,0,256,16,2211840,16777216
.long 503714,0,41088,41088,3344000,1284,16777216,327680,3,0,16,0,16,8192,1314816,16777216
.long 0,0,0,0,0,0,0,0,4,0,0,0,0,0,0,0
.long 0,0,0,0,0,0,0,0,4,0,0,0,0,0,0,0
.long 1726976,-3456,-3456,-3456,7045120,69120,16777216,1024,4,3,16,0,256,16,2211840,16777216
.long 668066,0,41088,41088,3344512,1284,16777216,327680,3,0,16,0,16,8192,1314816,16777216
.long 0,0,0,0,0,0,0,0,4,0,0,0,0,0,0,0
.long 0,0,0,0,0,0,0,0,4,0,0,0,0,0,0,0
.long 30080,3456,3456,3456,6356992,69120,16777216,1024,4,0,16,0,256,16,2211840,16777216
.long 832418,0,41088,41088,3345024,1284,16777216,327680,3,0,16,0,16,8192,1314816,16777216
.long 0,0,0,0,0,0,0,0,4,0,0,0,0,0,0,0
.long 0,0,0,0,0,0,0,0,4,0,0,0,0,0,0,0
.long 306560,3456,3456,3456,6602752,69120,16777216,1024,4,0,16,0,256,16,2211840,16777216
.long 996770,0,41088,41088,3345536,1284,16777216,327680,3,0,16,0,16,8192,1314816,16777216
.long 0,0,0,0,0,0,0,0,4,0,0,0,0,0,0,0
.long 0,0,0,0,0,0,0,0,4,0,0,0,0,0,0,0
.long 1975808,-3456,-3456,-3456,6848512,69120,16777216,1024,4,3,16,0,256,16,2211840,16777216
.long 1161122,0,41088,41088,3346048,1284,16777216,327680,3,0,16,0,16,8192,1314816,16777216
.long 0,0,0,0,0,0,0,0,4,0,0,0,0,0,0,0
.long 0,0,0,0,0,0,0,0,4,0,0,0,0,0,0,0
.long 1699328,-3456,-3456,-3456,7094272,69120,16777216,1024,4,3,16,0,256,16,2211840,16777216
.long 10786,0,41088,41088,3408000,1284,16777216,327680,3,0,16,0,16,8192,1314816,16777216
.long 0,0,0,0,0,0,0,0,4,0,0,0,0,0,0,0
.long 0,0,0,0,0,0,0,0,4,0,0,0,0,0,0,0
.long 1108352,3456,3456,3456,6406144,69120,16777216,1024,4,0,16,0,256,16,2211840,16777216
.long 175138,0,41088,41088,3408512,1284,16777216,327680,3,0,16,0,16,8192,1314816,16777216
.long 0,0,0,0,0,0,0,0,4,0,0,0,0,0,0,0
.long 0,0,0,0,0,0,0,0,4,0,0,0,0,0,0,0
.long 1384832,3456,3456,3456,6651904,69120,16777216,1024,4,0,16,0,256,16,2211840,16777216
.long 339490,0,41088,41088,3409024,1284,16777216,327680,3,0,16,0,16,8192,1314816,16777216
.long 0,0,0,0,0,0,0,0,4,0,0,0,0,0,0,0
.long 0,0,0,0,0,0,0,0,4,0,0,0,0,0,0,0
.long 897536,-3456,-3456,-3456,6897664,69120,16777216,1024,4,3,16,0,256,16,2211840,16777216
.long 503842,0,41088,41088,3409536,1284,16777216,327680,3,0,16,0,16,8192,1314816,16777216
.long 0,0,0,0,0,0,0,0,4,0,0,0,0,0,0,0
.long 0,0,0,0,0,0,0,0,4,0,0,0,0,0,0,0
.long 621056,-3456,-3456,-3456,7143424,69120,16777216,1024,4,3,16,0,256,16,2211840,16777216
.long 668194,0,41088,41088,3410048,1284,16777216,327680,3,0,16,0,16,8192,1314816,16777216
.long 0,0,0,0,0,0,0,0,4,0,0,0,0,0,0,0
.long 0,0,0,0,0,0,0,0,4,0,0,0,0,0,0,0
.long 1136000,3456,3456,3456,6455296,69120,16777216,1024,4,0,16,0,256,16,2211840,16777216
.long 832546,0,41088,41088,3410560,1284,16777216,327680,3,0,16,0,16,8192,1314816,16777216
.long 0,0,0,0,0,0,0,0,4,0,0,0,0,0,0,0
.long 0,0,0,0,0,0,0,0,4,0,0,0,0,0,0,0
.long 1412480,3456,3456,3456,6701056,69120,16777216,1024,4,0,16,0,256,16,2211840,16777216
.long 996898,0,41088,41088,3411072,1284,16777216,327680,3,0,16,0,16,8192,1314816,16777216
.long 0,0,0,0,0,0,0,0,4,0,0,0,0,0,0,0
.long 0,0,0,0,0,0,0,0,4,0,0,0,0,0,0,0
.long 869888,-3456,-3456,-3456,6946816,69120,16777216,1024,4,3,16,0,256,16,2211840,16777216
.long 1161250,0,41088,41088,3411584,1284,16777216,327680,3,0,16,0,16,8192,1314816,16777216
.long 0,0,0,0,0,0,0,0,4,0,0,0,0,0,0,0
.long 0,0,0,0,0,0,0,0,4,0,0,0,0,0,0,0
.long 593408,-3456,-3456,-3456,7192576,69120,16777216,1024,4,3,16,0,256,16,2211840,16777216
.long 10916,0,41088,41088,3149952,1284,16777216,327680,3,0,16,0,16,8192,1314816,16777216
.long 0,0,0,0,0,0,0,0,4,0,0,0,0,0,0,0
.long 0,0,0,0,0,0,0,0,4,0,0,0,0,0,0,0
.long 57728,3456,3456,1095552,6504448,69120,16777216,1024,4,0,16,0,256,16,2211840,16777216
.long 175268,0,41088,41088,3150464,1284,16777216,327680,3,0,16,0,16,8192,1314816,16777216
.long 0,0,0,0,0,0,0,0,4,0,0,0,0,0,0,0
.long 0,0,0,0,0,0,0,0,4,0,0,0,0,0,0,0
.long 334208,3456,3456,1095552,6750208,69120,16777216,1024,4,0,16,0,256,16,2211840,16777216
.long 339620,0,41088,41088,3150976,1284,16777216,327680,3,0,16,0,16,8192,1314816,16777216
.long 0,0,0,0,0,0,0,0,4,0,0,0,0,0,0,0
.long 0,0,0,0,0,0,0,0,4,0,0,0,0,0,0,0
.long 1948160,-3456,-3456,-1095552,6995968,69120,16777216,1024,4,3,16,0,256,16,2211840,16777216
.long 503972,0,41088,41088,3151488,1284,16777216,327680,3,0,16,0,16,8192,1314816,16777216
.long 0,0,0,0,0,0,0,0,4,0,0,0,0,0,0,0
.long 0,0,0,0,0,0,0,0,4,0,0,0,0,0,0,0
.long 1671680,-3456,-3456,-1095552,7241728,69120,16777216,1024,4,3,16,0,256,16,2211840,16777216
.long 668324,0,41088,41088,3152000,1284,16777216,327680,3,0,16,0,16,8192,1314816,16777216
.long 0,0,0,0,0,0,0,0,4,0,0,0,0,0,0,0
.long 0,0,0,0,0,0,0,0,4,0,0,0,0,0,0,0
.long 2688,3456,3456,3456,6316032,69120,16777216,1024,4,0,16,0,256,16,2211840,16777216
.long 832676,0,41088,41088,3152512,1284,16777216,327680,3,0,16,0,16,8192,1314816,16777216
.long 0,0,0,0,0,0,0,0,4,0,0,0,0,0,0,0
.long 0,0,0,0,0,0,0,0,4,0,0,0,0,0,0,0
.long 279168,3456,3456,3456,6561792,69120,16777216,1024,4,0,16,0,256,16,2211840,16777216
.long 997028,0,41088,41088,3153024,1284,16777216,327680,3,0,16,0,16,8192,1314816,16777216
.long 0,0,0,0,0,0,0,0,4,0,0,0,0,0,0,0
.long 0,0,0,0,0,0,0,0,4,0,0,0,0,0,0,0
.long 2003712,-3456,-3456,-3456,6807552,69120,16777216,1024,4,3,16,0,256,16,2211840,16777216
.long 1161380,0,41088,41088,3153536,1284,16777216,327680,3,0,16,0,16,8192,1314816,16777216
.long 0,0,0,0,0,0,0,0,4,0,0,0,0,0,0,0
.long 0,0,0,0,0,0,0,0,4,0,0,0,0,0,0,0
.long 1727232,-3456,-3456,-3456,7053312,69120,16777216,1024,4,3,16,0,256,16,2211840,16777216
.long 11044,0,41088,41088,3215488,1284,16777216,327680,3,0,16,0,16,8192,1314816,16777216
.long 0,0,0,0,0,0,0,0,4,0,0,0,0,0,0,0
.long 0,0,0,0,0,0,0,0,4,0,0,0,0,0,0,0
.long 30336,3456,3456,3456,6365184,69120,16777216,1024,4,0,16,0,256,16,2211840,16777216
.long 175396,0,41088,41088,3216000,1284,16777216,327680,3,0,16,0,16,8192,1314816,16777216
.long 0,0,0,0,0,0,0,0,4,0,0,0,0,0,0,0
.long 0,0,0,0,0,0,0,0,4,0,0,0,0,0,0,0
.long 306816,3456,3456,3456,6610944,69120,16777216,1024,4,0,16,0,256,16,2211840,16777216
.long 339748,0,41088,41088,3216512,1284,16777216,327680,3,0,16,0,16,8192,1314816,16777216
.long 0,0,0,0,0,0,0,0,4,0,0,0,0,0,0,0
.long 0,0,0,0,0,0,0,0,4,0,0,0,0,0,0,0
.long 1976064,-3456,-3456,-3456,6856704,69120,16777216,1024,4,3,16,0,256,16,2211840,16777216
.long 504100,0,41088,41088,3217024,1284,16777216,327680,3,0,16,0,16,8192,1314816,16777216
.long 0,0,0,0,0,0,0,0,4,0,0,0,0,0,0,0
.long 0,0,0,0,0,0,0,0,4,0,0,0,0,0,0,0
.long 1699584,-3456,-3456,-3456,7102464,69120,16777216,1024,4,3,16,0,256,16,2211840,16777216
.long 668452,0,41088,41088,3217536,1284,16777216,327680,3,0,16,0,16,8192,1314816,16777216
.long 0,0,0,0,0,0,0,0,4,0,0,0,0,0,0,0
.long 0,0,0,0,0,0,0,0,4,0,0,0,0,0,0,0
.long 1108608,3456,3456,3456,6414336,69120,16777216,1024,4,0,16,0,256,16,2211840,16777216
.long 832804,0,41088,41088,3218048,1284,16777216,327680,3,0,16,0,16,8192,1314816,16777216
.long 0,0,0,0,0,0,0,0,4,0,0,0,0,0,0,0
.long 0,0,0,0,0,0,0,0,4,0,0,0,0,0,0,0
.long 1385088,3456,3456,3456,6660096,69120,16777216,1024,4,0,16,0,256,16,2211840,16777216
.long 997156,0,41088,41088,3218560,1284,16777216,327680,3,0,16,0,16,8192,1314816,16777216
.long 0,0,0,0,0,0,0,0,4,0,0,0,0,0,0,0
.long 0,0,0,0,0,0,0,0,4,0,0,0,0,0,0,0
.long 897792,-3456,-3456,-3456,6905856,69120,16777216,1024,4,3,16,0,256,16,2211840,16777216
.long 1161508,0,41088,41088,3219072,1284,16777216,327680,3,0,16,0,16,8192,1314816,16777216
.long 0,0,0,0,0,0,0,0,4,0,0,0,0,0,0,0
.long 0,0,0,0,0,0,0,0,4,0,0,0,0,0,0,0
.long 621312,-3456,-3456,-3456,7151616,69120,16777216,1024,4,3,16,0,256,16,2211840,16777216
.long 11172,0,41088,41088,3281024,1284,16777216,327680,3,0,16,0,16,8192,1314816,16777216
.long 0,0,0,0,0,0,0,0,4,0,0,0,0,0,0,0
.long 0,0,0,0,0,0,0,0,4,0,0,0,0,0,0,0
.long 1136256,3456,3456,3456,6463488,69120,16777216,1024,4,0,16,0,256,16,2211840,16777216
.long 175524,0,41088,41088,3281536,1284,16777216,327680,3,0,16,0,16,8192,1314816,16777216
.long 0,0,0,0,0,0,0,0,4,0,0,0,0,0,0,0
.long 0,0,0,0,0,0,0,0,4,0,0,0,0,0,0,0
.long 1412736,3456,3456,3456,6709248,69120,16777216,1024,4,0,16,0,256,16,2211840,16777216
.long 339876,0,41088,41088,3282048,1284,16777216,327680,3,0,16,0,16,8192,1314816,16777216
.long 0,0,0,0,0,0,0,0,4,0,0,0,0,0,0,0
.long 0,0,0,0,0,0,0,0,4,0,0,0,0,0,0,0
.long 870144,-3456,-3456,-3456,6955008,69120,16777216,1024,4,3,16,0,256,16,2211840,16777216
.long 504228,0,41088,41088,3282560,1284,16777216,327680,3,0,16,0,16,8192,1314816,16777216
.long 0,0,0,0,0,0,0,0,4,0,0,0,0,0,0,0
.long 0,0,0,0,0,0,0,0,4,0,0,0,0,0,0,0
.long 593664,-3456,-3456,-3456,7200768,69120,16777216,1024,4,3,16,0,256,16,2211840,16777216
.long 668580,0,41088,41088,3283072,1284,16777216,327680,3,0,16,0,16,8192,1314816,16777216
.long 0,0,0,0,0,0,0,0,4,0,0,0,0,0,0,0
.long 0,0,0,0,0,0,0,0,4,0,0,0,0,0,0,0
.long 57984,3456,3456,1095552,6512640,69120,16777216,1024,4,0,16,0,256,16,2211840,16777216
.long 832932,0,41088,41088,3283584,1284,16777216,327680,3,0,16,0,16,8192,1314816,16777216
.long 0,0,0,0,0,0,0,0,4,0,0,0,0,0,0,0
.long 0,0,0,0,0,0,0,0,4,0,0,0,0,0,0,0
.long 334464,3456,3456,1095552,6758400,69120,16777216,1024,4,0,16,0,256,16,2211840,16777216
.long 997284,0,41088,41088,3284096,1284,16777216,327680,3,0,16,0,16,8192,1314816,16777216
.long 0,0,0,0,0,0,0,0,4,0,0,0,0,0,0,0
.long 0,0,0,0,0,0,0,0,4,0,0,0,0,0,0,0
.long 1948416,-3456,-3456,-1095552,7004160,69120,16777216,1024,4,3,16,0,256,16,2211840,16777216
.long 1161636,0,41088,41088,3284608,1284,16777216,327680,3,0,16,0,16,8192,1314816,16777216
.long 0,0,0,0,0,0,0,0,4,0,0,0,0,0,0,0
.long 0,0,0,0,0,0,0,0,4,0,0,0,0,0,0,0
.long 1671936,-3456,-3456,-1095552,7249920,69120,16777216,1024,4,3,16,0,256,16,2211840,16777216
.long 11300,0,41088,41088,3346560,1284,16777216,327680,3,0,16,0,16,8192,1314816,16777216
.long 0,0,0,0,0,0,0,0,4,0,0,0,0,0,0,0
.long 0,0,0,0,0,0,0,0,4,0,0,0,0,0,0,0
.long 2944,3456,3456,3456,6324224,69120,16777216,1024,4,0,16,0,256,16,2211840,16777216
.long 175652,0,41088,41088,3347072,1284,16777216,327680,3,0,16,0,16,8192,1314816,16777216
.long 0,0,0,0,0,0,0,0,4,0,0,0,0,0,0,0
.long 0,0,0,0,0,0,0,0,4,0,0,0,0,0,0,0
.long 279424,3456,3456,3456,6569984,69120,16777216,1024,4,0,16,0,256,16,2211840,16777216
.long 340004,0,41088,41088,3347584,1284,16777216,327680,3,0,16,0,16,8192,1314816,16777216
.long 0,0,0,0,0,0,0,0,4,0,0,0,0,0,0,0
.long 0,0,0,0,0,0,0,0,4,0,0,0,0,0,0,0
.long 2003968,-3456,-3456,-3456,6815744,69120,16777216,1024,4,3,16,0,256,16,2211840,16777216
.long 504356,0,41088,41088,3348096,1284,16777216,327680,3,0,16,0,16,8192,1314816,16777216
.long 0,0,0,0,0,0,0,0,4,0,0,0,0,0,0,0
.long 0,0,0,0,0,0,0,0,4,0,0,0,0,0,0,0
.long 1727488,-3456,-3456,-3456,7061504,69120,16777216,1024,4,3,16,0,256,16,2211840,16777216
.long 668708,0,41088,41088,3348608,1284,16777216,327680,3,0,16,0,16,8192,1314816,16777216
.long 0,0,0,0,0,0,0,0,4,0,0,0,0,0,0,0
.long 0,0,0,0,0,0,0,0,4,0,0,0,0,0,0,0
.long 30592,3456,3456,3456,6373376,69120,16777216,1024,4,0,16,0,256,16,2211840,16777216
.long 833060,0,41088,41088,3349120,1284,16777216,327680,3,0,16,0,16,8192,1314816,16777216
.long 0,0,0,0,0,0,0,0,4,0,0,0,0,0,0,0
.long 0,0,0,0,0,0,0,0,4,0,0,0,0,0,0,0
.long 307072,3456,3456,3456,6619136,69120,16777216,1024,4,0,16,0,256,16,2211840,16777216
.long 997412,0,41088,41088,3349632,1284,16777216,327680,3,0,16,0,16,8192,1314816,16777216
.long 0,0,0,0,0,0,0,0,4,0,0,0,0,0,0,0
.long 0,0,0,0,0,0,0,0,4,0,0,0,0,0,0,0
.long 1976320,-3456,-3456,-3456,6864896,69120,16777216,1024,4,3,16,0,256,16,2211840,16777216
.long 1161764,0,41088,41088,3350144,1284,16777216,327680,3,0,16,0,16,8192,1314816,16777216
.long 0,0,0,0,0,0,0,0,4,0,0,0,0,0,0,0
.long 0,0,0,0,0,0,0,0,4,0,0,0,0,0,0,0
.long 1699840,-3456,-3456,-3456,7110656,69120,16777216,1024,4,3,16,0,256,16,2211840,16777216
.long 11428,0,41088,41088,3412096,1284,16777216,327680,3,0,16,0,16,8192,1314816,16777216
.long 0,0,0,0,0,0,0,0,4,0,0,0,0,0,0,0
.long 0,0,0,0,0,0,0,0,4,0,0,0,0,0,0,0
.long 1108864,3456,3456,3456,6422528,69120,16777216,1024,4,0,16,0,256,16,2211840,16777216
.long 175780,0,41088,41088,3412608,1284,16777216,327680,3,0,16,0,16,8192,1314816,16777216
.long 0,0,0,0,0,0,0,0,4,0,0,0,0,0,0,0
.long 0,0,0,0,0,0,0,0,4,0,0,0,0,0,0,0
.long 1385344,3456,3456,3456,6668288,69120,16777216,1024,4,0,16,0,256,16,2211840,16777216
.long 340132,0,41088,41088,3413120,1284,16777216,327680,3,0,16,0,16,8192,1314816,16777216
.long 0,0,0,0,0,0,0,0,4,0,0,0,0,0,0,0
.long 0,0,0,0,0,0,0,0,4,0,0,0,0,0,0,0
.long 898048,-3456,-3456,-3456,6914048,69120,16777216,1024,4,3,16,0,256,16,2211840,16777216
.long 504484,0,41088,41088,3413632,1284,16777216,327680,3,0,16,0,16,8192,1314816,16777216
.long 0,0,0,0,0,0,0,0,4,0,0,0,0,0,0,0
.long 0,0,0,0,0,0,0,0,4,0,0,0,0,0,0,0
.long 621568,-3456,-3456,-3456,7159808,69120,16777216,1024,4,3,16,0,256,16,2211840,16777216
.long 668836,0,41088,41088,3414144,1284,16777216,327680,3,0,16,0,16,8192,1314816,16777216
.long 0,0,0,0,0,0,0,0,4,0,0,0,0,0,0,0
.long 0,0,0,0,0,0,0,0,4,0,0,0,0,0,0,0
.long 1136512,3456,3456,3456,6471680,69120,16777216,1024,4,0,16,0,256,16,2211840,16777216
.long 833188,0,41088,41088,3414656,1284,16777216,327680,3,0,16,0,16,8192,1314816,16777216
.long 0,0,0,0,0,0,0,0,4,0,0,0,0,0,0,0
.long 0,0,0,0,0,0,0,0,4,0,0,0,0,0,0,0
.long 1412992,3456,3456,3456,6717440,69120,16777216,1024,4,0,16,0,256,16,2211840,16777216
.long 997540,0,41088,41088,3415168,1284,16777216,327680,3,0,16,0,16,8192,1314816,16777216
.long 0,0,0,0,0,0,0,0,4,0,0,0,0,0,0,0
.long 0,0,0,0,0,0,0,0,4,0,0,0,0,0,0,0
.long 870400,-3456,-3456,-3456,6963200,69120,16777216,1024,4,3,16,0,256,16,2211840,16777216
.long 1161892,0,41088,41088,3415680,1284,16777216,327680,3,0,16,0,16,8192,1314816,16777216
.long 0,0,0,0,0,0,0,0,4,0,0,0,0,0,0,0
.long 0,0,0,0,0,0,0,0,4,0,0,0,0,0,0,0
.long 593920,-3456,-3456,-3456,7208960,69120,16777216,1024,4,3,16,0,256,16,2211840,16777216
.long 20546,0,41088,41088,3145984,1284,16777216,327680,3,0,16,0,16,8192,1314816,16777216
.long 0,0,0,0,0,0,0,0,4,0,0,0,0,0,0,0
.long 0,0,0,0,0,0,0,0,4,0,0,0,0,0,0,0
.long 58240,3456,3456,1095552,6520832,69120,16777216,1024,4,0,16,0,256,16,2211840,16777216
.long 184898,0,41088,41088,3146496,1284,16777216,327680,3,0,16,0,16,8192,1314816,16777216
.long 0,0,0,0,0,0,0,0,4,0,0,0,0,0,0,0
.long 0,0,0,0,0,0,0,0,4,0,0,0,0,0,0,0
.long 334720,3456,3456,1095552,6766592,69120,16777216,1024,4,0,16,0,256,16,2211840,16777216
.long 349250,0,41088,41088,3147008,1284,16777216,327680,3,0,16,0,16,8192,1314816,16777216
.long 0,0,0,0,0,0,0,0,4,0,0,0,0,0,0,0
.long 0,0,0,0,0,0,0,0,4,0,0,0,0,0,0,0
.long 1948672,-3456,-3456,-1095552,7012352,69120,16777216,1024,4,3,16,0,256,16,2211840,16777216
.long 513602,0,41088,41088,3147520,1284,16777216,327680,3,0,16,0,16,8192,1314816,16777216
.long 0,0,0,0,0,0,0,0,4,0,0,0,0,0,0,0
.long 0,0,0,0,0,0,0,0,4,0,0,0,0,0,0,0
.long 1672192,-3456,-3456,-1095552,7258112,69120,16777216,1024,4,3,16,0,256,16,2211840,16777216
.long 677954,0,41088,41088,3148032,1284,16777216,327680,3,0,16,0,16,8192,1314816,16777216
.long 0,0,0,0,0,0,0,0,4,0,0,0,0,0,0,0
.long 0,0,0,0,0,0,0,0,4,0,0,0,0,0,0,0
.long 3200,3456,3456,3456,6332416,69120,16777216,1024,4,0,16,0,256,16,2211840,16777216
.long 842306,0,41088,41088,3148544,1284,16777216,327680,3,0,16,0,16,8192,1314816,16777216
.long 0,0,0,0,0,0,0,0,4,0,0,0,0,0,0,0
.long 0,0,0,0,0,0,0,0,4,0,0,0,0,0,0,0
.long 279680,3456,3456,3456,6578176,69120,16777216,1024,4,0,16,0,256,16,2211840,16777216
.long 1006658,0,41088,41088,3149056,1284,16777216,327680,3,0,16,0,16,8192,1314816,16777216
.long 0,0,0,0,0,0,0,0,4,0,0,0,0,0,0,0
.long 0,0,0,0,0,0,0,0,4,0,0,0,0,0,0,0
.long 2004224,-3456,-3456,-3456,6823936,69120,16777216,1024,4,3,16,0,256,16,2211840,16777216
.long 1171010,0,41088,41088,3149568,1284,16777216,327680,3,0,16,0,16,8192,1314816,16777216
.long 0,0,0,0,0,0,0,0,4,0,0,0,0,0,0,0
.long 0,0,0,0,0,0,0,0,4,0,0,0,0,0,0,0
.long 1727744,-3456,-3456,-3456,7069696,69120,16777216,1024,4,3,16,0,256,16,2211840,16777216
.long 20674,0,41088,41088,3211520,1284,16777216,327680,3,0,16,0,16,8192,1314816,16777216
.long 0,0,0,0,0,0,0,0,4,0,0,0,0,0,0,0
.long 0,0,0,0,0,0,0,0,4,0,0,0,0,0,0,0
.long 30848,3456,3456,3456,6381568,69120,16777216,1024,4,0,16,0,256,16,2211840,16777216
.long 185026,0,41088,41088,3212032,1284,16777216,327680,3,0,16,0,16,8192,1314816,16777216
.long 0,0,0,0,0,0,0,0,4,0,0,0,0,0,0,0
.long 0,0,0,0,0,0,0,0,4,0,0,0,0,0,0,0
.long 307328,3456,3456,3456,6627328,69120,16777216,1024,4,0,16,0,256,16,2211840,16777216
.long 349378,0,41088,41088,3212544,1284,16777216,327680,3,0,16,0,16,8192,1314816,16777216
.long 0,0,0,0,0,0,0,0,4,0,0,0,0,0,0,0
.long 0,0,0,0,0,0,0,0,4,0,0,0,0,0,0,0
.long 1976576,-3456,-3456,-3456,6873088,69120,16777216,1024,4,3,16,0,256,16,2211840,16777216
.long 513730,0,41088,41088,3213056,1284,16777216,327680,3,0,16,0,16,8192,1314816,16777216
.long 0,0,0,0,0,0,0,0,4,0,0,0,0,0,0,0
.long 0,0,0,0,0,0,0,0,4,0,0,0,0,0,0,0
.long 1700096,-3456,-3456,-3456,7118848,69120,16777216,1024,4,3,16,0,256,16,2211840,16777216
.long 678082,0,41088,41088,3213568,1284,16777216,327680,3,0,16,0,16,8192,1314816,16777216
.long 0,0,0,0,0,0,0,0,4,0,0,0,0,0,0,0
.long 0,0,0,0,0,0,0,0,4,0,0,0,0,0,0,0
.long 1109120,3456,3456,3456,6430720,69120,16777216,1024,4,0,16,0,256,16,2211840,16777216
.long 842434,0,41088,41088,3214080,1284,16777216,327680,3,0,16,0,16,8192,1314816,16777216
.long 0,0,0,0,0,0,0,0,4,0,0,0,0,0,0,0
.long 0,0,0,0,0,0,0,0,4,0,0,0,0,0,0,0
.long 1385600,3456,3456,3456,6676480,69120,16777216,1024,4,0,16,0,256,16,2211840,16777216
.long 1006786,0,41088,41088,3214592,1284,16777216,327680,3,0,16,0,16,8192,1314816,16777216
.long 0,0,0,0,0,0,0,0,4,0,0,0,0,0,0,0
.long 0,0,0,0,0,0,0,0,4,0,0,0,0,0,0,0
.long 898304,-3456,-3456,-3456,6922240,69120,16777216,1024,4,3,16,0,256,16,2211840,16777216
.long 1171138,0,41088,41088,3215104,1284,16777216,327680,3,0,16,0,16,8192,1314816,16777216
.long 0,0,0,0,0,0,0,0,4,0,0,0,0,0,0,0
.long 0,0,0,0,0,0,0,0,4,0,0,0,0,0,0,0
.long 621824,-3456,-3456,-3456,7168000,69120,16777216,1024,4,3,16,0,256,16,2211840,16777216
.long 20802,0,41088,41088,3277056,1284,16777216,327680,3,0,16,0,16,8192,1314816,16777216
.long 0,0,0,0,0,0,0,0,4,0,0,0,0,0,0,0
.long 0,0,0,0,0,0,0,0,4,0,0,0,0,0,0,0
.long 1136768,3456,3456,3456,6479872,69120,16777216,1024,4,0,16,0,256,16,2211840,16777216
.long 185154,0,41088,41088,3277568,1284,16777216,327680,3,0,16,0,16,8192,1314816,16777216
.long 0,0,0,0,0,0,0,0,4,0,0,0,0,0,0,0
.long 0,0,0,0,0,0,0,0,4,0,0,0,0,0,0,0
.long 1413248,3456,3456,3456,6725632,69120,16777216,1024,4,0,16,0,256,16,2211840,16777216
.long 349506,0,41088,41088,3278080,1284,16777216,327680,3,0,16,0,16,8192,1314816,16777216
.long 0,0,0,0,0,0,0,0,4,0,0,0,0,0,0,0
.long 0,0,0,0,0,0,0,0,4,0,0,0,0,0,0,0
.long 870656,-3456,-3456,-3456,6971392,69120,16777216,1024,4,3,16,0,256,16,2211840,16777216
.long 513858,0,41088,41088,3278592,1284,16777216,327680,3,0,16,0,16,8192,1314816,16777216
.long 0,0,0,0,0,0,0,0,4,0,0,0,0,0,0,0
.long 0,0,0,0,0,0,0,0,4,0,0,0,0,0,0,0
.long 594176,-3456,-3456,-3456,7217152,69120,16777216,1024,4,3,16,0,256,16,2211840,16777216
.long 678210,0,41088,41088,3279104,1284,16777216,327680,3,0,16,0,16,8192,1314816,16777216
.long 0,0,0,0,0,0,0,0,4,0,0,0,0,0,0,0
.long 0,0,0,0,0,0,0,0,4,0,0,0,0,0,0,0
.long 58496,3456,3456,1095552,6529024,69120,16777216,1024,4,0,16,0,256,16,2211840,16777216
.long 842562,0,41088,41088,3279616,1284,16777216,327680,3,0,16,0,16,8192,1314816,16777216
.long 0,0,0,0,0,0,0,0,4,0,0,0,0,0,0,0
.long 0,0,0,0,0,0,0,0,4,0,0,0,0,0,0,0
.long 334976,3456,3456,1095552,6774784,69120,16777216,1024,4,0,16,0,256,16,2211840,16777216
.long 1006914,0,41088,41088,3280128,1284,16777216,327680,3,0,16,0,16,8192,1314816,16777216
.long 0,0,0,0,0,0,0,0,4,0,0,0,0,0,0,0
.long 0,0,0,0,0,0,0,0,4,0,0,0,0,0,0,0
.long 1948928,-3456,-3456,-1095552,7020544,69120,16777216,1024,4,3,16,0,256,16,2211840,16777216
.long 1171266,0,41088,41088,3280640,1284,16777216,327680,3,0,16,0,16,8192,1314816,16777216
.long 0,0,0,0,0,0,0,0,4,0,0,0,0,0,0,0
.long 0,0,0,0,0,0,0,0,4,0,0,0,0,0,0,0
.long 1672448,-3456,-3456,-1095552,7266304,69120,16777216,1024,4,3,16,0,256,16,2211840,16777216
.long 20930,0,41088,41088,3342592,1284,16777216,327680,3,0,16,0,16,8192,1314816,16777216
.long 0,0,0,0,0,0,0,0,4,0,0,0,0,0,0,0
.long 0,0,0,0,0,0,0,0,4,0,0,0,0,0,0,0
.long 0,0,0,0,0,0,0,0,4,0,0,0,0,0,0,0
.long 185282,0,41088,41088,3343104,1284,16777216,327680,3,0,16,0,16,8192,1314816,16777216
.long 0,0,0,0,0,0,0,0,4,0,0,0,0,0,0,0
.long 0,0,0,0,0,0,0,0,4,0,0,0,0,0,0,0
.long 0,0,0,0,0,0,0,0,4,0,0,0,0,0,0,0
.long 349634,0,41088,41088,3343616,1284,16777216,327680,3,0,16,0,16,8192,1314816,16777216
.long 0,0,0,0,0,0,0,0,4,0,0,0,0,0,0,0
.long 0,0,0,0,0,0,0,0,4,0,0,0,0,0,0,0
.long 0,0,0,0,0,0,0,0,4,0,0,0,0,0,0,0
.long 513986,0,41088,41088,3344128,1284,16777216,327680,3,0,16,0,16,8192,1314816,16777216
.long 0,0,0,0,0,0,0,0,4,0,0,0,0,0,0,0
.long 0,0,0,0,0,0,0,0,4,0,0,0,0,0,0,0
.long 0,0,0,0,0,0,0,0,4,0,0,0,0,0,0,0
.long 678338,0,41088,41088,3344640,1284,16777216,327680,3,0,16,0,16,8192,1314816,16777216
.long 0,0,0,0,0,0,0,0,4,0,0,0,0,0,0,0
.long 0,0,0,0,0,0,0,0,4,0,0,0,0,0,0,0
.long 0,0,0,0,0,0,0,0,4,0,0,0,0,0,0,0
.long 842690,0,41088,41088,3345152,1284,16777216,327680,3,0,16,0,16,8192,1314816,16777216
.long 0,0,0,0,0,0,0,0,4,0,0,0,0,0,0,0
.long 0,0,0,0,0,0,0,0,4,0,0,0,0,0,0,0
.long 0,0,0,0,0,0,0,0,4,0,0,0,0,0,0,0
.long 1007042,0,41088,41088,3345664,1284,16777216,327680,3,0,16,0,16,8192,1314816,16777216
.long 0,0,0,0,0,0,0,0,4,0,0,0,0,0,0,0
.long 0,0,0,0,0,0,0,0,4,0,0,0,0,0,0,0
.long 0,0,0,0,0,0,0,0,4,0,0,0,0,0,0,0
.long 1171394,0,41088,41088,3346176,1284,16777216,327680,3,0,16,0,16,8192,1314816,16777216
.long 0,0,0,0,0,0,0,0,4,0,0,0,0,0,0,0
.long 0,0,0,0,0,0,0,0,4,0,0,0,0,0,0,0
.long 0,0,0,0,0,0,0,0,4,0,0,0,0,0,0,0
.long 21058,0,41088,41088,3408128,1284,16777216,327680,3,0,16,0,16,8192,1314816,16777216
.long 0,0,0,0,0,0,0,0,4,0,0,0,0,0,0,0
.long 0,0,0,0,0,0,0,0,4,0,0,0,0,0,0,0
.long 0,0,0,0,0,0,0,0,4,0,0,0,0,0,0,0
.long 185410,0,41088,41088,3408640,1284,16777216,327680,3,0,16,0,16,8192,1314816,16777216
.long 0,0,0,0,0,0,0,0,4,0,0,0,0,0,0,0
.long 0,0,0,0,0,0,0,0,4,0,0,0,0,0,0,0
.long 0,0,0,0,0,0,0,0,4,0,0,0,0,0,0,0
.long 349762,0,41088,41088,3409152,1284,16777216,327680,3,0,16,0,16,8192,1314816,16777216
.long 0,0,0,0,0,0,0,0,4,0,0,0,0,0,0,0
.long 0,0,0,0,0,0,0,0,4,0,0,0,0,0,0,0
.long 0,0,0,0,0,0,0,0,4,0,0,0,0,0,0,0
.long 514114,0,41088,41088,3409664,1284,16777216,327680,3,0,16,0,16,8192,1314816,16777216
.long 0,0,0,0,0,0,0,0,4,0,0,0,0,0,0,0
.long 0,0,0,0,0,0,0,0,4,0,0,0,0,0,0,0
.long 0,0,0,0,0,0,0,0,4,0,0,0,0,0,0,0
.long 678466,0,41088,41088,3410176,1284,16777216,327680,3,0,16,0,16,8192,1314816,16777216
.long 0,0,0,0,0,0,0,0,4,0,0,0,0,0,0,0
.long 0,0,0,0,0,0,0,0,4,0,0,0,0,0,0,0
.long 0,0,0,0,0,0,0,0,4,0,0,0,0,0,0,0
.long 842818,0,41088,41088,3410688,1284,16777216,327680,3,0,16,0,16,8192,1314816,16777216
.long 0,0,0,0,0,0,0,0,4,0,0,0,0,0,0,0
.long 0,0,0,0,0,0,0,0,4,0,0,0,0,0,0,0
.long 0,0,0,0,0,0,0,0,4,0,0,0,0,0,0,0
.long 1007170,0,41088,41088,3411200,1284,16777216,327680,3,0,16,0,16,8192,1314816,16777216
.long 0,0,0,0,0,0,0,0,4,0,0,0,0,0,0,0
.long 0,0,0,0,0,0,0,0,4,0,0,0,0,0,0,0
.long 0,0,0,0,0,0,0,0,4,0,0,0,0,0,0,0
.long 1171522,0,41088,41088,3411712,1284,16777216,327680,3,0,16,0,16,8192,1314816,16777216
.long 0,0,0,0,0,0,0,0,4,0,0,0,0,0,0,0
.long 0,0,0,0,0,0,0,0,4,0,0,0,0,0,0,0
.long 0,0,0,0,0,0,0,0,4,0,0,0,0,0,0,0
.long 21188,0,41088,41088,3150080,1284,16777216,327680,3,0,16,0,16,8192,1314816,16777216
.long 0,0,0,0,0,0,0,0,4,0,0,0,0,0,0,0
.long 0,0,0,0,0,0,0,0,4,0,0,0,0,0,0,0
.long 0,0,0,0,0,0,0,0,4,0,0,0,0,0,0,0
.long 185540,0,41088,41088,3150592,1284,16777216,327680,3,0,16,0,16,8192,1314816,16777216
.long 0,0,0,0,0,0,0,0,4,0,0,0,0,0,0,0
.long 0,0,0,0,0,0,0,0,4,0,0,0,0,0,0,0
.long 0,0,0,0,0,0,0,0,4,0,0,0,0,0,0,0
.long 349892,0,41088,41088,3151104,1284,16777216,327680,3,0,16,0,16,8192,1314816,16777216
.long 0,0,0,0,0,0,0,0,4,0,0,0,0,0,0,0
.long 0,0,0,0,0,0,0,0,4,0,0,0,0,0,0,0
.long 0,0,0,0,0,0,0,0,4,0,0,0,0,0,0,0
.long 514244,0,41088,41088,3151616,1284,16777216,327680,3,0,16,0,16,8192,1314816,16777216
.long 0,0,0,0,0,0,0,0,4,0,0,0,0,0,0,0
.long 0,0,0,0,0,0,0,0,4,0,0,0,0,0,0,0
.long 0,0,0,0,0,0,0,0,4,0,0,0,0,0,0,0
.long 678596,0,41088,41088,3152128,1284,16777216,327680,3,0,16,0,16,8192,1314816,16777216
.long 0,0,0,0,0,0,0,0,4,0,0,0,0,0,0,0
.long 0,0,0,0,0,0,0,0,4,0,0,0,0,0,0,0
.long 0,0,0,0,0,0,0,0,4,0,0,0,0,0,0,0
.long 842948,0,41088,41088,3152640,1284,16777216,327680,3,0,16,0,16,8192,1314816,16777216
.long 0,0,0,0,0,0,0,0,4,0,0,0,0,0,0,0
.long 0,0,0,0,0,0,0,0,4,0,0,0,0,0,0,0
.long 0,0,0,0,0,0,0,0,4,0,0,0,0,0,0,0
.long 1007300,0,41088,41088,3153152,1284,16777216,327680,3,0,16,0,16,8192,1314816,16777216
.long 0,0,0,0,0,0,0,0,4,0,0,0,0,0,0,0
.long 0,0,0,0,0,0,0,0,4,0,0,0,0,0,0,0
.long 0,0,0,0,0,0,0,0,4,0,0,0,0,0,0,0
.long 1171652,0,41088,41088,3153664,1284,16777216,327680,3,0,16,0,16,8192,1314816,16777216
.long 0,0,0,0,0,0,0,0,4,0,0,0,0,0,0,0
.long 0,0,0,0,0,0,0,0,4,0,0,0,0,0,0,0
.long 0,0,0,0,0,0,0,0,4,0,0,0,0,0,0,0
.long 21316,0,41088,41088,3215616,1284,16777216,327680,3,0,16,0,16,8192,1314816,16777216
.long 0,0,0,0,0,0,0,0,4,0,0,0,0,0,0,0
.long 0,0,0,0,0,0,0,0,4,0,0,0,0,0,0,0
.long 0,0,0,0,0,0,0,0,4,0,0,0,0,0,0,0
.long 185668,0,41088,41088,3216128,1284,16777216,327680,3,0,16,0,16,8192,1314816,16777216
.long 0,0,0,0,0,0,0,0,4,0,0,0,0,0,0,0
.long 0,0,0,0,0,0,0,0,4,0,0,0,0,0,0,0
.long 0,0,0,0,0,0,0,0,4,0,0,0,0,0,0,0
.long 350020,0,41088,41088,3216640,1284,16777216,327680,3,0,16,0,16,8192,1314816,16777216
.long 0,0,0,0,0,0,0,0,4,0,0,0,0,0,0,0
.long 0,0,0,0,0,0,0,0,4,0,0,0,0,0,0,0
.long 0,0,0,0,0,0,0,0,4,0,0,0,0,0,0,0
.long 514372,0,41088,41088,3217152,1284,16777216,327680,3,0,16,0,16,8192,1314816,16777216
.long 0,0,0,0,0,0,0,0,4,0,0,0,0,0,0,0
.long 0,0,0,0,0,0,0,0,4,0,0,0,0,0,0,0
.long 0,0,0,0,0,0,0,0,4,0,0,0,0,0,0,0
.long 678724,0,41088,41088,3217664,1284,16777216,327680,3,0,16,0,16,8192,1314816,16777216
.long 0,0,0,0,0,0,0,0,4,0,0,0,0,0,0,0
.long 0,0,0,0,0,0,0,0,4,0,0,0,0,0,0,0
.long 0,0,0,0,0,0,0,0,4,0,0,0,0,0,0,0
.long 843076,0,41088,41088,3218176,1284,16777216,327680,3,0,16,0,16,8192,1314816,16777216
.long 0,0,0,0,0,0,0,0,4,0,0,0,0,0,0,0
.long 0,0,0,0,0,0,0,0,4,0,0,0,0,0,0,0
.long 0,0,0,0,0,0,0,0,4,0,0,0,0,0,0,0
.long 1007428,0,41088,41088,3218688,1284,16777216,327680,3,0,16,0,16,8192,1314816,16777216
.long 0,0,0,0,0,0,0,0,4,0,0,0,0,0,0,0
.long 0,0,0,0,0,0,0,0,4,0,0,0,0,0,0,0
.long 0,0,0,0,0,0,0,0,4,0,0,0,0,0,0,0
.long 1171780,0,41088,41088,3219200,1284,16777216,327680,3,0,16,0,16,8192,1314816,16777216
.long 0,0,0,0,0,0,0,0,4,0,0,0,0,0,0,0
.long 0,0,0,0,0,0,0,0,4,0,0,0,0,0,0,0
.long 0,0,0,0,0,0,0,0,4,0,0,0,0,0,0,0
.long 21444,0,41088,41088,3281152,1284,16777216,327680,3,0,16,0,16,8192,1314816,16777216
.long 0,0,0,0,0,0,0,0,4,0,0,0,0,0,0,0
.long 0,0,0,0,0,0,0,0,4,0,0,0,0,0,0,0
.long 0,0,0,0,0,0,0,0,4,0,0,0,0,0,0,0
.long 185796,0,41088,41088,3281664,1284,16777216,327680,3,0,16,0,16,8192,1314816,16777216
.long 0,0,0,0,0,0,0,0,4,0,0,0,0,0,0,0
.long 0,0,0,0,0,0,0,0,4,0,0,0,0,0,0,0
.long 0,0,0,0,0,0,0,0,4,0,0,0,0,0,0,0
.long 350148,0,41088,41088,3282176,1284,16777216,327680,3,0,16,0,16,8192,1314816,16777216
.long 0,0,0,0,0,0,0,0,4,0,0,0,0,0,0,0
.long 0,0,0,0,0,0,0,0,4,0,0,0,0,0,0,0
.long 0,0,0,0,0,0,0,0,4,0,0,0,0,0,0,0
.long 514500,0,41088,41088,3282688,1284,16777216,327680,3,0,16,0,16,8192,1314816,16777216
.long 0,0,0,0,0,0,0,0,4,0,0,0,0,0,0,0
.long 0,0,0,0,0,0,0,0,4,0,0,0,0,0,0,0
.long 0,0,0,0,0,0,0,0,4,0,0,0,0,0,0,0
.long 678852,0,41088,41088,3283200,1284,16777216,327680,3,0,16,0,16,8192,1314816,16777216
.long 0,0,0,0,0,0,0,0,4,0,0,0,0,0,0,0
.long 0,0,0,0,0,0,0,0,4,0,0,0,0,0,0,0
.long 0,0,0,0,0,0,0,0,4,0,0,0,0,0,0,0
.long 843204,0,41088,41088,3283712,1284,16777216,327680,3,0,16,0,16,8192,1314816,16777216
.long 0,0,0,0,0,0,0,0,4,0,0,0,0,0,0,0
.long 0,0,0,0,0,0,0,0,4,0,0,0,0,0,0,0
.long 0,0,0,0,0,0,0,0,4,0,0,0,0,0,0,0
.long 1007556,0,41088,41088,3284224,1284,16777216,327680,3,0,16,0,16,8192,1314816,16777216
.long 0,0,0,0,0,0,0,0,4,0,0,0,0,0,0,0
.long 0,0,0,0,0,0,0,0,4,0,0,0,0,0,0,0
.long 0,0,0,0,0,0,0,0,4,0,0,0,0,0,0,0
.long 1171908,0,41088,41088,3284736,1284,16777216,327680,3,0,16,0,16,8192,1314816,16777216
.long 0,0,0,0,0,0,0,0,4,0,0,0,0,0,0,0
.long 0,0,0,0,0,0,0,0,4,0,0,0,0,0,0,0
.long 0,0,0,0,0,0,0,0,4,0,0,0,0,0,0,0
.long 21572,0,41088,41088,3346688,1284,16777216,327680,3,0,16,0,16,8192,1314816,16777216
.long 0,0,0,0,0,0,0,0,4,0,0,0,0,0,0,0
.long 0,0,0,0,0,0,0,0,4,0,0,0,0,0,0,0
.long 0,0,0,0,0,0,0,0,4,0,0,0,0,0,0,0
.long 185924,0,41088,41088,3347200,1284,16777216,327680,3,0,16,0,16,8192,1314816,16777216
.long 0,0,0,0,0,0,0,0,4,0,0,0,0,0,0,0
.long 0,0,0,0,0,0,0,0,4,0,0,0,0,0,0,0
.long 0,0,0,0,0,0,0,0,4,0,0,0,0,0,0,0
.long 350276,0,41088,41088,3347712,1284,16777216,327680,3,0,16,0,16,8192,1314816,16777216
.long 0,0,0,0,0,0,0,0,4,0,0,0,0,0,0,0
.long 0,0,0,0,0,0,0,0,4,0,0,0,0,0,0,0
.long 0,0,0,0,0,0,0,0,4,0,0,0,0,0,0,0
.long 514628,0,41088,41088,3348224,1284,16777216,327680,3,0,16,0,16,8192,1314816,16777216
.long 0,0,0,0,0,0,0,0,4,0,0,0,0,0,0,0
.long 0,0,0,0,0,0,0,0,4,0,0,0,0,0,0,0
.long 0,0,0,0,0,0,0,0,4,0,0,0,0,0,0,0
.long 678980,0,41088,41088,3348736,1284,16777216,327680,3,0,16,0,16,8192,1314816,16777216
.long 0,0,0,0,0,0,0,0,4,0,0,0,0,0,0,0
.long 0,0,0,0,0,0,0,0,4,0,0,0,0,0,0,0
.long 0,0,0,0,0,0,0,0,4,0,0,0,0,0,0,0
.long 843332,0,41088,41088,3349248,1284,16777216,327680,3,0,16,0,16,8192,1314816,16777216
.long 0,0,0,0,0,0,0,0,4,0,0,0,0,0,0,0
.long 0,0,0,0,0,0,0,0,4,0,0,0,0,0,0,0
.long 0,0,0,0,0,0,0,0,4,0,0,0,0,0,0,0
.long 1007684,0,41088,41088,3349760,1284,16777216,327680,3,0,16,0,16,8192,1314816,16777216
.long 0,0,0,0,0,0,0,0,4,0,0,0,0,0,0,0
.long 0,0,0,0,0,0,0,0,4,0,0,0,0,0,0,0
.long 0,0,0,0,0,0,0,0,4,0,0,0,0,0,0,0
.long 1172036,0,41088,41088,3350272,1284,16777216,327680,3,0,16,0,16,8192,1314816,16777216
.long 0,0,0,0,0,0,0,0,4,0,0,0,0,0,0,0
.long 0,0,0,0,0,0,0,0,4,0,0,0,0,0,0,0
.long 0,0,0,0,0,0,0,0,4,0,0,0,0,0,0,0
.long 21700,0,41088,41088,3412224,1284,16777216,327680,3,0,16,0,16,8192,1314816,16777216
.long 0,0,0,0,0,0,0,0,4,0,0,0,0,0,0,0
.long 0,0,0,0,0,0,0,0,4,0,0,0,0,0,0,0
.long 0,0,0,0,0,0,0,0,4,0,0,0,0,0,0,0
.long 186052,0,41088,41088,3412736,1284,16777216,327680,3,0,16,0,16,8192,1314816,16777216
.long 0,0,0,0,0,0,0,0,4,0,0,0,0,0,0,0
.long 0,0,0,0,0,0,0,0,4,0,0,0,0,0,0,0
.long 0,0,0,0,0,0,0,0,4,0,0,0,0,0,0,0
.long 350404,0,41088,41088,3413248,1284,16777216,327680,3,0,16,0,16,8192,1314816,16777216
.long 0,0,0,0,0,0,0,0,4,0,0,0,0,0,0,0
.long 0,0,0,0,0,0,0,0,4,0,0,0,0,0,0,0
.long 0,0,0,0,0,0,0,0,4,0,0,0,0,0,0,0
.long 514756,0,41088,41088,3413760,1284,16777216,327680,3,0,16,0,16,8192,1314816,16777216
.long 0,0,0,0,0,0,0,0,4,0,0,0,0,0,0,0
.long 0,0,0,0,0,0,0,0,4,0,0,0,0,0,0,0
.long 0,0,0,0,0,0,0,0,4,0,0,0,0,0,0,0
.long 679108,0,41088,41088,3414272,1284,16777216,327680,3,0,16,0,16,8192,1314816,16777216
.long 0,0,0,0,0,0,0,0,4,0,0,0,0,0,0,0
.long 0,0,0,0,0,0,0,0,4,0,0,0,0,0,0,0
.long 0,0,0,0,0,0,0,0,4,0,0,0,0,0,0,0
.long 843460,0,41088,41088,3414784,1284,16777216,327680,3,0,16,0,16,8192,1314816,16777216
.long 0,0,0,0,0,0,0,0,4,0,0,0,0,0,0,0
.long 0,0,0,0,0,0,0,0,4,0,0,0,0,0,0,0
.long 0,0,0,0,0,0,0,0,4,0,0,0,0,0,0,0
.long 1007812,0,41088,41088,3415296,1284,16777216,327680,3,0,16,0,16,8192,1314816,16777216
.long 0,0,0,0,0,0,0,0,4,0,0,0,0,0,0,0
.long 0,0,0,0,0,0,0,0,4,0,0,0,0,0,0,0
.long 0,0,0,0,0,0,0,0,4,0,0,0,0,0,0,0
.long 1172164,0,41088,41088,3415808,1284,16777216,327680,3,0,16,0,16,8192,1314816,16777216
.long 0,0,0,0,0,0,0,0,4,0,0,0,0,0,0,0
.long 0,0,0,0,0,0,0,0,4,0,0,0,0,0,0,0
.long 0,0,0,0,0,0,0,0,4,0,0,0,0,0,0,0
.long 30818,0,41088,41088,3146112,1284,16777216,327680,3,0,16,0,16,8192,1314816,16777216
.long 0,0,0,0,0,0,0,0,4,0,0,0,0,0,0,0
.long 0,0,0,0,0,0,0,0,4,0,0,0,0,0,0,0
.long 0,0,0,0,0,0,0,0,4,0,0,0,0,0,0,0
.long 195170,0,41088,41088,3146624,1284,16777216,327680,3,0,16,0,16,8192,1314816,16777216
.long 0,0,0,0,0,0,0,0,4,0,0,0,0,0,0,0
.long 0,0,0,0,0,0,0,0,4,0,0,0,0,0,0,0
.long 0,0,0,0,0,0,0,0,4,0,0,0,0,0,0,0
.long 359522,0,41088,41088,3147136,1284,16777216,327680,3,0,16,0,16,8192,1314816,16777216
.long 0,0,0,0,0,0,0,0,4,0,0,0,0,0,0,0
.long 0,0,0,0,0,0,0,0,4,0,0,0,0,0,0,0
.long 0,0,0,0,0,0,0,0,4,0,0,0,0,0,0,0
.long 523874,0,41088,41088,3147648,1284,16777216,327680,3,0,16,0,16,8192,1314816,16777216
.long 0,0,0,0,0,0,0,0,4,0,0,0,0,0,0,0
.long 0,0,0,0,0,0,0,0,4,0,0,0,0,0,0,0
.long 0,0,0,0,0,0,0,0,4,0,0,0,0,0,0,0
.long 688226,0,41088,41088,3148160,1284,16777216,327680,3,0,16,0,16,8192,1314816,16777216
.long 0,0,0,0,0,0,0,0,4,0,0,0,0,0,0,0
.long 0,0,0,0,0,0,0,0,4,0,0,0,0,0,0,0
.long 0,0,0,0,0,0,0,0,4,0,0,0,0,0,0,0
.long 852578,0,41088,41088,3148672,1284,16777216,327680,3,0,16,0,16,8192,1314816,16777216
.long 0,0,0,0,0,0,0,0,4,0,0,0,0,0,0,0
.long 0,0,0,0,0,0,0,0,4,0,0,0,0,0,0,0
.long 0,0,0,0,0,0,0,0,4,0,0,0,0,0,0,0
.long 1016930,0,41088,41088,3149184,1284,16777216,327680,3,0,16,0,16,8192,1314816,16777216
.long 0,0,0,0,0,0,0,0,4,0,0,0,0,0,0,0
.long 0,0,0,0,0,0,0,0,4,0,0,0,0,0,0,0
.long 0,0,0,0,0,0,0,0,4,0,0,0,0,0,0,0
.long 1181282,0,41088,41088,3149696,1284,16777216,327680,3,0,16,0,16,8192,1314816,16777216
.long 0,0,0,0,0,0,0,0,4,0,0,0,0,0,0,0
.long 0,0,0,0,0,0,0,0,4,0,0,0,0,0,0,0
.long 0,0,0,0,0,0,0,0,4,0,0,0,0,0,0,0
.long 30946,0,41088,41088,3211648,1284,16777216,327680,3,0,16,0,16,8192,1314816,16777216
.long 0,0,0,0,0,0,0,0,4,0,0,0,0,0,0,0
.long 0,0,0,0,0,0,0,0,4,0,0,0,0,0,0,0
.long 0,0,0,0,0,0,0,0,4,0,0,0,0,0,0,0
.long 195298,0,41088,41088,3212160,1284,16777216,327680,3,0,16,0,16,8192,1314816,16777216
.long 0,0,0,0,0,0,0,0,4,0,0,0,0,0,0,0
.long 0,0,0,0,0,0,0,0,4,0,0,0,0,0,0,0
.long 0,0,0,0,0,0,0,0,4,0,0,0,0,0,0,0
.long 359650,0,41088,41088,3212672,1284,16777216,327680,3,0,16,0,16,8192,1314816,16777216
.long 0,0,0,0,0,0,0,0,4,0,0,0,0,0,0,0
.long 0,0,0,0,0,0,0,0,4,0,0,0,0,0,0,0
.long 0,0,0,0,0,0,0,0,4,0,0,0,0,0,0,0
.long 524002,0,41088,41088,3213184,1284,16777216,327680,3,0,16,0,16,8192,1314816,16777216
.long 0,0,0,0,0,0,0,0,4,0,0,0,0,0,0,0
.long 0,0,0,0,0,0,0,0,4,0,0,0,0,0,0,0
.long 0,0,0,0,0,0,0,0,4,0,0,0,0,0,0,0
.long 688354,0,41088,41088,3213696,1284,16777216,327680,3,0,16,0,16,8192,1314816,16777216
.long 0,0,0,0,0,0,0,0,4,0,0,0,0,0,0,0
.long 0,0,0,0,0,0,0,0,4,0,0,0,0,0,0,0
.long 0,0,0,0,0,0,0,0,4,0,0,0,0,0,0,0
.long 852706,0,41088,41088,3214208,1284,16777216,327680,3,0,16,0,16,8192,1314816,16777216
.long 0,0,0,0,0,0,0,0,4,0,0,0,0,0,0,0
.long 0,0,0,0,0,0,0,0,4,0,0,0,0,0,0,0
.long 0,0,0,0,0,0,0,0,4,0,0,0,0,0,0,0
.long 1017058,0,41088,41088,3214720,1284,16777216,327680,3,0,16,0,16,8192,1314816,16777216
.long 0,0,0,0,0,0,0,0,4,0,0,0,0,0,0,0
.long 0,0,0,0,0,0,0,0,4,0,0,0,0,0,0,0
.long 0,0,0,0,0,0,0,0,4,0,0,0,0,0,0,0
.long 1181410,0,41088,41088,3215232,1284,16777216,327680,3,0,16,0,16,8192,1314816,16777216
.long 0,0,0,0,0,0,0,0,4,0,0,0,0,0,0,0
.long 0,0,0,0,0,0,0,0,4,0,0,0,0,0,0,0
.long 0,0,0,0,0,0,0,0,4,0,0,0,0,0,0,0
.section .rodata,"a"
.p2align 6
.amdhsa_kernel sequential_preLN__spectral_gfnet__dense_activation_silu__prompt_kernel
  .amdhsa_next_free_vgpr 512
  .amdhsa_next_free_sgpr 100
  .amdhsa_accum_offset 256
  .amdhsa_group_segment_fixed_size 0
  .amdhsa_kernarg_size 72
  .amdhsa_user_sgpr_count 2
  .amdhsa_user_sgpr_kernarg_segment_ptr 1
  .amdhsa_system_sgpr_workgroup_id_x 1
  .amdhsa_float_denorm_mode_32 3
.end_amdhsa_kernel
```
